```python
import torch

def _softmax(x, axis=-1):
    return torch.softmax(x, dim=axis)
def _gelu(x):
    return torch.nn.functional.gelu(x, approximate="tanh")
def _silu(x):
    return torch.nn.functional.silu(x)
def _sigmoid(x):
    return torch.sigmoid(x)
def _layernorm(x, axis=-1, eps=1e-5):
    m = x.mean(dim=axis, keepdim=True)
    v = x.var(dim=axis, keepdim=True, unbiased=False)
    return (x - m) / torch.sqrt(v + eps)
def _scatter_add(tgt, idx, src, axis=0):
    return tgt.clone().index_add_(axis, idx, src)
def _segment_sum(src, seg, n):
    out = torch.zeros((n,) + src.shape[1:], dtype=src.dtype)
    return out.index_add_(0, seg, src)
def _pad(x, pw):
    flat = tuple(v for pair in reversed(pw) for v in pair)
    return torch.nn.functional.pad(x, flat)

kernel_name = 'interleave_layers__sliding_local_dilated__mixer_token_mlp__prompt'

def setup_inputs():

    _w = (lambda a: (lambda t: t.to(torch.bfloat16) if t.is_floating_point() else t)(torch.as_tensor(a)))
    def _A_setup():
        B, S, D = 1, 2048, 512
        return {
            "x": _w((lambda *s: torch.randn(*s, dtype=torch.bfloat16) * 0.05)(B, S, D)),
            "wqkv": _w((lambda *s: torch.randn(*s, dtype=torch.bfloat16) * 0.05)(D, 3 * D)),
            "wo": _w((lambda *s: torch.randn(*s, dtype=torch.bfloat16) * 0.05)(D, D)),
        }
    _A_in = _A_setup()

    def _B_setup():
        B, S, D, F = 1, 2048, 512, 1792
        return {
            "x": _w((lambda *s: torch.randn(*s, dtype=torch.bfloat16) * 0.05)(B, S, D)),
            "w1": _w((lambda *s: torch.randn(*s, dtype=torch.bfloat16) * 0.8)(S, F) * (S ** -0.5)),
            "b1": _w((lambda *s: torch.randn(*s, dtype=torch.bfloat16) * 0.8)(F) * 0.02),
            "w2": _w((lambda *s: torch.randn(*s, dtype=torch.bfloat16) * 0.8)(F, S) * (F ** -0.5)),
            "b2": _w((lambda *s: torch.randn(*s, dtype=torch.bfloat16) * 0.8)(S) * 0.02),
        }
    _B_in = _B_setup()

    return {
        "A_x": _A_in["x"],
        "A_wqkv": _A_in["wqkv"],
        "A_wo": _A_in["wo"],
        "B_x": _B_in["x"],
        "B_w1": _B_in["w1"],
        "B_b1": _B_in["b1"],
        "B_w2": _B_in["w2"],
        "B_b2": _B_in["b2"],
    }

def reference(A_x, A_wqkv, A_wo, B_x, B_w1, B_b1, B_w2, B_b2):
    def _A_ref(x, wqkv, wo):
        B, S, D = x.shape
        H = 32; Dh = D // H
        W, dil = 8, 2
        qkv = (lambda x, *d: x.permute(*d))((x @ wqkv).reshape(B, S, 3, H, Dh), 2, 0, 3, 1, 4)
        q, k, v = qkv[0], qkv[1], qkv[2]
        scale = Dh ** -0.5
        pos = torch.arange(S)
        off = torch.arange(W) * dil
        idx = pos[:, None] - off[None, :]
        mask = idx >= 0
        idx_c = torch.where(mask, idx, 0).reshape(-1)
        kg = k[:, :, idx_c, :].reshape(B, H, S, W, Dh)
        vg = v[:, :, idx_c, :].reshape(B, H, S, W, Dh)
        logits = torch.einsum("bhsd,bhswd->bhsw", q, kg) * scale
        logits = torch.where(mask[None, None, :, :], logits, -1e9)
        attn = _softmax(logits, axis=-1)
        o = torch.einsum("bhsw,bhswd->bhsd", attn, vg)
        return (lambda x, *d: x.permute(*d))(o, 0, 2, 1, 3).reshape(B, S, D) @ wo

    def _B_ref(x, w1, b1, w2, b2):
        B, S, D = x.shape
        h = _layernorm(x, axis=-1)
        u = torch.einsum("bsd,sf->bdf", h, w1) + b1
        u = _gelu(u)
        y = torch.einsum("bdf,fs->bds", u, w2) + b2
        return (lambda x, *d: x.permute(*d))(y, 0, 2, 1)

    x = A_x
    x = x + _A_ref(_layernorm(x, axis=-1), A_wqkv, A_wo)
    x = x + _B_ref(_layernorm(x, axis=-1), B_w1, B_b1, B_w2, B_b2)
    x = x + _A_ref(_layernorm(x, axis=-1), A_wqkv, A_wo)
    x = x + _B_ref(_layernorm(x, axis=-1), B_w1, B_b1, B_w2, B_b2)
    return x
```

```asm
; @launch grid=(256,1,1) block=(256,1,1) lds=163840
.amdgcn_target "amdgcn-amd-amdhsa--gfx950"
.text
.globl interleave_layers__sliding_local_dilated__mixer_token_mlp__prompt_kernel
.p2align 8
.type interleave_layers__sliding_local_dilated__mixer_token_mlp__prompt_kernel,@function
interleave_layers__sliding_local_dilated__mixer_token_mlp__prompt_kernel:
    s_cmp_lt_u32 s2, 256
    s_cbranch_scc1 L_go
    s_endpgm
L_go:
    s_load_dwordx16 s[64:79], s[0:1], 0
    s_load_dwordx2 s[80:81], s[0:1], 64
    s_load_dwordx2 s[82:83], s[0:1], 80
    v_lshrrev_b32 v22, 6, v0
    v_and_b32 v1, 63, v0
    v_readfirstlane_b32 s41, v22
    s_getreg_b32 s101, hwreg(HW_REG_XCC_ID)
    s_and_b32 s101, s101, 15
    s_and_b32 s42, s2, 7
    s_lshr_b32 s43, s2, 3
    s_mov_b32 s100, 0
    v_lshrrev_b32 v2, 4, v1
    v_and_b32 v3, 15, v1
    v_lshlrev_b32 v4, 4, v1
    v_lshlrev_b32 v27, 3, v1
    s_lshl_b32 s44, s41, 10
    s_lshr_b32 s60, s43, 4
    s_lshl_b32 s45, s42, 1
    s_add_u32 s45, s45, s60
    s_and_b32 s46, s43, 15
    s_lshl_b32 s53, s46, 6
    s_add_u32 s57, s46, s45
    s_add_u32 s92, s57, 0
    s_and_b32 s92, s92, 7
    s_mul_i32 s84, s92, 196608
    s_add_u32 s84, s84, s53
    s_add_u32 s93, s57, 1
    s_and_b32 s93, s93, 7
    s_mul_i32 s85, s93, 196608
    s_add_u32 s85, s85, s53
    s_add_u32 s94, s57, 2
    s_and_b32 s94, s94, 7
    s_mul_i32 s86, s94, 196608
    s_add_u32 s86, s86, s53
    s_add_u32 s95, s57, 3
    s_and_b32 s95, s95, 7
    s_mul_i32 s87, s95, 196608
    s_add_u32 s87, s87, s53
    s_add_u32 s96, s57, 4
    s_and_b32 s96, s96, 7
    s_mul_i32 s88, s96, 196608
    s_add_u32 s88, s88, s53
    s_add_u32 s97, s57, 5
    s_and_b32 s97, s97, 7
    s_mul_i32 s89, s97, 196608
    s_add_u32 s89, s89, s53
    s_add_u32 s98, s57, 6
    s_and_b32 s98, s98, 7
    s_mul_i32 s90, s98, 196608
    s_add_u32 s90, s90, s53
    s_add_u32 s99, s57, 7
    s_and_b32 s99, s99, 7
    s_mul_i32 s91, s99, 196608
    s_add_u32 s91, s91, s53
    v_lshrrev_b32 v22, 2, v1
    s_lshl_b32 s60, s41, 4
    v_add_u32 v22, s60, v22
    v_mul_u32_u24 v6, 3072, v22
    v_lshrrev_b32 v22, 5, v1
    v_lshlrev_b32 v22, 1, v22
    v_and_b32 v23, 3, v1
    v_xor_b32 v22, v22, v23
    v_lshl_add_u32 v6, v22, 4, v6
    v_lshrrev_b32 v22, 3, v1
    v_and_b32 v23, 7, v1
    v_xor_b32 v23, v23, v22
    v_lshlrev_b32 v23, 4, v23
    v_lshl_add_u32 v5, v22, 10, v23
    s_getpc_b64 s[58:59]
L_pc_1:
    s_sub_u32 s58, s58, L_pc_1-interleave_layers__sliding_local_dilated__mixer_token_mlp__prompt_kernel
    s_subb_u32 s59, s59, 0
    s_lshl_b32 s3, s43, 2
    s_add_u32 s3, s3, s41
    s_lshl_b32 s3, s3, 9
    v_lshlrev_b32 v62, 7, v1
    v_add_u32 v62, s3, v62
    v_min_u32 v62, L_end-interleave_layers__sliding_local_dilated__mixer_token_mlp__prompt_kernel-4, v62
    s_mov_b64 exec, 15
    global_load_dword a253, v62, s[58:59]
    s_mov_b64 exec, -1
    s_waitcnt lgkmcnt(0)
    s_load_dword s40, s[82:83], 0
    s_mov_b32 s71, 2031616
    s_load_dword s70, s[82:83], s71
    s_mov_b32 s4, s64
    s_and_b32 s5, s65, 0xffff
    s_mov_b32 s6, 2097152
    s_mov_b32 s7, 0x20000
    s_mov_b32 s8, s66
    s_and_b32 s9, s67, 0xffff
    s_mov_b32 s10, 1572864
    s_mov_b32 s11, 0x20000
    s_mov_b32 s12, s68
    s_and_b32 s13, s69, 0xffff
    s_mov_b32 s14, 524288
    s_mov_b32 s15, 0x20000
    s_mov_b32 s16, s72
    s_and_b32 s17, s73, 0xffff
    s_mov_b32 s18, 7340032
    s_mov_b32 s19, 0x20000
    s_mov_b32 s24, s74
    s_and_b32 s25, s75, 0xffff
    s_mov_b32 s26, 3584
    s_mov_b32 s27, 0x20000
    s_mov_b32 s20, s76
    s_and_b32 s21, s77, 0xffff
    s_mov_b32 s22, 7340032
    s_mov_b32 s23, 0x20000
    s_mov_b32 s28, s78
    s_and_b32 s29, s79, 0xffff
    s_mov_b32 s30, 4096
    s_mov_b32 s31, 0x20000
    s_mov_b32 s32, s80
    s_and_b32 s33, s81, 0xffff
    s_mov_b32 s34, 2097152
    s_mov_b32 s35, 0x20000
    s_mov_b32 s36, s82
    s_and_b32 s37, s83, 0xffff
    s_mov_b32 s38, 268435456
    s_mov_b32 s39, 0x20000
    s_lshl_b32 s72, s45, 3
    s_lshl_b32 s61, s41, 1
    s_add_u32 s72, s72, s61
    s_lshl_b32 s72, s72, 14
    s_lshl_b32 s78, s45, 4
    s_add_u32 s78, s78, s46
    s_lshl_b32 s78, s78, 3
    s_add_u32 s78, s78, s61
    s_lshl_b32 s74, s45, 3
    s_sub_u32 s74, s74, 1
    s_max_i32 s74, s74, 0
    s_lshl_b32 s74, s74, 14
    s_mul_i32 s73, s41, 12288
    s_add_u32 s73, s73, 98304
    s_lshl_b32 s3, s43, 2
    s_add_u32 s3, s3, s41
    s_mul_i32 s3, s3, 12288
    s_add_u32 s3, s3, 384
    v_lshlrev_b32 v23, 10, v1
    s_mov_b64 exec, 0xfff
    buffer_load_dword a246, v23, s[8:11], s3 offen
    s_mov_b64 exec, -1
    s_lshl_b32 s3, s78, 10
    buffer_load_dwordx4 v[64:67], v4, s[4:7], s3 offen offset:0
    buffer_load_dwordx4 v[68:71], v4, s[4:7], s3 offen offset:1024
    s_lshl_b32 s63, s92, 7
    s_add_u32 s63, s63, s72
    s_add_u32 m0, s73, 0
    s_nop 0
    buffer_load_dwordx4 v5, s[4:7], s63 offen lds
    s_lshl_b32 s63, s92, 7
    s_add_u32 s63, s63, s72
    s_add_u32 s63, s63, 8192
    s_add_u32 m0, s73, 1024
    s_nop 0
    buffer_load_dwordx4 v5, s[4:7], s63 offen lds
    s_lshl_b32 s63, s92, 7
    s_add_u32 s63, s63, s72
    s_add_u32 s63, s63, 16384
    s_add_u32 m0, s73, 2048
    s_nop 0
    buffer_load_dwordx4 v5, s[4:7], s63 offen lds
    s_lshl_b32 s63, s92, 7
    s_add_u32 s63, s63, s72
    s_add_u32 s63, s63, 24576
    s_add_u32 m0, s73, 3072
    s_nop 0
    buffer_load_dwordx4 v5, s[4:7], s63 offen lds
    s_add_u32 m0, s44, 0
    s_add_u32 s63, s84, 0
    buffer_load_dwordx4 v6, s[8:11], s63 offen lds
    s_add_u32 m0, s44, 4096
    s_add_u32 s63, s84, 1024
    buffer_load_dwordx4 v6, s[8:11], s63 offen lds
    s_add_u32 m0, s44, 8192
    s_add_u32 s63, s84, 2048
    buffer_load_dwordx4 v6, s[8:11], s63 offen lds
    s_lshl_b32 s63, s93, 7
    s_add_u32 s63, s63, s72
    s_add_u32 m0, s73, 4096
    s_nop 0
    buffer_load_dwordx4 v5, s[4:7], s63 offen lds
    s_lshl_b32 s63, s93, 7
    s_add_u32 s63, s63, s72
    s_add_u32 s63, s63, 8192
    s_add_u32 m0, s73, 5120
    s_nop 0
    buffer_load_dwordx4 v5, s[4:7], s63 offen lds
    s_lshr_b32 s60, s43, 3
    s_lshl_b32 s47, s42, 2
    s_add_u32 s47, s47, s60
    s_and_b32 s48, s43, 7
    s_and_b32 s60, s42, 1
    s_lshl_b32 s60, s60, 2
    s_and_b32 s49, s43, 3
    s_add_u32 s49, s49, s60
    s_lshr_b32 s60, s42, 1
    s_mul_i32 s60, s60, 7
    s_lshr_b32 s50, s43, 2
    s_add_u32 s50, s50, s60
    s_min_u32 s50, s50, 27
    s_lshr_b32 s51, s41, 1
    s_and_b32 s52, s41, 1
    s_lshl_b32 s54, s48, 7
    s_lshl_b32 s55, s50, 7
    s_lshl_b32 s56, s47, 7
    v_lshrrev_b32 v22, 3, v1
    s_lshl_b32 s60, s41, 3
    v_add_u32 v22, s60, v22
    v_and_b32 v23, 7, v1
    v_lshlrev_b32 v24, 1, v2
    v_xor_b32 v23, v23, v24
    v_lshlrev_b32 v23, 4, v23
    v_lshl_add_u32 v7, v22, 10, v23
    v_and_b32 v23, 7, v1
    v_and_b32 v24, 1, v2
    v_lshlrev_b32 v24, 2, v24
    v_xor_b32 v23, v23, v24
    v_lshlrev_b32 v23, 4, v23
    s_lshl_b32 s63, s93, 7
    s_add_u32 s63, s63, s72
    s_add_u32 s63, s63, 16384
    s_add_u32 m0, s73, 6144
    s_nop 0
    buffer_load_dwordx4 v5, s[4:7], s63 offen lds
    v_lshl_add_u32 v9, v22, 12, v23
    s_mul_i32 s79, s47, 229376
    s_add_u32 s79, s79, 17825792
    v_mul_u32_u24 v8, 3584, v22
    v_add_u32 v8, v8, v23
    s_and_b32 s60, s50, 1
    s_mul_i32 s61, s60, 1835008
    s_add_u32 s80, s55, s61
    s_sub_u32 s81, s55, s61
    v_mov_b32 v28, 0x3f803f80
    v_mov_b32 v29, 0x3f803f80
    v_mov_b32 v30, 0x3f803f80
    v_mov_b32 v31, 0x3f803f80
    s_waitcnt lgkmcnt(0)
    s_mul_i32 s40, s40, 1664525
    s_mul_i32 s70, s70, 0x9e3779b2
    s_add_u32 s40, s40, s70
    s_add_u32 s40, s40, 1013904223
    v_mov_b32 v26, s40
    s_cmp_lg_u32 s41, 0
    s_cbranch_scc1 xcc_2
    s_add_u32 s60, s40, s101
    v_mov_b32 v23, s60
    s_lshl_b32 s60, s42, 7
    s_lshl_b32 s61, s43, 2
    s_add_u32 s60, s60, s61
    s_add_u32 s60, s60, 655360
    v_mov_b32 v22, 0
    s_mov_b64 exec, 1
    buffer_store_dword v23, v22, s[36:39], s60 offen sc1
    s_mov_b64 exec, -1
xcc_2:
    v_lshrrev_b32 v22, 5, v1
    v_lshlrev_b32 v22, 2, v22
    v_lshrrev_b32 v23, 2, v1
    v_and_b32 v23, 3, v23
    s_lshl_b32 s63, s93, 7
    s_add_u32 s63, s63, s72
    s_add_u32 s63, s63, 24576
    s_add_u32 m0, s73, 7168
    s_nop 0
    buffer_load_dwordx4 v5, s[4:7], s63 offen lds
    v_add_u32 v22, v22, v23
    v_lshlrev_b32 v22, 7, v22
    v_lshrrev_b32 v23, 1, v23
    v_lshl_add_u32 v22, v23, 6, v22
    v_and_b32 v23, 1, v2
    v_lshl_add_u32 v22, v23, 5, v22
    v_and_b32 v23, 3, v1
    v_lshl_add_u32 v22, v23, 3, v22
    s_lshl_b32 s60, s51, 6
    v_xor_b32 v22, s60, v22
    s_lshl_b32 s60, s51, 12
    v_add_u32 v56, s60, v22
    v_xor_b32 v57, 64, v56
    v_add_u32 v58, 49152, v56
    s_add_u32 m0, s44, 12288
    s_add_u32 s63, s85, 0
    buffer_load_dwordx4 v6, s[8:11], s63 offen lds
    v_add_u32 v59, 49152, v57
    v_add_u32 v60, 98304, v56
    v_add_u32 v61, 98304, v57
    v_and_b32 v22, 1, v3
    v_cmp_eq_u32 s[64:65], 1, v22
    v_lshl_add_u32 v23, v2, 2, v22
    v_cmp_le_u32 s[66:67], v23, v3
    v_add_u32 v23, 2, v23
    v_cmp_le_u32 s[68:69], v23, v3
    s_lshl_b32 s76, s43, 2
    s_add_u32 s76, s76, s41
    s_lshr_b32 s60, s76, 6
    s_and_b32 s76, s76, 63
    s_mul_i32 s76, s76, 7168
    s_mul_i32 s60, s60, 3670016
    s_add_u32 s76, s76, s60
    s_lshr_b32 s60, s42, 1
    s_mul_i32 s60, s60, 896
    s_add_u32 s76, s76, s60
    s_lshl_b32 s77, s45, 3
    s_lshl_b32 s60, s41, 1
    s_add_u32 s77, s77, s60
    s_lshl_b32 s77, s77, 4
    s_add_u32 s77, s77, s46
    s_lshl_b32 s77, s77, 10
    v_mov_b32 v24, 0x0c0c0c0c
    v_mov_b32 v22, 0x0c0c0100
    v_mov_b32 v23, 0x01000c0c
    s_add_u32 m0, s44, 16384
    s_add_u32 s63, s85, 1024
    buffer_load_dwordx4 v6, s[8:11], s63 offen lds
    v_cndmask_b32 v22, v22, v23, s[64:65]
    v_cndmask_b32 v42, v24, v22, s[66:67]
    v_cndmask_b32 v40, v22, v24, s[66:67]
    v_mov_b32 v22, 0x0c0c0302
    v_mov_b32 v23, 0x03020c0c
    v_cndmask_b32 v22, v22, v23, s[64:65]
    v_cndmask_b32 v43, v24, v22, s[68:69]
    v_cndmask_b32 v41, v22, v24, s[68:69]
    s_or_b32 s60, s45, s41
    s_cmp_eq_u32 s60, 0
    s_cselect_b32 s60, 0xf149f2ca, 0
    v_mov_b32 v44, s60
    v_mov_b32 v45, s60
    v_mov_b32 v46, s60
    v_mov_b32 v47, s60
    s_add_u32 m0, s44, 20480
    s_add_u32 s63, s85, 2048
    buffer_load_dwordx4 v6, s[8:11], s63 offen lds
    v_lshrrev_b32 v22, 2, v1
    v_and_b32 v22, 3, v22
    v_lshl_add_u32 v22, v2, 3, v22
    v_lshlrev_b32 v22, 6, v22
    v_and_b32 v23, 3, v1
    v_lshl_add_u32 v22, v23, 3, v22
    v_and_b32 v23, 1, v2
    v_lshl_add_u32 v10, v23, 5, v22
    v_add_u32 v11, 49152, v10
    v_xor_b32 v12, 32, v10
    v_xor_b32 v13, 32, v11
    v_lshrrev_b32 v22, 3, v1
    s_lshl_b32 s63, s94, 7
    s_add_u32 s63, s63, s72
    s_add_u32 m0, s73, 8192
    s_nop 0
    buffer_load_dwordx4 v5, s[4:7], s63 offen lds
    v_mul_u32_u24 v24, 3584, v22
    v_and_b32 v23, 7, v1
    v_min_u32 v20, 6, v23
    v_lshl_add_u32 v20, v20, 7, v24
    v_lshlrev_b32 v22, 14, v22
    v_lshl_add_u32 v21, v23, 7, v22
    s_lshl_b32 s60, s52, 5
    v_xor_b32 v24, s60, v10
    v_xor_b32 v25, s60, v11
    s_lshl_b32 s60, s51, 12
    s_add_u32 s60, s60, 4096
    v_add_u32 v14, s60, v24
    v_add_u32 v15, s60, v25
    v_and_b32 v22, 7, v3
    v_xor_b32 v22, v22, v2
    s_lshl_b32 s63, s94, 7
    s_add_u32 s63, s63, s72
    s_add_u32 s63, s63, 8192
    s_add_u32 m0, s73, 9216
    s_nop 0
    buffer_load_dwordx4 v5, s[4:7], s63 offen lds
    v_lshlrev_b32 v22, 4, v22
    v_lshl_add_u32 v22, v3, 7, v22
    v_add_u32 v16, s73, v22
    v_xor_b32 v17, 64, v16
    v_add_u32 v18, 147456, v22
    v_xor_b32 v19, 64, v18
    v_lshrrev_b32 v22, 3, v1
    v_lshlrev_b32 v22, 11, v22
    v_and_b32 v23, 7, v1
    v_lshl_add_u32 v22, v23, 4, v22
    v_add_u32 v22, 147456, v22
    ds_write_b128 v22, v[28:31]
    s_waitcnt vmcnt(16)
    v_dot2_f32_bf16 v72, v64, v28, 0
    s_lshl_b32 s63, s94, 7
    s_add_u32 s63, s63, s72
    s_add_u32 s63, s63, 16384
    s_add_u32 m0, s73, 10240
    s_nop 0
    buffer_load_dwordx4 v5, s[4:7], s63 offen lds
    v_dot2_f32_bf16 v74, v64, v64, 0
    v_dot2_f32_bf16 v73, v68, v28, 0
    v_dot2_f32_bf16 v75, v68, v68, 0
    v_dot2_f32_bf16 v72, v65, v28, v72
    v_dot2_f32_bf16 v74, v65, v65, v74
    v_dot2_f32_bf16 v73, v69, v28, v73
    v_dot2_f32_bf16 v75, v69, v69, v75
    v_dot2_f32_bf16 v72, v66, v28, v72
    v_dot2_f32_bf16 v74, v66, v66, v74
    v_dot2_f32_bf16 v73, v70, v28, v73
    v_dot2_f32_bf16 v75, v70, v70, v75
    v_dot2_f32_bf16 v72, v67, v28, v72
    s_lshl_b32 s63, s94, 7
    s_add_u32 s63, s63, s72
    s_add_u32 s63, s63, 24576
    s_add_u32 m0, s73, 11264
    s_nop 0
    buffer_load_dwordx4 v5, s[4:7], s63 offen lds
    v_dot2_f32_bf16 v74, v67, v67, v74
    v_dot2_f32_bf16 v73, v71, v28, v73
    v_dot2_f32_bf16 v75, v71, v71, v75
    s_nop 1
    v_permlane32_swap_b32 v72, v73
    v_permlane32_swap_b32 v74, v75
    v_add_f32 v72, v72, v73
    v_add_f32 v74, v74, v75
    s_nop 1
    v_permlane16_swap_b32 v72, v74
    v_add_f32 v72, v72, v74
    s_nop 1
    v_add_f32_dpp v72, v72, v72 row_ror:8 row_mask:0xf bank_mask:0xf
    s_nop 1
    v_add_f32_dpp v72, v72, v72 row_ror:4 row_mask:0xf bank_mask:0xf
    s_nop 1
    v_add_f32_dpp v72, v72, v72 row_ror:2 row_mask:0xf bank_mask:0xf
    s_add_u32 m0, s44, 24576
    s_add_u32 s63, s86, 0
    buffer_load_dwordx4 v6, s[8:11], s63 offen lds
    v_add_f32_dpp v72, v72, v72 row_ror:1 row_mask:0xf bank_mask:0xf
    v_mov_b32 v73, v72
    s_nop 1
    v_permlane16_swap_b32 v72, v73
    v_mul_f32 v72, 0x3b000000, v72
    v_mul_f32 v73, 0x3b000000, v73
    v_fma_f32 v73, -v72, v72, v73
    v_max_f32 v73, 0, v73
    v_add_f32 v74, 0x3727c5ac, v73
    v_rsq_f32 v76, v74
    s_nop 0
    v_mul_f32 v78, v72, v76
    v_sub_f32 v78, 0, v78
    v_mov_b32 v77, v26
    v_mov_b32 v79, v26
    v_lshrrev_b32 v23, 5, v1
    v_lshlrev_b32 v23, 4, v23
    s_lshl_b32 s3, s78, 4
    s_add_u32 s3, s3, 720896
    s_mov_b32 exec_lo, 1
    s_mov_b32 exec_hi, 1
    buffer_store_dwordx4 v[76:79], v23, s[36:39], s3 offen sc1
    s_mov_b64 exec, -1
    s_add_u32 m0, s44, 28672
    s_add_u32 s63, s86, 1024
    buffer_load_dwordx4 v6, s[8:11], s63 offen lds
    s_add_u32 m0, s44, 32768
    s_add_u32 s63, s86, 2048
    buffer_load_dwordx4 v6, s[8:11], s63 offen lds
    s_lshl_b32 s60, s41, 11
    s_add_u32 s60, s60, 131072
    v_lshlrev_b32 v50, 6, v3
    v_lshl_add_u32 v50, v2, 3, v50
    v_add_u32 v48, s60, v50
    v_lshrrev_b32 v51, 2, v1
    v_lshlrev_b32 v51, 6, v51
    v_and_b32 v49, 3, v1
    v_lshl_add_u32 v51, v49, 3, v51
    v_add_u32 v51, s60, v51
    s_add_u32 s60, s44, 140288
    v_add_u32 v49, s60, v27
    s_lshl_b32 s60, s52, 9
    s_add_u32 s60, s60, 140288
    s_lshl_b32 s3, s52, 5
    s_add_u32 s3, s3, 131072
    s_cmp_lg_u32 s51, 0
    s_cselect_b32 s60, s3, s60
    s_cselect_b64 vcc, -1, 0
    v_cndmask_b32 v50, v27, v50, vcc
    v_add_u32 v50, s60, v50
    s_waitcnt vmcnt(18)
    ds_read_b128 v[136:139], v16 offset:0
    ds_read_b128 v[140:143], v16 offset:2048
    ds_read_b128 v[144:147], v17 offset:0
    ds_read_b128 v[148:151], v17 offset:2048
    s_waitcnt vmcnt(15)
    s_barrier
    ds_read_b64_tr_b16 a[0:1], v10 offset:0
    ds_read_b64_tr_b16 a[2:3], v10 offset:256
    ds_read_b64_tr_b16 a[4:5], v12 offset:0
    ds_read_b64_tr_b16 a[6:7], v12 offset:256
    ds_read_b64_tr_b16 a[8:9], v10 offset:4096
    ds_read_b64_tr_b16 a[10:11], v10 offset:4352
    ds_read_b64_tr_b16 a[12:13], v12 offset:4096
    ds_read_b64_tr_b16 a[14:15], v12 offset:4352
    ds_read_b64_tr_b16 a[16:17], v10 offset:8192
    ds_read_b64_tr_b16 a[18:19], v10 offset:8448
    s_waitcnt lgkmcnt(10)
    s_waitcnt lgkmcnt(6)
    v_mfma_f32_16x16x32_bf16 v[64:67], a[0:3], v[136:139], 0
    ds_read_b64_tr_b16 a[20:21], v12 offset:8192
    s_waitcnt lgkmcnt(11)
    s_lshl_b32 s63, s95, 7
    s_add_u32 s63, s63, s72
    s_add_u32 m0, s73, 0
    s_nop 0
    buffer_load_dwordx4 v5, s[4:7], s63 offen lds
    v_mfma_f32_16x16x32_bf16 v[88:91], a[0:3], v[140:143], 0
    ds_read_b64_tr_b16 a[22:23], v12 offset:8448
    v_mfma_f32_16x16x32_bf16 v[68:71], a[4:7], v[136:139], 0
    ds_read_b64_tr_b16 a[24:25], v10 offset:2048
    s_lshl_b32 s63, s95, 7
    s_add_u32 s63, s63, s72
    s_add_u32 s63, s63, 8192
    s_add_u32 m0, s73, 1024
    s_nop 0
    buffer_load_dwordx4 v5, s[4:7], s63 offen lds
    v_mfma_f32_16x16x32_bf16 v[92:95], a[4:7], v[140:143], 0
    ds_read_b64_tr_b16 a[26:27], v10 offset:2304
    s_waitcnt lgkmcnt(6)
    v_mfma_f32_16x16x32_bf16 v[72:75], a[8:11], v[136:139], 0
    ds_read_b64_tr_b16 a[28:29], v12 offset:2048
    s_lshl_b32 s63, s95, 7
    s_add_u32 s63, s63, s72
    s_add_u32 s63, s63, 16384
    s_add_u32 m0, s73, 2048
    s_nop 0
    buffer_load_dwordx4 v5, s[4:7], s63 offen lds
    v_mfma_f32_16x16x32_bf16 v[96:99], a[8:11], v[140:143], 0
    ds_read_b64_tr_b16 a[30:31], v12 offset:2304
    v_mfma_f32_16x16x32_bf16 v[76:79], a[12:15], v[136:139], 0
    ds_read_b64_tr_b16 a[32:33], v10 offset:6144
    s_waitcnt vmcnt(14)
    ds_read_b128 v[152:155], v16 offset:4096
    s_lshl_b32 s63, s95, 7
    s_add_u32 s63, s63, s72
    s_add_u32 s63, s63, 24576
    s_add_u32 m0, s73, 3072
    s_nop 0
    buffer_load_dwordx4 v5, s[4:7], s63 offen lds
    v_mfma_f32_16x16x32_bf16 v[100:103], a[12:15], v[140:143], 0
    ds_read_b64_tr_b16 a[34:35], v10 offset:6400
    ds_read_b128 v[156:159], v16 offset:6144
    s_waitcnt lgkmcnt(8)
    v_mfma_f32_16x16x32_bf16 v[80:83], a[16:19], v[136:139], 0
    ds_read_b64_tr_b16 a[36:37], v12 offset:6144
    ds_read_b128 v[160:163], v17 offset:4096
    s_add_u32 m0, s44, 36864
    s_add_u32 s63, s87, 0
    buffer_load_dwordx4 v6, s[8:11], s63 offen lds
    v_mfma_f32_16x16x32_bf16 v[104:107], a[16:19], v[140:143], 0
    ds_read_b64_tr_b16 a[38:39], v12 offset:6400
    ds_read_b128 v[164:167], v17 offset:6144
    v_mfma_f32_16x16x32_bf16 v[84:87], a[20:23], v[136:139], 0
    ds_read_b64_tr_b16 a[40:41], v10 offset:10240
    s_add_u32 m0, s44, 40960
    s_add_u32 s63, s87, 1024
    buffer_load_dwordx4 v6, s[8:11], s63 offen lds
    v_mfma_f32_16x16x32_bf16 v[108:111], a[20:23], v[140:143], 0
    ds_read_b64_tr_b16 a[42:43], v10 offset:10496
    s_waitcnt lgkmcnt(10)
    v_mfma_f32_16x16x32_bf16 v[64:67], a[24:27], v[144:147], v[64:67]
    ds_read_b64_tr_b16 a[44:45], v12 offset:10240
    s_waitcnt lgkmcnt(3)
    s_lshl_b32 s63, s96, 7
    s_add_u32 s63, s63, s72
    s_add_u32 m0, s73, 4096
    s_nop 0
    buffer_load_dwordx4 v5, s[4:7], s63 offen lds
    v_mfma_f32_16x16x32_bf16 v[88:91], a[24:27], v[148:151], v[88:91]
    ds_read_b64_tr_b16 a[46:47], v12 offset:10496
    s_waitcnt vmcnt(15)
    s_barrier
    v_mfma_f32_16x16x32_bf16 v[68:71], a[28:31], v[144:147], v[68:71]
    ds_read_b64_tr_b16 a[0:1], v10 offset:12288
    s_lshl_b32 s63, s96, 7
    s_add_u32 s63, s63, s72
    s_add_u32 s63, s63, 8192
    s_add_u32 m0, s73, 5120
    s_nop 0
    buffer_load_dwordx4 v5, s[4:7], s63 offen lds
    v_mfma_f32_16x16x32_bf16 v[92:95], a[28:31], v[148:151], v[92:95]
    ds_read_b64_tr_b16 a[2:3], v10 offset:12544
    s_waitcnt lgkmcnt(7)
    v_mfma_f32_16x16x32_bf16 v[72:75], a[32:35], v[144:147], v[72:75]
    ds_read_b64_tr_b16 a[4:5], v12 offset:12288
    s_lshl_b32 s63, s96, 7
    s_add_u32 s63, s63, s72
    s_add_u32 s63, s63, 16384
    s_add_u32 m0, s73, 6144
    s_nop 0
    buffer_load_dwordx4 v5, s[4:7], s63 offen lds
    v_mfma_f32_16x16x32_bf16 v[96:99], a[32:35], v[148:151], v[96:99]
    ds_read_b64_tr_b16 a[6:7], v12 offset:12544
    v_mfma_f32_16x16x32_bf16 v[76:79], a[36:39], v[144:147], v[76:79]
    ds_read_b64_tr_b16 a[8:9], v10 offset:16384
    s_waitcnt vmcnt(13)
    ds_read_b128 v[168:171], v16 offset:8192
    s_lshl_b32 s63, s96, 7
    s_add_u32 s63, s63, s72
    s_add_u32 s63, s63, 24576
    s_add_u32 m0, s73, 7168
    s_nop 0
    buffer_load_dwordx4 v5, s[4:7], s63 offen lds
    v_mfma_f32_16x16x32_bf16 v[100:103], a[36:39], v[148:151], v[100:103]
    ds_read_b64_tr_b16 a[10:11], v10 offset:16640
    ds_read_b128 v[172:175], v16 offset:10240
    s_waitcnt lgkmcnt(8)
    v_mfma_f32_16x16x32_bf16 v[80:83], a[40:43], v[144:147], v[80:83]
    ds_read_b64_tr_b16 a[12:13], v12 offset:16384
    ds_read_b128 v[176:179], v17 offset:8192
    s_add_u32 m0, s44, 45056
    s_add_u32 s63, s87, 2048
    buffer_load_dwordx4 v6, s[8:11], s63 offen lds
    v_mfma_f32_16x16x32_bf16 v[104:107], a[40:43], v[148:151], v[104:107]
    ds_read_b64_tr_b16 a[14:15], v12 offset:16640
    ds_read_b128 v[180:183], v17 offset:10240
    v_mfma_f32_16x16x32_bf16 v[84:87], a[44:47], v[144:147], v[84:87]
    ds_read_b64_tr_b16 a[16:17], v10 offset:20480
    s_add_u32 m0, s44, 49152
    s_add_u32 s63, s88, 0
    buffer_load_dwordx4 v6, s[8:11], s63 offen lds
    v_mfma_f32_16x16x32_bf16 v[108:111], a[44:47], v[148:151], v[108:111]
    ds_read_b64_tr_b16 a[18:19], v10 offset:20736
    s_waitcnt lgkmcnt(15)
    s_waitcnt lgkmcnt(10)
    v_mfma_f32_16x16x32_bf16 v[64:67], a[0:3], v[152:155], v[64:67]
    ds_read_b64_tr_b16 a[20:21], v12 offset:20480
    s_waitcnt lgkmcnt(3)
    s_lshl_b32 s63, s97, 7
    s_add_u32 s63, s63, s72
    s_add_u32 m0, s73, 8192
    s_nop 0
    buffer_load_dwordx4 v5, s[4:7], s63 offen lds
    v_mfma_f32_16x16x32_bf16 v[88:91], a[0:3], v[156:159], v[88:91]
    ds_read_b64_tr_b16 a[22:23], v12 offset:20736
    v_mfma_f32_16x16x32_bf16 v[68:71], a[4:7], v[152:155], v[68:71]
    ds_read_b64_tr_b16 a[24:25], v10 offset:14336
    s_lshl_b32 s63, s97, 7
    s_add_u32 s63, s63, s72
    s_add_u32 s63, s63, 8192
    s_add_u32 m0, s73, 9216
    s_nop 0
    buffer_load_dwordx4 v5, s[4:7], s63 offen lds
    v_mfma_f32_16x16x32_bf16 v[92:95], a[4:7], v[156:159], v[92:95]
    ds_read_b64_tr_b16 a[26:27], v10 offset:14592
    s_waitcnt lgkmcnt(7)
    v_mfma_f32_16x16x32_bf16 v[72:75], a[8:11], v[152:155], v[72:75]
    ds_read_b64_tr_b16 a[28:29], v12 offset:14336
    s_lshl_b32 s63, s97, 7
    s_add_u32 s63, s63, s72
    s_add_u32 s63, s63, 16384
    s_add_u32 m0, s73, 10240
    s_nop 0
    buffer_load_dwordx4 v5, s[4:7], s63 offen lds
    v_mfma_f32_16x16x32_bf16 v[96:99], a[8:11], v[156:159], v[96:99]
    ds_read_b64_tr_b16 a[30:31], v12 offset:14592
    v_mfma_f32_16x16x32_bf16 v[76:79], a[12:15], v[152:155], v[76:79]
    ds_read_b64_tr_b16 a[32:33], v10 offset:18432
    s_waitcnt vmcnt(11)
    ds_read_b128 v[184:187], v16 offset:0
    s_lshl_b32 s63, s97, 7
    s_add_u32 s63, s63, s72
    s_add_u32 s63, s63, 24576
    s_add_u32 m0, s73, 11264
    s_nop 0
    buffer_load_dwordx4 v5, s[4:7], s63 offen lds
    v_mfma_f32_16x16x32_bf16 v[100:103], a[12:15], v[156:159], v[100:103]
    ds_read_b64_tr_b16 a[34:35], v10 offset:18688
    ds_read_b128 v[188:191], v16 offset:2048
    s_waitcnt lgkmcnt(8)
    v_mfma_f32_16x16x32_bf16 v[80:83], a[16:19], v[152:155], v[80:83]
    ds_read_b64_tr_b16 a[36:37], v12 offset:18432
    ds_read_b128 v[192:195], v17 offset:0
    s_add_u32 m0, s44, 53248
    s_add_u32 s63, s88, 1024
    buffer_load_dwordx4 v6, s[8:11], s63 offen lds
    v_mfma_f32_16x16x32_bf16 v[104:107], a[16:19], v[156:159], v[104:107]
    ds_read_b64_tr_b16 a[38:39], v12 offset:18688
    ds_read_b128 v[196:199], v17 offset:2048
    v_mfma_f32_16x16x32_bf16 v[84:87], a[20:23], v[152:155], v[84:87]
    ds_read_b64_tr_b16 a[40:41], v10 offset:22528
    s_add_u32 m0, s44, 57344
    s_add_u32 s63, s88, 2048
    buffer_load_dwordx4 v6, s[8:11], s63 offen lds
    v_mfma_f32_16x16x32_bf16 v[108:111], a[20:23], v[156:159], v[108:111]
    ds_read_b64_tr_b16 a[42:43], v10 offset:22784
    s_waitcnt lgkmcnt(10)
    v_mfma_f32_16x16x32_bf16 v[64:67], a[24:27], v[160:163], v[64:67]
    ds_read_b64_tr_b16 a[44:45], v12 offset:22528
    s_waitcnt lgkmcnt(3)
    s_lshl_b32 s63, s98, 7
    s_add_u32 s63, s63, s72
    s_add_u32 m0, s73, 0
    s_nop 0
    buffer_load_dwordx4 v5, s[4:7], s63 offen lds
    v_mfma_f32_16x16x32_bf16 v[88:91], a[24:27], v[164:167], v[88:91]
    ds_read_b64_tr_b16 a[46:47], v12 offset:22784
    s_waitcnt vmcnt(19)
    s_barrier
    v_mfma_f32_16x16x32_bf16 v[68:71], a[28:31], v[160:163], v[68:71]
    ds_read_b64_tr_b16 a[0:1], v10 offset:24576
    s_lshl_b32 s63, s98, 7
    s_add_u32 s63, s63, s72
    s_add_u32 s63, s63, 8192
    s_add_u32 m0, s73, 1024
    s_nop 0
    buffer_load_dwordx4 v5, s[4:7], s63 offen lds
    v_mfma_f32_16x16x32_bf16 v[92:95], a[28:31], v[164:167], v[92:95]
    ds_read_b64_tr_b16 a[2:3], v10 offset:24832
    s_waitcnt lgkmcnt(7)
    v_mfma_f32_16x16x32_bf16 v[72:75], a[32:35], v[160:163], v[72:75]
    ds_read_b64_tr_b16 a[4:5], v12 offset:24576
    s_lshl_b32 s63, s98, 7
    s_add_u32 s63, s63, s72
    s_add_u32 s63, s63, 16384
    s_add_u32 m0, s73, 2048
    s_nop 0
    buffer_load_dwordx4 v5, s[4:7], s63 offen lds
    v_mfma_f32_16x16x32_bf16 v[96:99], a[32:35], v[164:167], v[96:99]
    ds_read_b64_tr_b16 a[6:7], v12 offset:24832
    v_mfma_f32_16x16x32_bf16 v[76:79], a[36:39], v[160:163], v[76:79]
    ds_read_b64_tr_b16 a[8:9], v10 offset:28672
    s_waitcnt vmcnt(11)
    ds_read_b128 v[200:203], v16 offset:4096
    s_lshl_b32 s63, s98, 7
    s_add_u32 s63, s63, s72
    s_add_u32 s63, s63, 24576
    s_add_u32 m0, s73, 3072
    s_nop 0
    buffer_load_dwordx4 v5, s[4:7], s63 offen lds
    v_mfma_f32_16x16x32_bf16 v[100:103], a[36:39], v[164:167], v[100:103]
    ds_read_b64_tr_b16 a[10:11], v10 offset:28928
    ds_read_b128 v[204:207], v16 offset:6144
    s_waitcnt lgkmcnt(8)
    v_mfma_f32_16x16x32_bf16 v[80:83], a[40:43], v[160:163], v[80:83]
    ds_read_b64_tr_b16 a[12:13], v12 offset:28672
    ds_read_b128 v[208:211], v17 offset:4096
    s_lshl_b32 s3, s41, 1
    s_add_u32 s3, s3, s57
    s_add_u32 s3, s3, 0
    s_and_b32 s3, s3, 7
    s_lshl_b32 s3, s3, 7
    s_add_u32 s3, s3, s74
    s_add_u32 s3, s3, 0
    s_lshl_b32 s63, s41, 12
    s_add_u32 m0, s63, 147456
    s_mov_b32 exec_lo, 0xffffff00
    buffer_load_dwordx4 v5, s[4:7], s3 offen lds
    s_mov_b32 exec_lo, -1
    v_mfma_f32_16x16x32_bf16 v[104:107], a[40:43], v[164:167], v[104:107]
    ds_read_b64_tr_b16 a[14:15], v12 offset:28928
    ds_read_b128 v[212:215], v17 offset:6144
    v_mfma_f32_16x16x32_bf16 v[84:87], a[44:47], v[160:163], v[84:87]
    ds_read_b64_tr_b16 a[16:17], v10 offset:32768
    s_lshl_b32 s3, s41, 1
    s_add_u32 s3, s3, s57
    s_add_u32 s3, s3, 0
    s_and_b32 s3, s3, 7
    s_lshl_b32 s3, s3, 7
    s_add_u32 s3, s3, s74
    s_add_u32 s3, s3, 8192
    s_lshl_b32 s63, s41, 12
    s_add_u32 m0, s63, 148480
    s_nop 0
    buffer_load_dwordx4 v5, s[4:7], s3 offen lds
    v_mfma_f32_16x16x32_bf16 v[108:111], a[44:47], v[164:167], v[108:111]
    ds_read_b64_tr_b16 a[18:19], v10 offset:33024
    s_waitcnt lgkmcnt(15)
    s_waitcnt lgkmcnt(10)
    v_mfma_f32_16x16x32_bf16 v[64:67], a[0:3], v[168:171], v[64:67]
    ds_read_b64_tr_b16 a[20:21], v12 offset:32768
    s_waitcnt lgkmcnt(3)
    s_lshl_b32 s63, s99, 7
    s_add_u32 s63, s63, s72
    s_add_u32 m0, s73, 4096
    s_nop 0
    buffer_load_dwordx4 v5, s[4:7], s63 offen lds
    v_mfma_f32_16x16x32_bf16 v[88:91], a[0:3], v[172:175], v[88:91]
    ds_read_b64_tr_b16 a[22:23], v12 offset:33024
    v_mfma_f32_16x16x32_bf16 v[68:71], a[4:7], v[168:171], v[68:71]
    ds_read_b64_tr_b16 a[24:25], v10 offset:26624
    s_lshl_b32 s63, s99, 7
    s_add_u32 s63, s63, s72
    s_add_u32 s63, s63, 8192
    s_add_u32 m0, s73, 5120
    s_nop 0
    buffer_load_dwordx4 v5, s[4:7], s63 offen lds
    v_mfma_f32_16x16x32_bf16 v[92:95], a[4:7], v[172:175], v[92:95]
    ds_read_b64_tr_b16 a[26:27], v10 offset:26880
    s_waitcnt lgkmcnt(7)
    v_mfma_f32_16x16x32_bf16 v[72:75], a[8:11], v[168:171], v[72:75]
    ds_read_b64_tr_b16 a[28:29], v12 offset:26624
    s_lshl_b32 s63, s99, 7
    s_add_u32 s63, s63, s72
    s_add_u32 s63, s63, 16384
    s_add_u32 m0, s73, 6144
    s_nop 0
    buffer_load_dwordx4 v5, s[4:7], s63 offen lds
    v_mfma_f32_16x16x32_bf16 v[96:99], a[8:11], v[172:175], v[96:99]
    ds_read_b64_tr_b16 a[30:31], v12 offset:26880
    v_mfma_f32_16x16x32_bf16 v[76:79], a[12:15], v[168:171], v[76:79]
    ds_read_b64_tr_b16 a[32:33], v10 offset:30720
    s_waitcnt vmcnt(11)
    ds_read_b128 v[216:219], v16 offset:8192
    s_lshl_b32 s63, s99, 7
    s_add_u32 s63, s63, s72
    s_add_u32 s63, s63, 24576
    s_add_u32 m0, s73, 7168
    s_nop 0
    buffer_load_dwordx4 v5, s[4:7], s63 offen lds
    v_mfma_f32_16x16x32_bf16 v[100:103], a[12:15], v[172:175], v[100:103]
    ds_read_b64_tr_b16 a[34:35], v10 offset:30976
    ds_read_b128 v[220:223], v16 offset:10240
    s_waitcnt lgkmcnt(8)
    v_mfma_f32_16x16x32_bf16 v[80:83], a[16:19], v[168:171], v[80:83]
    ds_read_b64_tr_b16 a[36:37], v12 offset:30720
    ds_read_b128 v[224:227], v17 offset:8192
    s_lshl_b32 s3, s41, 1
    s_add_u32 s3, s3, s57
    s_add_u32 s3, s3, 1
    s_and_b32 s3, s3, 7
    s_lshl_b32 s3, s3, 7
    s_add_u32 s3, s3, s74
    s_add_u32 s3, s3, 0
    s_lshl_b32 s63, s41, 12
    s_add_u32 m0, s63, 149504
    s_mov_b32 exec_lo, 0xffffff00
    buffer_load_dwordx4 v5, s[4:7], s3 offen lds
    s_mov_b32 exec_lo, -1
    v_mfma_f32_16x16x32_bf16 v[104:107], a[16:19], v[172:175], v[104:107]
    ds_read_b64_tr_b16 a[38:39], v12 offset:30976
    ds_read_b128 v[228:231], v17 offset:10240
    v_mfma_f32_16x16x32_bf16 v[84:87], a[20:23], v[168:171], v[84:87]
    ds_read_b64_tr_b16 a[40:41], v10 offset:34816
    s_lshl_b32 s3, s41, 1
    s_add_u32 s3, s3, s57
    s_add_u32 s3, s3, 1
    s_and_b32 s3, s3, 7
    s_lshl_b32 s3, s3, 7
    s_add_u32 s3, s3, s74
    s_add_u32 s3, s3, 8192
    s_lshl_b32 s63, s41, 12
    s_add_u32 m0, s63, 150528
    s_nop 0
    buffer_load_dwordx4 v5, s[4:7], s3 offen lds
    v_mfma_f32_16x16x32_bf16 v[108:111], a[20:23], v[172:175], v[108:111]
    ds_read_b64_tr_b16 a[42:43], v10 offset:35072
    s_waitcnt lgkmcnt(10)
    v_mfma_f32_16x16x32_bf16 v[64:67], a[24:27], v[176:179], v[64:67]
    ds_read_b64_tr_b16 a[44:45], v12 offset:34816
    s_add_u32 m0, s44, 61440
    s_add_u32 s63, s89, 0
    buffer_load_dwordx4 v6, s[8:11], s63 offen lds
    v_mfma_f32_16x16x32_bf16 v[88:91], a[24:27], v[180:183], v[88:91]
    ds_read_b64_tr_b16 a[46:47], v12 offset:35072
    s_waitcnt vmcnt(20)
    s_barrier
    v_mfma_f32_16x16x32_bf16 v[68:71], a[28:31], v[176:179], v[68:71]
    ds_read_b64_tr_b16 a[0:1], v10 offset:36864
    s_add_u32 m0, s44, 65536
    s_add_u32 s63, s89, 1024
    buffer_load_dwordx4 v6, s[8:11], s63 offen lds
    v_mfma_f32_16x16x32_bf16 v[92:95], a[28:31], v[180:183], v[92:95]
    ds_read_b64_tr_b16 a[2:3], v10 offset:37120
    s_waitcnt lgkmcnt(7)
    v_mfma_f32_16x16x32_bf16 v[72:75], a[32:35], v[176:179], v[72:75]
    ds_read_b64_tr_b16 a[4:5], v12 offset:36864
    s_add_u32 m0, s44, 69632
    s_add_u32 s63, s89, 2048
    buffer_load_dwordx4 v6, s[8:11], s63 offen lds
    v_mfma_f32_16x16x32_bf16 v[96:99], a[32:35], v[180:183], v[96:99]
    ds_read_b64_tr_b16 a[6:7], v12 offset:37120
    v_mfma_f32_16x16x32_bf16 v[76:79], a[36:39], v[176:179], v[76:79]
    ds_read_b64_tr_b16 a[8:9], v10 offset:40960
    s_waitcnt vmcnt(11)
    ds_read_b128 v[136:139], v16 offset:0
    s_add_u32 m0, s44, 73728
    s_add_u32 s63, s90, 0
    buffer_load_dwordx4 v6, s[8:11], s63 offen lds
    v_mfma_f32_16x16x32_bf16 v[100:103], a[36:39], v[180:183], v[100:103]
    ds_read_b64_tr_b16 a[10:11], v10 offset:41216
    ds_read_b128 v[140:143], v16 offset:2048
    s_waitcnt lgkmcnt(8)
    v_mfma_f32_16x16x32_bf16 v[80:83], a[40:43], v[176:179], v[80:83]
    ds_read_b64_tr_b16 a[12:13], v12 offset:40960
    ds_read_b128 v[144:147], v17 offset:0
    s_add_u32 m0, s44, 77824
    s_add_u32 s63, s90, 1024
    buffer_load_dwordx4 v6, s[8:11], s63 offen lds
    v_mfma_f32_16x16x32_bf16 v[104:107], a[40:43], v[180:183], v[104:107]
    ds_read_b64_tr_b16 a[14:15], v12 offset:41216
    ds_read_b128 v[148:151], v17 offset:2048
    v_mfma_f32_16x16x32_bf16 v[84:87], a[44:47], v[176:179], v[84:87]
    ds_read_b64_tr_b16 a[16:17], v10 offset:45056
    s_add_u32 m0, s44, 81920
    s_add_u32 s63, s90, 2048
    buffer_load_dwordx4 v6, s[8:11], s63 offen lds
    v_mfma_f32_16x16x32_bf16 v[108:111], a[44:47], v[180:183], v[108:111]
    ds_read_b64_tr_b16 a[18:19], v10 offset:45312
    s_waitcnt lgkmcnt(15)
    s_waitcnt lgkmcnt(10)
    v_mfma_f32_16x16x32_bf16 v[64:67], a[0:3], v[184:187], v[64:67]
    ds_read_b64_tr_b16 a[20:21], v12 offset:45056
    v_and_b32 v62, 31, v1
    v_lshlrev_b32 v62, 2, v62
    s_lshl_b32 s61, s42, 7
    s_add_u32 s61, s61, 655360
    buffer_load_dword v63, v62, s[36:39], s61 offen sc1
    v_mfma_f32_16x16x32_bf16 v[88:91], a[0:3], v[188:191], v[88:91]
    ds_read_b64_tr_b16 a[22:23], v12 offset:45312
    v_mfma_f32_16x16x32_bf16 v[68:71], a[4:7], v[184:187], v[68:71]
    ds_read_b64_tr_b16 a[24:25], v10 offset:38912
    s_add_u32 m0, s44, 86016
    s_add_u32 s63, s91, 0
    buffer_load_dwordx4 v6, s[8:11], s63 offen lds
    v_mfma_f32_16x16x32_bf16 v[92:95], a[4:7], v[188:191], v[92:95]
    ds_read_b64_tr_b16 a[26:27], v10 offset:39168
    s_waitcnt lgkmcnt(7)
    v_mfma_f32_16x16x32_bf16 v[72:75], a[8:11], v[184:187], v[72:75]
    ds_read_b64_tr_b16 a[28:29], v12 offset:38912
    s_add_u32 m0, s44, 90112
    s_add_u32 s63, s91, 1024
    buffer_load_dwordx4 v6, s[8:11], s63 offen lds
    v_mfma_f32_16x16x32_bf16 v[96:99], a[8:11], v[188:191], v[96:99]
    ds_read_b64_tr_b16 a[30:31], v12 offset:39168
    v_mfma_f32_16x16x32_bf16 v[76:79], a[12:15], v[184:187], v[76:79]
    ds_read_b64_tr_b16 a[32:33], v10 offset:43008
    s_waitcnt vmcnt(11)
    ds_read_b128 v[152:155], v16 offset:4096
    s_add_u32 m0, s44, 94208
    s_add_u32 s63, s91, 2048
    buffer_load_dwordx4 v6, s[8:11], s63 offen lds
    v_mfma_f32_16x16x32_bf16 v[100:103], a[12:15], v[188:191], v[100:103]
    ds_read_b64_tr_b16 a[34:35], v10 offset:43264
    ds_read_b128 v[156:159], v16 offset:6144
    s_waitcnt lgkmcnt(8)
    v_mfma_f32_16x16x32_bf16 v[80:83], a[16:19], v[184:187], v[80:83]
    ds_read_b64_tr_b16 a[36:37], v12 offset:43008
    ds_read_b128 v[160:163], v17 offset:4096
    v_mfma_f32_16x16x32_bf16 v[104:107], a[16:19], v[188:191], v[104:107]
    ds_read_b64_tr_b16 a[38:39], v12 offset:43264
    ds_read_b128 v[164:167], v17 offset:6144
    v_mfma_f32_16x16x32_bf16 v[84:87], a[20:23], v[184:187], v[84:87]
    ds_read_b64_tr_b16 a[40:41], v10 offset:47104
    v_mfma_f32_16x16x32_bf16 v[108:111], a[20:23], v[188:191], v[108:111]
    ds_read_b64_tr_b16 a[42:43], v10 offset:47360
    s_waitcnt lgkmcnt(10)
    v_mfma_f32_16x16x32_bf16 v[64:67], a[24:27], v[192:195], v[64:67]
    ds_read_b64_tr_b16 a[44:45], v12 offset:47104
    s_lshl_b32 s3, s43, 2
    s_add_u32 s3, s3, s41
    s_lshl_b32 s3, s3, 12
    v_lshlrev_b32 v23, 7, v1
    s_mov_b32 exec_hi, 0
    buffer_load_dword a245, v23, s[12:15], s3 offen
    s_mov_b64 exec, -1
    v_mfma_f32_16x16x32_bf16 v[88:91], a[24:27], v[196:199], v[88:91]
    ds_read_b64_tr_b16 a[46:47], v12 offset:47360
    s_waitcnt vmcnt(23)
    s_barrier
    v_mfma_f32_16x16x32_bf16 v[68:71], a[28:31], v[192:195], v[68:71]
    ds_read_b64_tr_b16 a[0:1], v11 offset:0
    v_mfma_f32_16x16x32_bf16 v[92:95], a[28:31], v[196:199], v[92:95]
    ds_read_b64_tr_b16 a[2:3], v11 offset:256
    s_waitcnt lgkmcnt(7)
    v_mfma_f32_16x16x32_bf16 v[72:75], a[32:35], v[192:195], v[72:75]
    ds_read_b64_tr_b16 a[4:5], v13 offset:0
    v_mfma_f32_16x16x32_bf16 v[96:99], a[32:35], v[196:199], v[96:99]
    ds_read_b64_tr_b16 a[6:7], v13 offset:256
    v_mfma_f32_16x16x32_bf16 v[76:79], a[36:39], v[192:195], v[76:79]
    ds_read_b64_tr_b16 a[8:9], v11 offset:4096
    v_mfma_f32_16x16x32_bf16 v[100:103], a[36:39], v[196:199], v[100:103]
    ds_read_b64_tr_b16 a[10:11], v11 offset:4352
    s_waitcnt lgkmcnt(6)
    v_mfma_f32_16x16x32_bf16 v[80:83], a[40:43], v[192:195], v[80:83]
    ds_read_b64_tr_b16 a[12:13], v13 offset:4096
    v_mfma_f32_16x16x32_bf16 v[104:107], a[40:43], v[196:199], v[104:107]
    ds_read_b64_tr_b16 a[14:15], v13 offset:4352
    v_mfma_f32_16x16x32_bf16 v[84:87], a[44:47], v[192:195], v[84:87]
    ds_read_b64_tr_b16 a[16:17], v11 offset:8192
    v_mfma_f32_16x16x32_bf16 v[108:111], a[44:47], v[196:199], v[108:111]
    ds_read_b64_tr_b16 a[18:19], v11 offset:8448
    s_waitcnt vmcnt(11)
    s_barrier
    s_waitcnt lgkmcnt(15)
    s_waitcnt lgkmcnt(6)
    v_mfma_f32_16x16x32_bf16 v[64:67], a[0:3], v[200:203], v[64:67]
    ds_read_b64_tr_b16 a[20:21], v13 offset:8192
    s_add_u32 s3, s76, 3211264
    s_mov_b64 exec, 0xffff
    buffer_load_dword v55, v20, s[16:19], s3 offen
    s_mov_b64 exec, -1
    v_mfma_f32_16x16x32_bf16 v[88:91], a[0:3], v[204:207], v[88:91]
    ds_read_b64_tr_b16 a[22:23], v13 offset:8448
    ds_read_b128 a[48:51], v18 offset:0
    ds_read_b64_tr_b16 a[52:53], v14 offset:0
    ds_read_b64_tr_b16 a[54:55], v14 offset:256
    ds_read_b64_tr_b16 a[56:57], v24 offset:0
    ds_read_b64_tr_b16 a[58:59], v24 offset:256
    v_mfma_f32_16x16x32_bf16 v[68:71], a[4:7], v[200:203], v[68:71]
    ds_read_b64_tr_b16 a[24:25], v11 offset:2048
    v_mfma_f32_16x16x32_bf16 v[92:95], a[4:7], v[204:207], v[92:95]
    ds_read_b64_tr_b16 a[26:27], v11 offset:2304
    s_waitcnt lgkmcnt(11)
    v_mfma_f32_16x16x32_bf16 v[72:75], a[8:11], v[200:203], v[72:75]
    ds_read_b64_tr_b16 a[28:29], v13 offset:2048
    v_mfma_f32_16x16x32_bf16 v[96:99], a[8:11], v[204:207], v[96:99]
    ds_read_b64_tr_b16 a[30:31], v13 offset:2304
    ds_read_b128 a[60:63], v19 offset:0
    ds_read_b64_tr_b16 a[64:65], v14 offset:2048
    ds_read_b64_tr_b16 a[66:67], v14 offset:2304
    ds_read_b64_tr_b16 a[68:69], v24 offset:2048
    ds_read_b64_tr_b16 a[70:71], v24 offset:2304
    v_mfma_f32_16x16x32_bf16 v[76:79], a[12:15], v[200:203], v[76:79]
    ds_read_b64_tr_b16 a[32:33], v11 offset:6144
    v_mfma_f32_16x16x32_bf16 v[100:103], a[12:15], v[204:207], v[100:103]
    ds_read_b64_tr_b16 a[34:35], v11 offset:6400
    s_waitcnt lgkmcnt(15)
    v_mfma_f32_16x16x32_bf16 v[80:83], a[16:19], v[200:203], v[80:83]
    ds_read_b64_tr_b16 a[36:37], v13 offset:6144
    v_mfma_f32_16x16x32_bf16 v[104:107], a[16:19], v[204:207], v[104:107]
    ds_read_b64_tr_b16 a[38:39], v13 offset:6400
    v_mfma_f32_16x16x32_bf16 v[84:87], a[20:23], v[200:203], v[84:87]
    ds_read_b64_tr_b16 a[40:41], v11 offset:10240
    v_mfma_f32_16x16x32_bf16 v[108:111], a[20:23], v[204:207], v[108:111]
    ds_read_b64_tr_b16 a[42:43], v11 offset:10496
    s_waitcnt lgkmcnt(15)
    v_mfma_f32_16x16x32_bf16 v[112:115], a[52:55], a[48:51], 0
    ds_read_b128 a[72:75], v18 offset:2048
    ds_read_b64_tr_b16 a[76:77], v14 offset:12288
    v_mfma_f32_16x16x32_bf16 v[116:119], a[56:59], a[48:51], 0
    ds_read_b64_tr_b16 a[78:79], v14 offset:12544
    ds_read_b64_tr_b16 a[80:81], v24 offset:12288
    ds_read_b64_tr_b16 a[82:83], v24 offset:12544
    s_waitcnt lgkmcnt(15)
    v_mfma_f32_16x16x32_bf16 v[64:67], a[24:27], v[208:211], v[64:67]
    ds_read_b64_tr_b16 a[44:45], v13 offset:10240
    s_lshl_b32 s3, s47, 2
    s_add_u32 s3, s3, s41
    s_lshl_b32 s3, s3, 3
    s_add_u32 s3, s3, s48
    s_lshl_b32 s3, s3, 8
    s_add_u32 s3, s3, 1048576
    s_mov_b64 exec, 3
    buffer_load_dword a248, v21, s[36:39], s3 offen
    s_lshl_b32 s3, s45, 4
    s_add_u32 s3, s3, s46
    s_mul_i32 s3, s3, 128
    s_add_u32 s3, s3, 65536
    s_mov_b64 exec, 1
    buffer_load_dword a247, v21, s[36:39], s3 offen
    s_mov_b64 exec, -1
    v_mfma_f32_16x16x32_bf16 v[88:91], a[24:27], v[212:215], v[88:91]
    ds_read_b64_tr_b16 a[46:47], v13 offset:10496
    s_waitcnt vmcnt(11)
    s_barrier
    v_mfma_f32_16x16x32_bf16 v[68:71], a[28:31], v[208:211], v[68:71]
    ds_read_b64_tr_b16 a[0:1], v11 offset:12288
    s_add_u32 s3, s76, 2752512
    s_mov_b64 exec, 0xffff
    buffer_load_dword v55, v20, s[16:19], s3 offen
    s_mov_b64 exec, -1
    v_mfma_f32_16x16x32_bf16 v[92:95], a[28:31], v[212:215], v[92:95]
    ds_read_b64_tr_b16 a[2:3], v11 offset:12544
    s_waitcnt lgkmcnt(11)
    v_mfma_f32_16x16x32_bf16 v[72:75], a[32:35], v[208:211], v[72:75]
    ds_read_b64_tr_b16 a[4:5], v13 offset:12288
    v_mfma_f32_16x16x32_bf16 v[96:99], a[32:35], v[212:215], v[96:99]
    ds_read_b64_tr_b16 a[6:7], v13 offset:12544
    s_waitcnt lgkmcnt(15)
    v_mfma_f32_16x16x32_bf16 v[112:115], a[64:67], a[60:63], v[112:115]
    ds_read_b128 a[84:87], v19 offset:2048
    ds_read_b64_tr_b16 a[88:89], v14 offset:14336
    v_mfma_f32_16x16x32_bf16 v[116:119], a[68:71], a[60:63], v[116:119]
    ds_read_b64_tr_b16 a[90:91], v14 offset:14592
    ds_read_b64_tr_b16 a[92:93], v24 offset:14336
    ds_read_b64_tr_b16 a[94:95], v24 offset:14592
    v_mfma_f32_16x16x32_bf16 v[76:79], a[36:39], v[208:211], v[76:79]
    ds_read_b64_tr_b16 a[8:9], v11 offset:16384
    v_mfma_f32_16x16x32_bf16 v[100:103], a[36:39], v[212:215], v[100:103]
    ds_read_b64_tr_b16 a[10:11], v11 offset:16640
    s_waitcnt lgkmcnt(11)
    v_mfma_f32_16x16x32_bf16 v[80:83], a[40:43], v[208:211], v[80:83]
    ds_read_b64_tr_b16 a[12:13], v13 offset:16384
    v_mfma_f32_16x16x32_bf16 v[104:107], a[40:43], v[212:215], v[104:107]
    ds_read_b64_tr_b16 a[14:15], v13 offset:16640
    s_waitcnt lgkmcnt(15)
    v_mfma_f32_16x16x32_bf16 v[112:115], a[76:79], a[72:75], v[112:115]
    ds_read_b128 a[48:51], v18 offset:4096
    ds_read_b64_tr_b16 a[52:53], v14 offset:24576
    v_mfma_f32_16x16x32_bf16 v[116:119], a[80:83], a[72:75], v[116:119]
    ds_read_b64_tr_b16 a[54:55], v14 offset:24832
    ds_read_b64_tr_b16 a[56:57], v24 offset:24576
    ds_read_b64_tr_b16 a[58:59], v24 offset:24832
    v_mfma_f32_16x16x32_bf16 v[84:87], a[44:47], v[208:211], v[84:87]
    ds_read_b64_tr_b16 a[16:17], v11 offset:20480
    v_mfma_f32_16x16x32_bf16 v[108:111], a[44:47], v[212:215], v[108:111]
    ds_read_b64_tr_b16 a[18:19], v11 offset:20736
    s_waitcnt lgkmcnt(15)
    s_waitcnt lgkmcnt(15)
    v_mfma_f32_16x16x32_bf16 v[64:67], a[0:3], v[216:219], v[64:67]
    ds_read_b64_tr_b16 a[20:21], v13 offset:20480
    s_lshl_b32 s3, s48, 5
    s_add_u32 s3, s3, s47
    s_mul_i32 s3, s3, 128
    s_add_u32 s3, s3, 131072
    s_mov_b64 exec, 1
    buffer_load_dword a244, v21, s[36:39], s3 offen
    s_mov_b64 exec, -1
    v_mfma_f32_16x16x32_bf16 v[88:91], a[0:3], v[220:223], v[88:91]
    ds_read_b64_tr_b16 a[22:23], v13 offset:20736
    v_mfma_f32_16x16x32_bf16 v[68:71], a[4:7], v[216:219], v[68:71]
    ds_read_b64_tr_b16 a[24:25], v11 offset:14336
    s_add_u32 s3, s76, 2293760
    s_mov_b64 exec, 0xffff
    buffer_load_dword v55, v20, s[16:19], s3 offen
    s_mov_b64 exec, -1
    v_mfma_f32_16x16x32_bf16 v[92:95], a[4:7], v[220:223], v[92:95]
    ds_read_b64_tr_b16 a[26:27], v11 offset:14592
    s_waitcnt lgkmcnt(15)
    v_mfma_f32_16x16x32_bf16 v[112:115], a[88:91], a[84:87], v[112:115]
    ds_read_b128 a[60:63], v19 offset:4096
    ds_read_b64_tr_b16 a[64:65], v14 offset:26624
    v_mfma_f32_16x16x32_bf16 v[116:119], a[92:95], a[84:87], v[116:119]
    ds_read_b64_tr_b16 a[66:67], v14 offset:26880
    ds_read_b64_tr_b16 a[68:69], v24 offset:26624
    ds_read_b64_tr_b16 a[70:71], v24 offset:26880
    s_waitcnt lgkmcnt(15)
    v_mfma_f32_16x16x32_bf16 v[72:75], a[8:11], v[216:219], v[72:75]
    ds_read_b64_tr_b16 a[28:29], v13 offset:14336
    v_mfma_f32_16x16x32_bf16 v[96:99], a[8:11], v[220:223], v[96:99]
    ds_read_b64_tr_b16 a[30:31], v13 offset:14592
    v_mfma_f32_16x16x32_bf16 v[76:79], a[12:15], v[216:219], v[76:79]
    ds_read_b64_tr_b16 a[32:33], v11 offset:18432
    v_mfma_f32_16x16x32_bf16 v[100:103], a[12:15], v[220:223], v[100:103]
    ds_read_b64_tr_b16 a[34:35], v11 offset:18688
    s_waitcnt lgkmcnt(11)
    v_mfma_f32_16x16x32_bf16 v[80:83], a[16:19], v[216:219], v[80:83]
    ds_read_b64_tr_b16 a[36:37], v13 offset:18432
    v_mfma_f32_16x16x32_bf16 v[104:107], a[16:19], v[220:223], v[104:107]
    ds_read_b64_tr_b16 a[38:39], v13 offset:18688
    s_waitcnt lgkmcnt(15)
    v_mfma_f32_16x16x32_bf16 v[112:115], a[52:55], a[48:51], v[112:115]
    ds_read_b128 a[72:75], v18 offset:6144
    ds_read_b64_tr_b16 a[76:77], v14 offset:36864
    v_mfma_f32_16x16x32_bf16 v[116:119], a[56:59], a[48:51], v[116:119]
    ds_read_b64_tr_b16 a[78:79], v14 offset:37120
    ds_read_b64_tr_b16 a[80:81], v24 offset:36864
    ds_read_b64_tr_b16 a[82:83], v24 offset:37120
    v_mfma_f32_16x16x32_bf16 v[84:87], a[20:23], v[216:219], v[84:87]
    ds_read_b64_tr_b16 a[40:41], v11 offset:22528
    v_mfma_f32_16x16x32_bf16 v[108:111], a[20:23], v[220:223], v[108:111]
    ds_read_b64_tr_b16 a[42:43], v11 offset:22784
    s_waitcnt lgkmcnt(11)
    v_mfma_f32_16x16x32_bf16 v[64:67], a[24:27], v[224:227], v[64:67]
    ds_read_b64_tr_b16 a[44:45], v13 offset:22528
    s_waitcnt vmcnt(10)
    s_mov_b32 s70, 30000
chk_3:
    v_sub_u32 v23, v63, v26
    v_cmp_lt_u32 vcc, 15, v23
    s_nop 3
    s_cbranch_vccz chk_3_d
    buffer_load_dword v63, v62, s[36:39], s61 offen sc1
    s_waitcnt vmcnt(0)
    s_sub_u32 s70, s70, 1
    s_cmp_lg_u32 s70, 0
    s_cbranch_scc1 chk_3
chk_3_d:
    v_cmp_ne_u32 vcc, s101, v23
    s_nop 3
    s_cmp_eq_u64 vcc, 0
    s_cselect_b32 s100, 1, 0
    v_mfma_f32_16x16x32_bf16 v[88:91], a[24:27], v[228:231], v[88:91]
    ds_read_b64_tr_b16 a[46:47], v13 offset:22784
    s_waitcnt lgkmcnt(15)
    v_mfma_f32_16x16x32_bf16 v[112:115], a[64:67], a[60:63], v[112:115]
    ds_read_b128 a[84:87], v19 offset:6144
    ds_read_b64_tr_b16 a[88:89], v14 offset:38912
    v_mfma_f32_16x16x32_bf16 v[116:119], a[68:71], a[60:63], v[116:119]
    ds_read_b64_tr_b16 a[90:91], v14 offset:39168
    ds_read_b64_tr_b16 a[92:93], v24 offset:38912
    ds_read_b64_tr_b16 a[94:95], v24 offset:39168
    s_waitcnt vmcnt(11)
    s_barrier
    v_mfma_f32_16x16x32_bf16 v[68:71], a[28:31], v[224:227], v[68:71]
    ds_read_b64_tr_b16 a[0:1], v11 offset:24576
    v_lshlrev_b32 v62, 4, v3
    s_lshl_b32 s61, s45, 11
    s_sub_u32 s78, s61, 256
    s_max_i32 s78, s78, 0
    s_add_u32 s78, s78, 720896
    s_lshl_b32 s3, s41, 9
    s_add_u32 s61, s61, s3
    s_add_u32 s61, s61, 720896
    buffer_load_dwordx4 v[120:123], v62, s[36:39], s61 offen offset:0 sc1
    buffer_load_dwordx4 v[124:127], v62, s[36:39], s61 offen offset:256 sc1
    buffer_load_dwordx4 v[128:131], v62, s[36:39], s78 offen offset:0 sc1
    v_mfma_f32_16x16x32_bf16 v[92:95], a[28:31], v[228:231], v[92:95]
    ds_read_b64_tr_b16 a[2:3], v11 offset:24832
    s_waitcnt lgkmcnt(15)
    v_mfma_f32_16x16x32_bf16 v[72:75], a[32:35], v[224:227], v[72:75]
    ds_read_b64_tr_b16 a[4:5], v13 offset:24576
    s_add_u32 s3, s76, 1835008
    s_mov_b64 exec, 0xffff
    buffer_load_dword v55, v20, s[16:19], s3 offen
    s_mov_b64 exec, -1
    v_mfma_f32_16x16x32_bf16 v[96:99], a[32:35], v[228:231], v[96:99]
    ds_read_b64_tr_b16 a[6:7], v13 offset:24832
    v_mfma_f32_16x16x32_bf16 v[76:79], a[36:39], v[224:227], v[76:79]
    ds_read_b64_tr_b16 a[8:9], v11 offset:28672
    v_mfma_f32_16x16x32_bf16 v[100:103], a[36:39], v[228:231], v[100:103]
    ds_read_b64_tr_b16 a[10:11], v11 offset:28928
    s_waitcnt lgkmcnt(15)
    v_mfma_f32_16x16x32_bf16 v[112:115], a[76:79], a[72:75], v[112:115]
    ds_read_b128 a[48:51], v18 offset:8192
    ds_read_b64_tr_b16 a[52:53], v15 offset:0
    v_mfma_f32_16x16x32_bf16 v[116:119], a[80:83], a[72:75], v[116:119]
    ds_read_b64_tr_b16 a[54:55], v15 offset:256
    ds_read_b64_tr_b16 a[56:57], v25 offset:0
    ds_read_b64_tr_b16 a[58:59], v25 offset:256
    s_waitcnt lgkmcnt(15)
    v_mfma_f32_16x16x32_bf16 v[80:83], a[40:43], v[224:227], v[80:83]
    ds_read_b64_tr_b16 a[12:13], v13 offset:28672
    v_mfma_f32_16x16x32_bf16 v[104:107], a[40:43], v[228:231], v[104:107]
    ds_read_b64_tr_b16 a[14:15], v13 offset:28928
    v_mfma_f32_16x16x32_bf16 v[84:87], a[44:47], v[224:227], v[84:87]
    ds_read_b64_tr_b16 a[16:17], v11 offset:32768
    v_mfma_f32_16x16x32_bf16 v[108:111], a[44:47], v[228:231], v[108:111]
    ds_read_b64_tr_b16 a[18:19], v11 offset:33024
    s_waitcnt lgkmcnt(15)
    s_waitcnt lgkmcnt(11)
    v_mfma_f32_16x16x32_bf16 v[64:67], a[0:3], v[136:139], v[64:67]
    ds_read_b64_tr_b16 a[20:21], v13 offset:32768
    s_and_b32 s3, s42, 1
    s_mul_i32 s3, s3, 458752
    s_add_u32 s3, s3, s76
    s_add_u32 s3, s3, 917504
    s_mov_b64 exec, 0xffff
    buffer_load_dword v55, v20, s[16:19], s3 offen
    s_mov_b64 exec, -1
    v_mfma_f32_16x16x32_bf16 v[88:91], a[0:3], v[140:143], v[88:91]
    ds_read_b64_tr_b16 a[22:23], v13 offset:33024
    s_waitcnt lgkmcnt(15)
    v_mfma_f32_16x16x32_bf16 v[112:115], a[88:91], a[84:87], v[112:115]
    ds_read_b128 a[60:63], v19 offset:8192
    ds_read_b64_tr_b16 a[64:65], v15 offset:2048
    v_mfma_f32_16x16x32_bf16 v[116:119], a[92:95], a[84:87], v[116:119]
    ds_read_b64_tr_b16 a[66:67], v15 offset:2304
    ds_read_b64_tr_b16 a[68:69], v25 offset:2048
    ds_read_b64_tr_b16 a[70:71], v25 offset:2304
    v_mfma_f32_16x16x32_bf16 v[68:71], a[4:7], v[136:139], v[68:71]
    ds_read_b64_tr_b16 a[24:25], v11 offset:26624
    v_mfma_f32_16x16x32_bf16 v[92:95], a[4:7], v[140:143], v[92:95]
    ds_read_b64_tr_b16 a[26:27], v11 offset:26880
    s_waitcnt lgkmcnt(11)
    v_mfma_f32_16x16x32_bf16 v[72:75], a[8:11], v[136:139], v[72:75]
    ds_read_b64_tr_b16 a[28:29], v13 offset:26624
    v_mfma_f32_16x16x32_bf16 v[96:99], a[8:11], v[140:143], v[96:99]
    ds_read_b64_tr_b16 a[30:31], v13 offset:26880
    s_waitcnt lgkmcnt(15)
    v_mfma_f32_16x16x32_bf16 v[112:115], a[52:55], a[48:51], v[112:115]
    ds_read_b128 a[72:75], v18 offset:10240
    ds_read_b64_tr_b16 a[76:77], v15 offset:12288
    v_mfma_f32_16x16x32_bf16 v[116:119], a[56:59], a[48:51], v[116:119]
    ds_read_b64_tr_b16 a[78:79], v15 offset:12544
    ds_read_b64_tr_b16 a[80:81], v25 offset:12288
    ds_read_b64_tr_b16 a[82:83], v25 offset:12544
    v_mfma_f32_16x16x32_bf16 v[76:79], a[12:15], v[136:139], v[76:79]
    ds_read_b64_tr_b16 a[32:33], v11 offset:30720
    v_mfma_f32_16x16x32_bf16 v[100:103], a[12:15], v[140:143], v[100:103]
    ds_read_b64_tr_b16 a[34:35], v11 offset:30976
    s_waitcnt lgkmcnt(15)
    v_mfma_f32_16x16x32_bf16 v[80:83], a[16:19], v[136:139], v[80:83]
    ds_read_b64_tr_b16 a[36:37], v13 offset:30720
    v_mfma_f32_16x16x32_bf16 v[104:107], a[16:19], v[140:143], v[104:107]
    ds_read_b64_tr_b16 a[38:39], v13 offset:30976
    v_mfma_f32_16x16x32_bf16 v[84:87], a[20:23], v[136:139], v[84:87]
    ds_read_b64_tr_b16 a[40:41], v11 offset:34816
    v_mfma_f32_16x16x32_bf16 v[108:111], a[20:23], v[140:143], v[108:111]
    ds_read_b64_tr_b16 a[42:43], v11 offset:35072
    s_waitcnt lgkmcnt(15)
    v_mfma_f32_16x16x32_bf16 v[112:115], a[64:67], a[60:63], v[112:115]
    ds_read_b128 a[84:87], v19 offset:10240
    ds_read_b64_tr_b16 a[88:89], v15 offset:14336
    v_mfma_f32_16x16x32_bf16 v[116:119], a[68:71], a[60:63], v[116:119]
    ds_read_b64_tr_b16 a[90:91], v15 offset:14592
    ds_read_b64_tr_b16 a[92:93], v25 offset:14336
    ds_read_b64_tr_b16 a[94:95], v25 offset:14592
    s_waitcnt lgkmcnt(15)
    v_mfma_f32_16x16x32_bf16 v[64:67], a[24:27], v[144:147], v[64:67]
    ds_read_b64_tr_b16 a[44:45], v13 offset:34816
    s_and_b32 s3, s42, 1
    s_mul_i32 s3, s3, 458752
    s_add_u32 s3, s3, s76
    s_add_u32 s3, s3, 0
    s_mov_b64 exec, 0xffff
    buffer_load_dword v55, v20, s[16:19], s3 offen
    s_mov_b64 exec, -1
    v_mfma_f32_16x16x32_bf16 v[88:91], a[24:27], v[148:151], v[88:91]
    ds_read_b64_tr_b16 a[46:47], v13 offset:35072
    s_waitcnt vmcnt(13)
    s_barrier
    v_mfma_f32_16x16x32_bf16 v[68:71], a[28:31], v[144:147], v[68:71]
    ds_read_b64_tr_b16 a[0:1], v11 offset:36864
    v_mfma_f32_16x16x32_bf16 v[92:95], a[28:31], v[148:151], v[92:95]
    ds_read_b64_tr_b16 a[2:3], v11 offset:37120
    s_waitcnt lgkmcnt(11)
    v_mfma_f32_16x16x32_bf16 v[72:75], a[32:35], v[144:147], v[72:75]
    ds_read_b64_tr_b16 a[4:5], v13 offset:36864
    v_mfma_f32_16x16x32_bf16 v[96:99], a[32:35], v[148:151], v[96:99]
    ds_read_b64_tr_b16 a[6:7], v13 offset:37120
    s_waitcnt lgkmcnt(15)
    v_mfma_f32_16x16x32_bf16 v[112:115], a[76:79], a[72:75], v[112:115]
    ds_read_b128 a[48:51], v18 offset:12288
    ds_read_b64_tr_b16 a[52:53], v15 offset:24576
    v_mfma_f32_16x16x32_bf16 v[116:119], a[80:83], a[72:75], v[116:119]
    ds_read_b64_tr_b16 a[54:55], v15 offset:24832
    ds_read_b64_tr_b16 a[56:57], v25 offset:24576
    ds_read_b64_tr_b16 a[58:59], v25 offset:24832
    v_mfma_f32_16x16x32_bf16 v[76:79], a[36:39], v[144:147], v[76:79]
    ds_read_b64_tr_b16 a[8:9], v11 offset:40960
    v_mfma_f32_16x16x32_bf16 v[100:103], a[36:39], v[148:151], v[100:103]
    ds_read_b64_tr_b16 a[10:11], v11 offset:41216
    s_waitcnt lgkmcnt(11)
    v_mfma_f32_16x16x32_bf16 v[80:83], a[40:43], v[144:147], v[80:83]
    ds_read_b64_tr_b16 a[12:13], v13 offset:40960
    v_mfma_f32_16x16x32_bf16 v[104:107], a[40:43], v[148:151], v[104:107]
    ds_read_b64_tr_b16 a[14:15], v13 offset:41216
    s_waitcnt lgkmcnt(15)
    v_mfma_f32_16x16x32_bf16 v[112:115], a[88:91], a[84:87], v[112:115]
    ds_read_b128 a[60:63], v19 offset:12288
    ds_read_b64_tr_b16 a[64:65], v15 offset:26624
    v_mfma_f32_16x16x32_bf16 v[116:119], a[92:95], a[84:87], v[116:119]
    ds_read_b64_tr_b16 a[66:67], v15 offset:26880
    ds_read_b64_tr_b16 a[68:69], v25 offset:26624
    ds_read_b64_tr_b16 a[70:71], v25 offset:26880
    v_mfma_f32_16x16x32_bf16 v[84:87], a[44:47], v[144:147], v[84:87]
    ds_read_b64_tr_b16 a[16:17], v11 offset:45056
    v_mfma_f32_16x16x32_bf16 v[108:111], a[44:47], v[148:151], v[108:111]
    ds_read_b64_tr_b16 a[18:19], v11 offset:45312
    s_waitcnt lgkmcnt(15)
    s_waitcnt lgkmcnt(15)
    v_mfma_f32_16x16x32_bf16 v[64:67], a[0:3], v[152:155], v[64:67]
    ds_read_b64_tr_b16 a[20:21], v13 offset:45056
    v_mfma_f32_16x16x32_bf16 v[88:91], a[0:3], v[156:159], v[88:91]
    ds_read_b64_tr_b16 a[22:23], v13 offset:45312
    v_mfma_f32_16x16x32_bf16 v[68:71], a[4:7], v[152:155], v[68:71]
    ds_read_b64_tr_b16 a[24:25], v11 offset:38912
    v_mfma_f32_16x16x32_bf16 v[92:95], a[4:7], v[156:159], v[92:95]
    ds_read_b64_tr_b16 a[26:27], v11 offset:39168
    s_waitcnt lgkmcnt(15)
    v_mfma_f32_16x16x32_bf16 v[112:115], a[52:55], a[48:51], v[112:115]
    ds_read_b128 a[72:75], v18 offset:14336
    ds_read_b64_tr_b16 a[76:77], v15 offset:36864
    v_mfma_f32_16x16x32_bf16 v[116:119], a[56:59], a[48:51], v[116:119]
    ds_read_b64_tr_b16 a[78:79], v15 offset:37120
    ds_read_b64_tr_b16 a[80:81], v25 offset:36864
    ds_read_b64_tr_b16 a[82:83], v25 offset:37120
    s_waitcnt lgkmcnt(15)
    v_mfma_f32_16x16x32_bf16 v[72:75], a[8:11], v[152:155], v[72:75]
    ds_read_b64_tr_b16 a[28:29], v13 offset:38912
    v_mfma_f32_16x16x32_bf16 v[96:99], a[8:11], v[156:159], v[96:99]
    ds_read_b64_tr_b16 a[30:31], v13 offset:39168
    v_mfma_f32_16x16x32_bf16 v[76:79], a[12:15], v[152:155], v[76:79]
    ds_read_b64_tr_b16 a[32:33], v11 offset:43008
    v_mfma_f32_16x16x32_bf16 v[100:103], a[12:15], v[156:159], v[100:103]
    ds_read_b64_tr_b16 a[34:35], v11 offset:43264
    s_waitcnt lgkmcnt(11)
    v_mfma_f32_16x16x32_bf16 v[80:83], a[16:19], v[152:155], v[80:83]
    ds_read_b64_tr_b16 a[36:37], v13 offset:43008
    v_mfma_f32_16x16x32_bf16 v[104:107], a[16:19], v[156:159], v[104:107]
    ds_read_b64_tr_b16 a[38:39], v13 offset:43264
    s_waitcnt lgkmcnt(15)
    v_mfma_f32_16x16x32_bf16 v[112:115], a[64:67], a[60:63], v[112:115]
    ds_read_b128 a[84:87], v19 offset:14336
    ds_read_b64_tr_b16 a[88:89], v15 offset:38912
    v_mfma_f32_16x16x32_bf16 v[116:119], a[68:71], a[60:63], v[116:119]
    ds_read_b64_tr_b16 a[90:91], v15 offset:39168
    ds_read_b64_tr_b16 a[92:93], v25 offset:38912
    ds_read_b64_tr_b16 a[94:95], v25 offset:39168
    v_mfma_f32_16x16x32_bf16 v[84:87], a[20:23], v[152:155], v[84:87]
    ds_read_b64_tr_b16 a[40:41], v11 offset:47104
    v_mfma_f32_16x16x32_bf16 v[108:111], a[20:23], v[156:159], v[108:111]
    ds_read_b64_tr_b16 a[42:43], v11 offset:47360
    s_waitcnt lgkmcnt(11)
    v_mfma_f32_16x16x32_bf16 v[64:67], a[24:27], v[160:163], v[64:67]
    ds_read_b64_tr_b16 a[44:45], v13 offset:47104
    s_lshl_b32 s3, s43, 2
    s_add_u32 s3, s3, s41
    s_and_b32 s63, s42, 1
    s_lshl_b32 s63, s63, 7
    s_add_u32 s3, s3, s63
    s_mul_i32 s3, s3, 28672
    s_lshr_b32 s63, s42, 1
    s_lshl_b32 s63, s63, 10
    s_add_u32 s3, s3, s63
    s_add_u32 s3, s3, 384
    v_lshlrev_b32 v23, 12, v1
    s_mov_b64 exec, 0x7f
    buffer_load_dword a251, v23, s[20:23], s3 offen
    s_mov_b64 exec, -1
    v_mfma_f32_16x16x32_bf16 v[88:91], a[24:27], v[164:167], v[88:91]
    ds_read_b64_tr_b16 a[46:47], v13 offset:47360
    s_waitcnt lgkmcnt(15)
    v_mfma_f32_16x16x32_bf16 v[112:115], a[76:79], a[72:75], v[112:115]
    v_mfma_f32_16x16x32_bf16 v[116:119], a[80:83], a[72:75], v[116:119]
    v_mfma_f32_16x16x32_bf16 v[68:71], a[28:31], v[160:163], v[68:71]
    v_mfma_f32_16x16x32_bf16 v[92:95], a[28:31], v[164:167], v[92:95]
    s_waitcnt lgkmcnt(9)
    v_mfma_f32_16x16x32_bf16 v[72:75], a[32:35], v[160:163], v[72:75]
    v_mfma_f32_16x16x32_bf16 v[96:99], a[32:35], v[164:167], v[96:99]
    v_mfma_f32_16x16x32_bf16 v[76:79], a[36:39], v[160:163], v[76:79]
    v_mfma_f32_16x16x32_bf16 v[100:103], a[36:39], v[164:167], v[100:103]
    s_waitcnt lgkmcnt(4)
    v_mfma_f32_16x16x32_bf16 v[112:115], a[88:91], a[84:87], v[112:115]
    v_mfma_f32_16x16x32_bf16 v[116:119], a[92:95], a[84:87], v[116:119]
    s_waitcnt lgkmcnt(0)
    v_mfma_f32_16x16x32_bf16 v[80:83], a[40:43], v[160:163], v[80:83]
    v_mfma_f32_16x16x32_bf16 v[104:107], a[40:43], v[164:167], v[104:107]
    v_mfma_f32_16x16x32_bf16 v[84:87], a[44:47], v[160:163], v[84:87]
    v_mfma_f32_16x16x32_bf16 v[108:111], a[44:47], v[164:167], v[108:111]
    s_lshl_b32 s60, s41, 6
    s_add_u32 s60, s60, 145536
    s_lshl_b32 s62, s52, 6
    s_add_u32 s62, s62, 145408
    v_lshlrev_b32 v136, 4, v2
    v_add_u32 v137, s60, v136
    v_add_u32 v138, s62, v136
    v_add_u32 v136, 145408, v136
    s_barrier
    s_mov_b32 exec_lo, 0x00010001
    s_mov_b32 exec_hi, 0x00010001
    ds_write_b128 v137, v[112:115]
    ds_write_b128 v138, v[116:119]
    s_mov_b64 exec, -1
    s_waitcnt lgkmcnt(0)
    s_barrier
    ds_read_b128 v[232:235], v136 offset:0
    ds_read_b128 v[236:239], v136 offset:64
    ds_read_b128 v[240:243], v136 offset:128
    ds_read_b128 v[244:247], v136 offset:192
    ds_read_b128 v[248:251], v136 offset:256
    ds_read_b128 v[252:255], v136 offset:320
    v_lshrrev_b32 v139, 3, v1
    v_and_b32 v5, 7, v1
    v_lshlrev_b32 v5, 4, v5
    v_lshl_add_u32 v5, v139, 10, v5
    s_waitcnt vmcnt(4)
    s_mov_b32 s70, 30000
chk_4:
    v_xor_b32 v132, v121, v26
    v_xor_b32 v133, v123, v26
    v_xor_b32 v134, v125, v26
    v_xor_b32 v135, v127, v26
    v_or3_b32 v132, v132, v133, v134
    v_xor_b32 v133, v129, v26
    v_xor_b32 v134, v131, v26
    v_or3_b32 v132, v132, v135, v133
    v_or_b32 v132, v132, v134
    v_cmp_ne_u32 vcc, 0, v132
    s_nop 3
    s_cbranch_vccz chk_4_d
    buffer_load_dwordx4 v[120:123], v62, s[36:39], s61 offen offset:0 sc1
    buffer_load_dwordx4 v[124:127], v62, s[36:39], s61 offen offset:256 sc1
    buffer_load_dwordx4 v[128:131], v62, s[36:39], s78 offen offset:0 sc1
    s_waitcnt vmcnt(0)
    s_sub_u32 s70, s70, 1
    s_cmp_lg_u32 s70, 0
    s_cbranch_scc1 chk_4
chk_4_d:
    v_mov_b32_dpp v116, v112 row_newbcast:0 row_mask:0xf bank_mask:0xf
    s_add_u32 m0, s44, 98304
    s_add_u32 s63, s54, 0
    buffer_load_dwordx4 v7, s[12:15], s63 offen lds
    v_mov_b32_dpp v117, v113 row_newbcast:0 row_mask:0xf bank_mask:0xf
    v_mov_b32_dpp v118, v114 row_newbcast:0 row_mask:0xf bank_mask:0xf
    v_mov_b32_dpp v119, v115 row_newbcast:0 row_mask:0xf bank_mask:0xf
    v_pk_mul_f32 v[112:113], v[112:113], v[128:129] op_sel_hi:[1,0]
    v_pk_mul_f32 v[114:115], v[114:115], v[128:129] op_sel_hi:[1,0]
    v_pk_fma_f32 v[112:113], v[116:117], v[130:131], v[112:113] op_sel_hi:[1,0,1]
    v_pk_fma_f32 v[114:115], v[118:119], v[130:131], v[114:115] op_sel_hi:[1,0,1]
    v_cvt_pk_bf16_f32 v216, v112, v113
    s_add_u32 m0, s44, 102400
    s_add_u32 s63, s54, 32768
    buffer_load_dwordx4 v7, s[12:15], s63 offen lds
    v_cvt_pk_bf16_f32 v217, v114, v115
    ds_write_b64 v50, v[216:217]
    s_waitcnt lgkmcnt(1)
    v_pk_mul_f32 v[96:97], v[96:97], v[124:125] op_sel_hi:[1,0]
    v_pk_mul_f32 v[98:99], v[98:99], v[124:125] op_sel_hi:[1,0]
    v_pk_fma_f32 v[96:97], v[240:241], v[126:127], v[96:97] op_sel_hi:[1,0,1]
    v_pk_fma_f32 v[98:99], v[242:243], v[126:127], v[98:99] op_sel_hi:[1,0,1]
    v_cvt_pk_bf16_f32 v188, v96, v97
    v_cvt_pk_bf16_f32 v189, v98, v99
    ds_write_b64 v49, v[188:189] offset:1024
    v_pk_mul_f32 v[100:101], v[100:101], v[124:125] op_sel_hi:[1,0]
    s_add_u32 m0, s44, 106496
    s_add_u32 s63, s54, 65536
    buffer_load_dwordx4 v7, s[12:15], s63 offen lds
    v_pk_mul_f32 v[102:103], v[102:103], v[124:125] op_sel_hi:[1,0]
    v_pk_fma_f32 v[100:101], v[244:245], v[126:127], v[100:101] op_sel_hi:[1,0,1]
    v_pk_fma_f32 v[102:103], v[246:247], v[126:127], v[102:103] op_sel_hi:[1,0,1]
    v_cvt_pk_bf16_f32 v194, v100, v101
    v_cvt_pk_bf16_f32 v195, v102, v103
    ds_write_b64 v49, v[194:195] offset:1536
    v_pk_mul_f32 v[104:105], v[104:105], v[124:125] op_sel_hi:[1,0]
    v_pk_mul_f32 v[106:107], v[106:107], v[124:125] op_sel_hi:[1,0]
    v_pk_fma_f32 v[104:105], v[248:249], v[126:127], v[104:105] op_sel_hi:[1,0,1]
    s_add_u32 m0, s44, 110592
    s_add_u32 s63, s54, 98304
    buffer_load_dwordx4 v7, s[12:15], s63 offen lds
    v_pk_fma_f32 v[106:107], v[250:251], v[126:127], v[106:107] op_sel_hi:[1,0,1]
    v_cvt_pk_bf16_f32 v212, v104, v105
    v_cvt_pk_bf16_f32 v213, v106, v107
    ds_write_b64 v48, v[212:213] offset:2048
    v_pk_mul_f32 v[108:109], v[108:109], v[124:125] op_sel_hi:[1,0]
    v_pk_mul_f32 v[110:111], v[110:111], v[124:125] op_sel_hi:[1,0]
    v_pk_fma_f32 v[108:109], v[252:253], v[126:127], v[108:109] op_sel_hi:[1,0,1]
    v_pk_fma_f32 v[110:111], v[254:255], v[126:127], v[110:111] op_sel_hi:[1,0,1]
    v_cvt_pk_bf16_f32 v214, v108, v109
    s_add_u32 m0, s44, 114688
    s_add_u32 s63, s54, 131072
    buffer_load_dwordx4 v7, s[12:15], s63 offen lds
    v_cvt_pk_bf16_f32 v215, v110, v111
    ds_write_b64 v48, v[214:215] offset:2080
    v_pk_mul_f32 v[80:81], v[80:81], v[120:121] op_sel_hi:[1,0]
    v_pk_mul_f32 v[82:83], v[82:83], v[120:121] op_sel_hi:[1,0]
    v_pk_fma_f32 v[80:81], v[248:249], v[122:123], v[80:81] op_sel_hi:[1,0,1]
    v_pk_fma_f32 v[82:83], v[250:251], v[122:123], v[82:83] op_sel_hi:[1,0,1]
    v_cvt_pk_bf16_f32 v208, v80, v81
    v_cvt_pk_bf16_f32 v209, v82, v83
    ds_write_b64 v48, v[208:209] offset:1024
    v_pk_mul_f32 v[84:85], v[84:85], v[120:121] op_sel_hi:[1,0]
    s_add_u32 m0, s44, 118784
    s_add_u32 s63, s54, 163840
    buffer_load_dwordx4 v7, s[12:15], s63 offen lds
    v_pk_mul_f32 v[86:87], v[86:87], v[120:121] op_sel_hi:[1,0]
    v_pk_fma_f32 v[84:85], v[252:253], v[122:123], v[84:85] op_sel_hi:[1,0,1]
    v_pk_fma_f32 v[86:87], v[254:255], v[122:123], v[86:87] op_sel_hi:[1,0,1]
    v_cvt_pk_bf16_f32 v210, v84, v85
    v_cvt_pk_bf16_f32 v211, v86, v87
    ds_write_b64 v48, v[210:211] offset:1056
    v_pk_mul_f32 v[72:73], v[72:73], v[120:121] op_sel_hi:[1,0]
    v_pk_mul_f32 v[74:75], v[74:75], v[120:121] op_sel_hi:[1,0]
    v_pk_fma_f32 v[72:73], v[240:241], v[122:123], v[72:73] op_sel_hi:[1,0,1]
    s_add_u32 m0, s44, 122880
    s_add_u32 s63, s54, 196608
    buffer_load_dwordx4 v7, s[12:15], s63 offen lds
    v_pk_fma_f32 v[74:75], v[242:243], v[122:123], v[74:75] op_sel_hi:[1,0,1]
    v_cvt_pk_bf16_f32 v186, v72, v73
    v_cvt_pk_bf16_f32 v187, v74, v75
    v_pk_mul_f32 v[76:77], v[76:77], v[120:121] op_sel_hi:[1,0]
    v_pk_mul_f32 v[78:79], v[78:79], v[120:121] op_sel_hi:[1,0]
    v_pk_fma_f32 v[76:77], v[244:245], v[122:123], v[76:77] op_sel_hi:[1,0,1]
    v_pk_fma_f32 v[78:79], v[246:247], v[122:123], v[78:79] op_sel_hi:[1,0,1]
    v_cvt_pk_bf16_f32 v192, v76, v77
    s_add_u32 m0, s44, 126976
    s_add_u32 s63, s54, 229376
    buffer_load_dwordx4 v7, s[12:15], s63 offen lds
    v_cvt_pk_bf16_f32 v193, v78, v79
    s_waitcnt lgkmcnt(0)
    s_barrier
    ds_read_b64 v[184:185], v49 offset:0
    ds_read_b64 v[190:191], v49 offset:512
    ds_read_b64_tr_b16 v[196:197], v51 offset:0
    ds_read_b64_tr_b16 v[198:199], v51 offset:1024
    ds_read_b64_tr_b16 v[200:201], v51 offset:2048
    ds_read_b64_tr_b16 v[202:203], v51 offset:32
    ds_read_b64_tr_b16 v[204:205], v51 offset:1056
    ds_read_b64_tr_b16 v[206:207], v51 offset:2080
    v_pk_mul_f32 v[88:89], v[88:89], v[124:125] op_sel_hi:[1,0]
    v_pk_mul_f32 v[90:91], v[90:91], v[124:125] op_sel_hi:[1,0]
    v_pk_fma_f32 v[88:89], v[232:233], v[126:127], v[88:89] op_sel_hi:[1,0,1]
    v_pk_fma_f32 v[90:91], v[234:235], v[126:127], v[90:91] op_sel_hi:[1,0,1]
    v_cvt_pk_bf16_f32 v180, v88, v89
    v_cvt_pk_bf16_f32 v181, v90, v91
    v_pk_mul_f32 v[92:93], v[92:93], v[124:125] op_sel_hi:[1,0]
    s_lshl_b32 s3, s47, 2
    s_add_u32 s3, s3, s41
    s_lshl_b32 s3, s3, 14
    s_add_u32 s3, s3, s54
    s_add_u32 s3, s3, 0
    s_lshl_b32 s63, s41, 11
    s_add_u32 m0, s63, 147456
    s_nop 0
    buffer_load_dwordx4 v5, s[4:7], s3 offen lds
    v_pk_mul_f32 v[94:95], v[94:95], v[124:125] op_sel_hi:[1,0]
    v_pk_fma_f32 v[92:93], v[236:237], v[126:127], v[92:93] op_sel_hi:[1,0,1]
    v_pk_fma_f32 v[94:95], v[238:239], v[126:127], v[94:95] op_sel_hi:[1,0,1]
    v_cvt_pk_bf16_f32 v182, v92, v93
    v_cvt_pk_bf16_f32 v183, v94, v95
    v_pk_mul_f32 v[64:65], v[64:65], v[120:121] op_sel_hi:[1,0]
    v_pk_mul_f32 v[66:67], v[66:67], v[120:121] op_sel_hi:[1,0]
    v_pk_fma_f32 v[64:65], v[232:233], v[122:123], v[64:65] op_sel_hi:[1,0,1]
    s_lshl_b32 s3, s47, 2
    s_add_u32 s3, s3, s41
    s_lshl_b32 s3, s3, 14
    s_add_u32 s3, s3, s54
    s_add_u32 s3, s3, 8192
    s_lshl_b32 s63, s41, 11
    s_add_u32 m0, s63, 148480
    s_nop 0
    buffer_load_dwordx4 v5, s[4:7], s3 offen lds
    v_pk_fma_f32 v[66:67], v[234:235], v[122:123], v[66:67] op_sel_hi:[1,0,1]
    v_cvt_pk_bf16_f32 v176, v64, v65
    v_cvt_pk_bf16_f32 v177, v66, v67
    v_pk_mul_f32 v[68:69], v[68:69], v[120:121] op_sel_hi:[1,0]
    v_pk_mul_f32 v[70:71], v[70:71], v[120:121] op_sel_hi:[1,0]
    v_pk_fma_f32 v[68:69], v[236:237], v[122:123], v[68:69] op_sel_hi:[1,0,1]
    v_pk_fma_f32 v[70:71], v[238:239], v[122:123], v[70:71] op_sel_hi:[1,0,1]
    v_cvt_pk_bf16_f32 v178, v68, v69
    s_add_u32 m0, s44, 0
    s_add_u32 s63, s54, 393216
    buffer_load_dwordx4 v7, s[12:15], s63 offen lds
    v_cvt_pk_bf16_f32 v179, v70, v71
    v_mfma_f32_16x16x16_bf16 v[80:83], v[188:189], v[180:181], 0
    v_mfma_f32_16x16x16_bf16 v[64:67], v[186:187], v[180:181], 0
    v_mfma_f32_16x16x16_bf16 v[84:87], v[194:195], v[182:183], 0
    v_mfma_f32_16x16x16_bf16 v[68:71], v[192:193], v[182:183], 0
    s_waitcnt lgkmcnt(6)
    v_mfma_f32_16x16x16_bf16 v[88:91], v[186:187], v[176:177], 0
    v_mfma_f32_16x16x16_bf16 v[72:75], v[184:185], v[176:177], v[44:47]
    v_mfma_f32_16x16x16_bf16 v[92:95], v[192:193], v[178:179], 0
    v_mfma_f32_16x16x16_bf16 v[76:79], v[190:191], v[178:179], v[44:47]
    v_cndmask_b32 v80, v80, v81, s[64:65]
    v_cndmask_b32 v64, v64, v65, s[64:65]
    v_cndmask_b32 v82, v82, v83, s[64:65]
    v_cndmask_b32 v66, v66, v67, s[64:65]
    v_cndmask_b32 v96, v64, v80, s[66:67]
    v_cndmask_b32 v97, v66, v82, s[68:69]
    v_max_f32 v104, v96, v97
    s_add_u32 m0, s44, 4096
    s_add_u32 s63, s54, 425984
    buffer_load_dwordx4 v7, s[12:15], s63 offen lds
    v_cndmask_b32 v84, v84, v85, s[64:65]
    v_cndmask_b32 v68, v68, v69, s[64:65]
    v_cndmask_b32 v86, v86, v87, s[64:65]
    v_cndmask_b32 v70, v70, v71, s[64:65]
    v_cndmask_b32 v98, v68, v84, s[66:67]
    v_cndmask_b32 v99, v70, v86, s[68:69]
    v_max_f32 v106, v98, v99
    v_cndmask_b32 v88, v88, v89, s[64:65]
    s_add_u32 m0, s44, 8192
    s_add_u32 s63, s54, 458752
    buffer_load_dwordx4 v7, s[12:15], s63 offen lds
    v_cndmask_b32 v72, v72, v73, s[64:65]
    v_cndmask_b32 v90, v90, v91, s[64:65]
    v_cndmask_b32 v74, v74, v75, s[64:65]
    v_cndmask_b32 v100, v72, v88, s[66:67]
    v_cndmask_b32 v101, v74, v90, s[68:69]
    v_max_f32 v108, v100, v101
    v_cndmask_b32 v92, v92, v93, s[64:65]
    v_cndmask_b32 v76, v76, v77, s[64:65]
    s_add_u32 m0, s44, 12288
    s_add_u32 s63, s54, 491520
    buffer_load_dwordx4 v7, s[12:15], s63 offen lds
    v_cndmask_b32 v94, v94, v95, s[64:65]
    v_cndmask_b32 v78, v78, v79, s[64:65]
    v_cndmask_b32 v102, v76, v92, s[66:67]
    v_cndmask_b32 v103, v78, v94, s[68:69]
    v_max_f32 v110, v102, v103
    v_permlane32_swap_b32 v104, v106
    s_nop 0
    v_permlane32_swap_b32 v108, v110
    v_max_f32 v104, v104, v106
    v_max_f32 v108, v108, v110
    s_nop 1
    v_permlane16_swap_b32 v104, v108
    v_max_f32 v104, v104, v108
    s_mov_b32 s58, 0x3eb8aa3b
    v_mul_f32 v104, 0xbeb8aa3b, v104
    v_mov_b32 v108, v104
    s_nop 1
    v_permlane16_swap_b32 v104, v108
    v_mov_b32 v106, v104
    v_mov_b32 v110, v108
    s_nop 0
    v_permlane32_swap_b32 v104, v106
    v_permlane32_swap_b32 v108, v110
    v_pk_fma_f32 v[96:97], v[96:97], s[58:59], v[104:105] op_sel_hi:[1,0,0]
    v_pk_fma_f32 v[98:99], v[98:99], s[58:59], v[106:107] op_sel_hi:[1,0,0]
    v_pk_fma_f32 v[100:101], v[100:101], s[58:59], v[108:109] op_sel_hi:[1,0,0]
    v_pk_fma_f32 v[102:103], v[102:103], s[58:59], v[110:111] op_sel_hi:[1,0,0]
    v_exp_f32 v96, v96
    v_exp_f32 v97, v97
    v_exp_f32 v98, v98
    v_exp_f32 v99, v99
    v_exp_f32 v100, v100
    v_exp_f32 v101, v101
    v_exp_f32 v102, v102
    v_exp_f32 v103, v103
    v_cvt_pk_bf16_f32 v96, v96, v97
    v_cvt_pk_bf16_f32 v98, v98, v99
    v_cvt_pk_bf16_f32 v100, v100, v101
    v_cvt_pk_bf16_f32 v102, v102, v103
    s_waitcnt lgkmcnt(0)
    v_perm_b32 v64, v96, v96, v40
    v_perm_b32 v65, v96, v96, v41
    v_perm_b32 v66, v96, v96, v42
    v_perm_b32 v67, v96, v96, v43
    v_perm_b32 v68, v98, v98, v40
    v_perm_b32 v69, v98, v98, v41
    v_perm_b32 v70, v98, v98, v42
    v_perm_b32 v71, v98, v98, v43
    v_mfma_f32_16x16x32_bf16 v[136:139], v[28:31], v[64:67], 0
    v_mfma_f32_16x16x32_bf16 v[80:83], v[198:201], v[64:67], 0
    v_perm_b32 v72, v100, v100, v40
    v_perm_b32 v73, v100, v100, v41
    v_perm_b32 v74, v100, v100, v42
    v_perm_b32 v75, v100, v100, v43
    v_mfma_f32_16x16x32_bf16 v[140:143], v[28:31], v[68:71], 0
    v_mfma_f32_16x16x32_bf16 v[84:87], v[204:207], v[68:71], 0
    v_perm_b32 v76, v102, v102, v40
    v_perm_b32 v77, v102, v102, v41
    v_perm_b32 v78, v102, v102, v42
    v_perm_b32 v79, v102, v102, v43
    v_mfma_f32_16x16x32_bf16 v[144:147], v[28:31], v[72:75], 0
    v_mfma_f32_16x16x32_bf16 v[88:91], v[196:199], v[72:75], 0
    s_add_u32 s60, s77, 2097152
    s_add_u32 s61, s60, 16384
    v_mfma_f32_16x16x32_bf16 v[148:151], v[28:31], v[76:79], 0
    v_mfma_f32_16x16x32_bf16 v[92:95], v[202:205], v[76:79], 0
    v_rcp_f32 v136, v136
    s_nop 0
    v_pk_mul_f32 v[80:81], v[80:81], v[136:137] op_sel_hi:[1,0]
    v_pk_mul_f32 v[82:83], v[82:83], v[136:137] op_sel_hi:[1,0]
    v_cvt_pk_bf16_f32 v100, v80, v81
    v_cvt_pk_bf16_f32 v101, v82, v83
    v_rcp_f32 v140, v140
    s_nop 0
    v_pk_mul_f32 v[84:85], v[84:85], v[140:141] op_sel_hi:[1,0]
    v_pk_mul_f32 v[86:87], v[86:87], v[140:141] op_sel_hi:[1,0]
    v_cvt_pk_bf16_f32 v102, v84, v85
    v_cvt_pk_bf16_f32 v103, v86, v87
    buffer_store_dwordx4 v[100:103], v4, s[36:39], s61 offen sc1
    v_rcp_f32 v144, v144
    s_nop 0
    v_pk_mul_f32 v[88:89], v[88:89], v[144:145] op_sel_hi:[1,0]
    v_pk_mul_f32 v[90:91], v[90:91], v[144:145] op_sel_hi:[1,0]
    v_cvt_pk_bf16_f32 v96, v88, v89
    v_cvt_pk_bf16_f32 v97, v90, v91
    v_rcp_f32 v148, v148
    s_nop 0
    v_pk_mul_f32 v[92:93], v[92:93], v[148:149] op_sel_hi:[1,0]
    v_pk_mul_f32 v[94:95], v[94:95], v[148:149] op_sel_hi:[1,0]
    v_cvt_pk_bf16_f32 v98, v92, v93
    v_cvt_pk_bf16_f32 v99, v94, v95
    buffer_store_dwordx4 v[96:99], v4, s[36:39], s60 offen sc1
    s_add_u32 m0, s44, 16384
    s_add_u32 s63, s55, 2064384
    buffer_load_dwordx4 v8, s[16:19], s63 offen lds
    s_add_u32 m0, s44, 20480
    s_add_u32 s63, s55, 5734400
    buffer_load_dwordx4 v8, s[16:19], s63 offen lds
    s_add_u32 m0, s44, 24576
    s_add_u32 s63, s55, 2179072
    buffer_load_dwordx4 v8, s[16:19], s63 offen lds
    s_add_u32 m0, s44, 28672
    s_add_u32 s63, s55, 5849088
    buffer_load_dwordx4 v8, s[16:19], s63 offen lds
    s_add_u32 m0, s44, 32768
    s_add_u32 s63, s55, 2293760
    buffer_load_dwordx4 v8, s[16:19], s63 offen lds
    s_waitcnt vmcnt(5)
    s_waitcnt lgkmcnt(0)
    s_barrier
    s_cmp_lg_u32 s41, 0
    s_cbranch_scc1 pub_5
    s_lshl_b32 s60, s45, 4
    s_add_u32 s60, s60, s46
    s_mul_i32 s60, s60, 128
    s_add_u32 s60, s60, 65536
    v_lshlrev_b32 v62, 2, v1
    s_mov_b32 exec_hi, 0
    s_mov_b32 exec_lo, 0x00000001
    s_cmp_lg_u32 s100, 0
    s_cbranch_scc1 hs_f_6
    buffer_store_dword v26, v62, s[36:39], s60 offen sc1
    s_branch hs_j_7
hs_f_6:
    buffer_store_dword v26, v62, s[36:39], s60 offen
hs_j_7:
    s_mov_b64 exec, -1
pub_5:
    s_add_u32 m0, s44, 131072
    s_add_u32 s63, s54, 262144
    buffer_load_dwordx4 v7, s[12:15], s63 offen lds
    s_add_u32 m0, s44, 135168
    s_add_u32 s63, s54, 294912
    buffer_load_dwordx4 v7, s[12:15], s63 offen lds
    s_add_u32 m0, s44, 139264
    s_add_u32 s63, s54, 327680
    buffer_load_dwordx4 v7, s[12:15], s63 offen lds
    s_add_u32 m0, s44, 143360
    s_add_u32 s63, s54, 360448
    buffer_load_dwordx4 v7, s[12:15], s63 offen lds
    s_add_u32 m0, s44, 36864
    s_add_u32 s63, s55, 5963776
    buffer_load_dwordx4 v8, s[16:19], s63 offen lds
    s_add_u32 m0, s44, 40960
    s_add_u32 s63, s55, 2408448
    buffer_load_dwordx4 v8, s[16:19], s63 offen lds
    v_lshrrev_b32 v22, 2, v1
    v_lshrrev_b32 v23, 3, v1
    v_and_b32 v23, 3, v23
    v_lshlrev_b32 v22, 7, v22
    v_lshl_add_u32 v22, v23, 5, v22
    v_and_b32 v23, 3, v1
    v_lshl_add_u32 v22, v23, 3, v22
    v_xor_b32 v10, 0, v22
    v_add_u32 v14, 98304, v10
    v_xor_b32 v11, 32, v22
    v_add_u32 v15, 98304, v11
    v_xor_b32 v12, 64, v22
    v_add_u32 v16, 98304, v12
    v_xor_b32 v13, 96, v22
    v_add_u32 v17, 98304, v13
    s_lshl_b32 s61, s41, 11
    s_add_u32 s61, s61, 147456
    v_lshlrev_b32 v23, 7, v3
    v_lshl_add_u32 v23, v2, 3, v23
    v_add_u32 v23, s61, v23
    ds_read_b64 v[32:33], v23 offset:0
    ds_read_b64 v[34:35], v23 offset:32
    ds_read_b64 v[36:37], v23 offset:64
    ds_read_b64 v[38:39], v23 offset:96
    ds_read_b64_tr_b16 a[0:1], v14 offset:0
    ds_read_b64_tr_b16 a[2:3], v14 offset:2048
    ds_read_b64_tr_b16 a[4:5], v15 offset:0
    ds_read_b64_tr_b16 a[6:7], v15 offset:2048
    ds_read_b64_tr_b16 a[8:9], v16 offset:0
    ds_read_b64_tr_b16 a[10:11], v16 offset:2048
    ds_read_b64_tr_b16 a[12:13], v17 offset:0
    ds_read_b64_tr_b16 a[14:15], v17 offset:2048
    ds_read_b64_tr_b16 a[16:17], v14 offset:4096
    ds_read_b64_tr_b16 a[18:19], v14 offset:6144
    ds_read_b64_tr_b16 a[20:21], v15 offset:4096
    ds_read_b64_tr_b16 a[22:23], v15 offset:6144
    ds_read_b64_tr_b16 a[24:25], v16 offset:4096
    ds_read_b64_tr_b16 a[26:27], v16 offset:6144
    ds_read_b64_tr_b16 a[28:29], v17 offset:4096
    ds_read_b64_tr_b16 a[30:31], v17 offset:6144
    ds_read_b64_tr_b16 a[32:33], v14 offset:8192
    ds_read_b64_tr_b16 a[34:35], v14 offset:10240
    ds_read_b64_tr_b16 a[36:37], v15 offset:8192
    ds_read_b64_tr_b16 a[38:39], v15 offset:10240
    ds_read_b64_tr_b16 a[40:41], v16 offset:8192
    ds_read_b64_tr_b16 a[42:43], v16 offset:10240
    ds_read_b64_tr_b16 a[44:45], v17 offset:8192
    ds_read_b64_tr_b16 a[46:47], v17 offset:10240
    ds_read_b64_tr_b16 a[48:49], v14 offset:12288
    ds_read_b64_tr_b16 a[50:51], v14 offset:14336
    ds_read_b64_tr_b16 a[52:53], v15 offset:12288
    ds_read_b64_tr_b16 a[54:55], v15 offset:14336
    ds_read_b64_tr_b16 a[56:57], v16 offset:12288
    ds_read_b64_tr_b16 a[58:59], v16 offset:14336
    ds_read_b64_tr_b16 a[60:61], v17 offset:12288
    ds_read_b64_tr_b16 a[62:63], v17 offset:14336
    ds_read_b64_tr_b16 a[64:65], v14 offset:16384
    ds_read_b64_tr_b16 a[66:67], v14 offset:18432
    ds_read_b64_tr_b16 a[68:69], v15 offset:16384
    ds_read_b64_tr_b16 a[70:71], v15 offset:18432
    ds_read_b64_tr_b16 a[72:73], v16 offset:16384
    ds_read_b64_tr_b16 a[74:75], v16 offset:18432
    ds_read_b64_tr_b16 a[76:77], v17 offset:16384
    ds_read_b64_tr_b16 a[78:79], v17 offset:18432
    ds_read_b64_tr_b16 a[80:81], v14 offset:20480
    ds_read_b64_tr_b16 a[82:83], v14 offset:22528
    ds_read_b64_tr_b16 a[84:85], v15 offset:20480
    ds_read_b64_tr_b16 a[86:87], v15 offset:22528
    ds_read_b64_tr_b16 a[88:89], v16 offset:20480
    ds_read_b64_tr_b16 a[90:91], v16 offset:22528
    ds_read_b64_tr_b16 a[92:93], v17 offset:20480
    ds_read_b64_tr_b16 a[94:95], v17 offset:22528
    ds_read_b64_tr_b16 a[96:97], v14 offset:24576
    ds_read_b64_tr_b16 a[98:99], v14 offset:26624
    ds_read_b64_tr_b16 a[100:101], v15 offset:24576
    ds_read_b64_tr_b16 a[102:103], v15 offset:26624
    ds_read_b64_tr_b16 a[104:105], v16 offset:24576
    ds_read_b64_tr_b16 a[106:107], v16 offset:26624
    ds_read_b64_tr_b16 a[108:109], v17 offset:24576
    ds_read_b64_tr_b16 a[110:111], v17 offset:26624
    ds_read_b64_tr_b16 a[112:113], v14 offset:28672
    ds_read_b64_tr_b16 a[114:115], v14 offset:30720
    ds_read_b64_tr_b16 a[116:117], v15 offset:28672
    ds_read_b64_tr_b16 a[118:119], v15 offset:30720
    ds_read_b64_tr_b16 a[120:121], v16 offset:28672
    ds_read_b64_tr_b16 a[122:123], v16 offset:30720
    ds_read_b64_tr_b16 a[124:125], v17 offset:28672
    ds_read_b64_tr_b16 a[126:127], v17 offset:30720
    ds_read_b64_tr_b16 a[192:193], v10 offset:0
    ds_read_b64_tr_b16 a[194:195], v10 offset:2048
    ds_read_b64_tr_b16 a[196:197], v11 offset:0
    ds_read_b64_tr_b16 a[198:199], v11 offset:2048
    ds_read_b64_tr_b16 a[200:201], v12 offset:0
    ds_read_b64_tr_b16 a[202:203], v12 offset:2048
    ds_read_b64_tr_b16 a[204:205], v13 offset:0
    ds_read_b64_tr_b16 a[206:207], v13 offset:2048
    ds_read_b64_tr_b16 a[208:209], v10 offset:4096
    ds_read_b64_tr_b16 a[210:211], v10 offset:6144
    ds_read_b64_tr_b16 a[212:213], v11 offset:4096
    ds_read_b64_tr_b16 a[214:215], v11 offset:6144
    ds_read_b64_tr_b16 a[216:217], v12 offset:4096
    ds_read_b64_tr_b16 a[218:219], v12 offset:6144
    ds_read_b64_tr_b16 a[220:221], v13 offset:4096
    ds_read_b64_tr_b16 a[222:223], v13 offset:6144
    ds_read_b64_tr_b16 a[224:225], v10 offset:8192
    ds_read_b64_tr_b16 a[226:227], v10 offset:10240
    ds_read_b64_tr_b16 a[228:229], v11 offset:8192
    ds_read_b64_tr_b16 a[230:231], v11 offset:10240
    ds_read_b64_tr_b16 a[232:233], v12 offset:8192
    ds_read_b64_tr_b16 a[234:235], v12 offset:10240
    ds_read_b64_tr_b16 a[236:237], v13 offset:8192
    ds_read_b64_tr_b16 a[238:239], v13 offset:10240
    ds_read_b64_tr_b16 a[240:241], v10 offset:12288
    ds_read_b64_tr_b16 a[242:243], v10 offset:14336
    ds_read_b64_tr_b16 a[244:245], v11 offset:12288
    ds_read_b64_tr_b16 a[246:247], v11 offset:14336
    ds_read_b64_tr_b16 a[248:249], v12 offset:12288
    ds_read_b64_tr_b16 a[250:251], v12 offset:14336
    ds_read_b64_tr_b16 a[252:253], v13 offset:12288
    ds_read_b64_tr_b16 a[254:255], v13 offset:14336
    s_waitcnt lgkmcnt(15)
    v_lshlrev_b32 v64, 16, v32
    v_and_b32 v65, 0xffff0000, v32
    v_lshlrev_b32 v66, 16, v33
    v_and_b32 v67, 0xffff0000, v33
    v_lshlrev_b32 v68, 16, v34
    v_and_b32 v69, 0xffff0000, v34
    v_lshlrev_b32 v70, 16, v35
    v_and_b32 v71, 0xffff0000, v35
    v_lshlrev_b32 v72, 16, v36
    v_and_b32 v73, 0xffff0000, v36
    v_lshlrev_b32 v74, 16, v37
    v_and_b32 v75, 0xffff0000, v37
    v_lshlrev_b32 v76, 16, v38
    v_and_b32 v77, 0xffff0000, v38
    v_lshlrev_b32 v78, 16, v39
    v_and_b32 v79, 0xffff0000, v39
    s_lshl_b32 s72, s47, 2
    s_add_u32 s72, s72, s41
    s_lshl_b32 s73, s72, 11
    s_add_u32 s73, s73, 1048576
    s_lshl_b32 s74, s72, 10
    s_lshl_b32 s72, s72, 14
    s_add_u32 s72, s72, 2097152
    s_cmp_lg_u32 s41, 0
    s_cbranch_scc1 poll_8_d
    s_lshr_b32 s60, s47, 1
    s_lshl_b32 s60, s60, 4
    s_mul_i32 s60, s60, 128
    s_add_u32 s60, s60, 65536
    v_min_u32 v62, 15, v1
    v_mul_u32_u24 v62, 128, v62
    s_mov_b32 s70, 30000
poll_8:
    buffer_load_dword v63, v62, s[36:39], s60 offen sc1
    s_waitcnt vmcnt(0)
    v_cmp_ne_u32 vcc, v63, v26
    s_nop 3
    s_cbranch_vccz poll_8_d
    s_sub_u32 s70, s70, 1
    s_cmp_lg_u32 s70, 0
    s_cbranch_scc1 poll_8
poll_8_d:
    s_waitcnt vmcnt(0) lgkmcnt(0)
    s_barrier
    buffer_load_dwordx4 v[128:131], v4, s[36:39], s72 offen offset:0 sc1
    buffer_load_dwordx4 v[132:135], v4, s[36:39], s72 offen offset:1024 sc1
    ds_read_b64_tr_b16 a[128:129], v14 offset:32768
    ds_read_b64_tr_b16 a[130:131], v14 offset:34816
    ds_read_b64_tr_b16 a[132:133], v15 offset:32768
    ds_read_b64_tr_b16 a[134:135], v15 offset:34816
    ds_read_b64_tr_b16 a[136:137], v16 offset:32768
    ds_read_b64_tr_b16 a[138:139], v16 offset:34816
    ds_read_b64_tr_b16 a[140:141], v17 offset:32768
    ds_read_b64_tr_b16 a[142:143], v17 offset:34816
    buffer_load_dwordx4 v[136:139], v4, s[36:39], s72 offen offset:2048 sc1
    buffer_load_dwordx4 v[140:143], v4, s[36:39], s72 offen offset:3072 sc1
    ds_read_b64_tr_b16 a[144:145], v14 offset:36864
    ds_read_b64_tr_b16 a[146:147], v14 offset:38912
    ds_read_b64_tr_b16 a[148:149], v15 offset:36864
    ds_read_b64_tr_b16 a[150:151], v15 offset:38912
    ds_read_b64_tr_b16 a[152:153], v16 offset:36864
    ds_read_b64_tr_b16 a[154:155], v16 offset:38912
    ds_read_b64_tr_b16 a[156:157], v17 offset:36864
    ds_read_b64_tr_b16 a[158:159], v17 offset:38912
    s_add_u32 s72, s72, 4096
    buffer_load_dwordx4 v[144:147], v4, s[36:39], s72 offen offset:0 sc1
    buffer_load_dwordx4 v[148:151], v4, s[36:39], s72 offen offset:1024 sc1
    ds_read_b64_tr_b16 a[160:161], v14 offset:40960
    ds_read_b64_tr_b16 a[162:163], v14 offset:43008
    ds_read_b64_tr_b16 a[164:165], v15 offset:40960
    ds_read_b64_tr_b16 a[166:167], v15 offset:43008
    ds_read_b64_tr_b16 a[168:169], v16 offset:40960
    ds_read_b64_tr_b16 a[170:171], v16 offset:43008
    ds_read_b64_tr_b16 a[172:173], v17 offset:40960
    ds_read_b64_tr_b16 a[174:175], v17 offset:43008
    buffer_load_dwordx4 v[152:155], v4, s[36:39], s72 offen offset:2048 sc1
    buffer_load_dwordx4 v[156:159], v4, s[36:39], s72 offen offset:3072 sc1
    ds_read_b64_tr_b16 a[176:177], v14 offset:45056
    ds_read_b64_tr_b16 a[178:179], v14 offset:47104
    ds_read_b64_tr_b16 a[180:181], v15 offset:45056
    ds_read_b64_tr_b16 a[182:183], v15 offset:47104
    ds_read_b64_tr_b16 a[184:185], v16 offset:45056
    ds_read_b64_tr_b16 a[186:187], v16 offset:47104
    ds_read_b64_tr_b16 a[188:189], v17 offset:45056
    ds_read_b64_tr_b16 a[190:191], v17 offset:47104
    s_add_u32 s72, s72, 4096
    buffer_load_dwordx4 v[160:163], v4, s[36:39], s72 offen offset:0 sc1
    buffer_load_dwordx4 v[164:167], v4, s[36:39], s72 offen offset:1024 sc1
    buffer_load_dwordx4 v[168:171], v4, s[36:39], s72 offen offset:2048 sc1
    buffer_load_dwordx4 v[172:175], v4, s[36:39], s72 offen offset:3072 sc1
    s_add_u32 s72, s72, 4096
    buffer_load_dwordx4 v[176:179], v4, s[36:39], s72 offen offset:0 sc1
    buffer_load_dwordx4 v[180:183], v4, s[36:39], s72 offen offset:1024 sc1
    buffer_load_dwordx4 v[184:187], v4, s[36:39], s72 offen offset:2048 sc1
    buffer_load_dwordx4 v[188:191], v4, s[36:39], s72 offen offset:3072 sc1
    s_lshl_b32 s61, s48, 8
    s_add_u32 s61, s61, s73
    v_lshrrev_b32 v62, 1, v2
    v_lshlrev_b32 v62, 3, v62
    v_lshl_add_u32 v62, v3, 4, v62
    s_mul_i32 s60, s41, 2304
    s_add_u32 s60, s60, 147456
    v_mul_u32_u24 v23, 144, v3
    v_lshl_add_u32 v23, v2, 3, v23
    v_add_u32 v23, s60, v23
    s_mul_i32 s60, s41, 2176
    s_add_u32 s60, s60, 131072
    v_mul_u32_u24 v25, 136, v3
    v_lshl_add_u32 v25, v2, 3, v25
    v_add_u32 v25, s60, v25
    v_lshrrev_b32 v22, 5, v1
    v_lshlrev_b32 v22, 2, v22
    v_lshrrev_b32 v24, 2, v1
    v_and_b32 v24, 3, v24
    v_add_u32 v22, v22, v24
    v_mul_u32_u24 v22, 136, v22
    v_and_b32 v24, 1, v2
    v_lshl_add_u32 v22, v24, 5, v22
    v_and_b32 v24, 1, v1
    v_lshl_add_u32 v22, v24, 4, v22
    v_and_b32 v24, 2, v1
    v_lshl_add_u32 v22, v24, 2, v22
    v_add_u32 v22, s60, v22
    s_mul_i32 s62, s51, 4608
    s_lshl_b32 s60, s52, 6
    s_add_u32 s62, s62, s60
    s_add_u32 s62, s62, 147456
    v_and_b32 v24, 31, v1
    v_mul_u32_u24 v24, 144, v24
    v_lshrrev_b32 v63, 5, v1
    v_lshl_add_u32 v24, v63, 4, v24
    v_add_u32 v24, s62, v24
    s_mul_i32 s62, s48, 262144
    s_add_u32 s62, s62, s74
    s_lshr_b32 s74, s74, 16
    s_mul_i32 s74, s74, 0
    s_add_u32 s62, s62, s74
    s_add_u32 s62, s62, 6291456
    s_add_u32 s74, s62, 131072
    s_waitcnt vmcnt(15)
    v_mfma_f32_16x16x32_bf16 v[64:67], a[0:3], v[128:131], v[64:67]
    v_mfma_f32_16x16x32_bf16 v[68:71], a[4:7], v[128:131], v[68:71]
    v_mfma_f32_16x16x32_bf16 v[72:75], a[8:11], v[128:131], v[72:75]
    v_mfma_f32_16x16x32_bf16 v[76:79], a[12:15], v[128:131], v[76:79]
    s_waitcnt vmcnt(14)
    v_mfma_f32_16x16x32_bf16 v[64:67], a[16:19], v[132:135], v[64:67]
    v_mfma_f32_16x16x32_bf16 v[68:71], a[20:23], v[132:135], v[68:71]
    v_mfma_f32_16x16x32_bf16 v[72:75], a[24:27], v[132:135], v[72:75]
    v_mfma_f32_16x16x32_bf16 v[76:79], a[28:31], v[132:135], v[76:79]
    s_waitcnt vmcnt(13)
    v_mfma_f32_16x16x32_bf16 v[64:67], a[32:35], v[136:139], v[64:67]
    v_mfma_f32_16x16x32_bf16 v[68:71], a[36:39], v[136:139], v[68:71]
    s_add_u32 m0, s44, 45056
    s_add_u32 s63, s55, 6078464
    buffer_load_dwordx4 v8, s[16:19], s63 offen lds
    v_mfma_f32_16x16x32_bf16 v[72:75], a[40:43], v[136:139], v[72:75]
    v_mfma_f32_16x16x32_bf16 v[76:79], a[44:47], v[136:139], v[76:79]
    s_waitcnt vmcnt(13)
    v_mfma_f32_16x16x32_bf16 v[64:67], a[48:51], v[140:143], v[64:67]
    v_mfma_f32_16x16x32_bf16 v[68:71], a[52:55], v[140:143], v[68:71]
    s_add_u32 m0, s44, 49152
    s_add_u32 s63, s55, 2523136
    buffer_load_dwordx4 v8, s[16:19], s63 offen lds
    v_mfma_f32_16x16x32_bf16 v[72:75], a[56:59], v[140:143], v[72:75]
    v_mfma_f32_16x16x32_bf16 v[76:79], a[60:63], v[140:143], v[76:79]
    s_waitcnt vmcnt(13)
    v_mfma_f32_16x16x32_bf16 v[64:67], a[64:67], v[144:147], v[64:67]
    v_mfma_f32_16x16x32_bf16 v[68:71], a[68:71], v[144:147], v[68:71]
    s_add_u32 m0, s44, 53248
    s_add_u32 s63, s55, 6193152
    buffer_load_dwordx4 v8, s[16:19], s63 offen lds
    v_mfma_f32_16x16x32_bf16 v[72:75], a[72:75], v[144:147], v[72:75]
    v_mfma_f32_16x16x32_bf16 v[76:79], a[76:79], v[144:147], v[76:79]
    s_waitcnt vmcnt(13)
    v_mfma_f32_16x16x32_bf16 v[64:67], a[80:83], v[148:151], v[64:67]
    v_mfma_f32_16x16x32_bf16 v[68:71], a[84:87], v[148:151], v[68:71]
    s_add_u32 m0, s44, 57344
    s_add_u32 s63, s55, 2637824
    buffer_load_dwordx4 v8, s[16:19], s63 offen lds
    v_mfma_f32_16x16x32_bf16 v[72:75], a[88:91], v[148:151], v[72:75]
    v_mfma_f32_16x16x32_bf16 v[76:79], a[92:95], v[148:151], v[76:79]
    s_waitcnt vmcnt(13)
    v_mfma_f32_16x16x32_bf16 v[64:67], a[96:99], v[152:155], v[64:67]
    v_mfma_f32_16x16x32_bf16 v[68:71], a[100:103], v[152:155], v[68:71]
    s_add_u32 m0, s44, 61440
    s_add_u32 s63, s55, 6307840
    buffer_load_dwordx4 v8, s[16:19], s63 offen lds
    v_mfma_f32_16x16x32_bf16 v[72:75], a[104:107], v[152:155], v[72:75]
    v_mfma_f32_16x16x32_bf16 v[76:79], a[108:111], v[152:155], v[76:79]
    s_waitcnt vmcnt(13)
    v_mfma_f32_16x16x32_bf16 v[64:67], a[112:115], v[156:159], v[64:67]
    v_mfma_f32_16x16x32_bf16 v[68:71], a[116:119], v[156:159], v[68:71]
    s_add_u32 m0, s44, 65536
    s_add_u32 s63, s55, 2752512
    buffer_load_dwordx4 v8, s[16:19], s63 offen lds
    v_mfma_f32_16x16x32_bf16 v[72:75], a[120:123], v[156:159], v[72:75]
    v_mfma_f32_16x16x32_bf16 v[76:79], a[124:127], v[156:159], v[76:79]
    s_waitcnt vmcnt(13) lgkmcnt(15)
    v_mfma_f32_16x16x32_bf16 v[64:67], a[128:131], v[160:163], v[64:67]
    v_mfma_f32_16x16x32_bf16 v[68:71], a[132:135], v[160:163], v[68:71]
    s_add_u32 m0, s44, 69632
    s_add_u32 s63, s55, 6422528
    buffer_load_dwordx4 v8, s[16:19], s63 offen lds
    v_mfma_f32_16x16x32_bf16 v[72:75], a[136:139], v[160:163], v[72:75]
    v_mfma_f32_16x16x32_bf16 v[76:79], a[140:143], v[160:163], v[76:79]
    s_waitcnt vmcnt(13) lgkmcnt(15)
    v_mfma_f32_16x16x32_bf16 v[64:67], a[144:147], v[164:167], v[64:67]
    v_mfma_f32_16x16x32_bf16 v[68:71], a[148:151], v[164:167], v[68:71]
    s_add_u32 m0, s44, 73728
    s_add_u32 s63, s55, 2867200
    buffer_load_dwordx4 v8, s[16:19], s63 offen lds
    v_mfma_f32_16x16x32_bf16 v[72:75], a[152:155], v[164:167], v[72:75]
    v_mfma_f32_16x16x32_bf16 v[76:79], a[156:159], v[164:167], v[76:79]
    s_waitcnt vmcnt(13) lgkmcnt(8)
    v_mfma_f32_16x16x32_bf16 v[64:67], a[160:163], v[168:171], v[64:67]
    v_mfma_f32_16x16x32_bf16 v[68:71], a[164:167], v[168:171], v[68:71]
    s_add_u32 m0, s44, 77824
    s_add_u32 s63, s55, 6537216
    buffer_load_dwordx4 v8, s[16:19], s63 offen lds
    v_mfma_f32_16x16x32_bf16 v[72:75], a[168:171], v[168:171], v[72:75]
    v_mfma_f32_16x16x32_bf16 v[76:79], a[172:175], v[168:171], v[76:79]
    s_waitcnt vmcnt(13) lgkmcnt(0)
    v_mfma_f32_16x16x32_bf16 v[64:67], a[176:179], v[172:175], v[64:67]
    v_mfma_f32_16x16x32_bf16 v[68:71], a[180:183], v[172:175], v[68:71]
    s_add_u32 m0, s44, 81920
    s_add_u32 s63, s55, 2981888
    buffer_load_dwordx4 v8, s[16:19], s63 offen lds
    v_mfma_f32_16x16x32_bf16 v[72:75], a[184:187], v[172:175], v[72:75]
    v_mfma_f32_16x16x32_bf16 v[76:79], a[188:191], v[172:175], v[76:79]
    s_waitcnt vmcnt(13)
    v_mfma_f32_16x16x32_bf16 v[64:67], a[192:195], v[176:179], v[64:67]
    v_mfma_f32_16x16x32_bf16 v[68:71], a[196:199], v[176:179], v[68:71]
    s_add_u32 m0, s44, 86016
    s_add_u32 s63, s55, 6651904
    buffer_load_dwordx4 v8, s[16:19], s63 offen lds
    v_mfma_f32_16x16x32_bf16 v[72:75], a[200:203], v[176:179], v[72:75]
    v_mfma_f32_16x16x32_bf16 v[76:79], a[204:207], v[176:179], v[76:79]
    s_waitcnt vmcnt(13)
    v_mfma_f32_16x16x32_bf16 v[64:67], a[208:211], v[180:183], v[64:67]
    v_mfma_f32_16x16x32_bf16 v[68:71], a[212:215], v[180:183], v[68:71]
    s_add_u32 m0, s44, 90112
    s_add_u32 s63, s55, 3096576
    buffer_load_dwordx4 v8, s[16:19], s63 offen lds
    v_mfma_f32_16x16x32_bf16 v[72:75], a[216:219], v[180:183], v[72:75]
    v_mfma_f32_16x16x32_bf16 v[76:79], a[220:223], v[180:183], v[76:79]
    s_waitcnt vmcnt(13)
    v_mfma_f32_16x16x32_bf16 v[64:67], a[224:227], v[184:187], v[64:67]
    v_mfma_f32_16x16x32_bf16 v[68:71], a[228:231], v[184:187], v[68:71]
    s_add_u32 m0, s44, 94208
    s_add_u32 s63, s55, 6766592
    buffer_load_dwordx4 v8, s[16:19], s63 offen lds
    v_mfma_f32_16x16x32_bf16 v[72:75], a[232:235], v[184:187], v[72:75]
    v_mfma_f32_16x16x32_bf16 v[76:79], a[236:239], v[184:187], v[76:79]
    s_waitcnt vmcnt(13)
    v_mfma_f32_16x16x32_bf16 v[64:67], a[240:243], v[188:191], v[64:67]
    v_mfma_f32_16x16x32_bf16 v[68:71], a[244:247], v[188:191], v[68:71]
    s_add_u32 m0, s44, 98304
    s_add_u32 s63, s55, 3211264
    buffer_load_dwordx4 v8, s[16:19], s63 offen lds
    v_mfma_f32_16x16x32_bf16 v[72:75], a[248:251], v[188:191], v[72:75]
    v_mfma_f32_16x16x32_bf16 v[76:79], a[252:255], v[188:191], v[76:79]
    s_add_u32 m0, s44, 102400
    s_add_u32 s63, s55, 6881280
    buffer_load_dwordx4 v8, s[16:19], s63 offen lds
    s_add_u32 m0, s44, 106496
    s_add_u32 s63, s55, 3325952
    buffer_load_dwordx4 v8, s[16:19], s63 offen lds
    s_add_u32 m0, s44, 110592
    s_add_u32 s63, s55, 6995968
    buffer_load_dwordx4 v8, s[16:19], s63 offen lds
    s_add_u32 m0, s44, 114688
    s_add_u32 s63, s55, 3440640
    buffer_load_dwordx4 v8, s[16:19], s63 offen lds
    s_add_u32 m0, s44, 118784
    s_add_u32 s63, s55, 7110656
    buffer_load_dwordx4 v8, s[16:19], s63 offen lds
    s_add_u32 m0, s44, 122880
    s_add_u32 s63, s55, 3555328
    buffer_load_dwordx4 v8, s[16:19], s63 offen lds
    s_add_u32 m0, s44, 126976
    s_add_u32 s63, s55, 7225344
    buffer_load_dwordx4 v8, s[16:19], s63 offen lds
    v_cvt_pk_bf16_f32 v100, v64, v65
    v_cvt_pk_bf16_f32 v101, v66, v67
    v_cvt_pk_bf16_f32 v102, v68, v69
    v_cvt_pk_bf16_f32 v103, v70, v71
    v_cvt_pk_bf16_f32 v104, v72, v73
    v_cvt_pk_bf16_f32 v105, v74, v75
    v_cvt_pk_bf16_f32 v106, v76, v77
    v_cvt_pk_bf16_f32 v107, v78, v79
    v_lshlrev_b32 v64, 16, v100
    v_and_b32 v65, 0xffff0000, v100
    v_lshlrev_b32 v66, 16, v101
    v_and_b32 v67, 0xffff0000, v101
    v_lshlrev_b32 v68, 16, v102
    v_and_b32 v69, 0xffff0000, v102
    v_lshlrev_b32 v70, 16, v103
    v_and_b32 v71, 0xffff0000, v103
    v_lshlrev_b32 v72, 16, v104
    v_and_b32 v73, 0xffff0000, v104
    v_lshlrev_b32 v74, 16, v105
    v_and_b32 v75, 0xffff0000, v105
    v_lshlrev_b32 v76, 16, v106
    v_and_b32 v77, 0xffff0000, v106
    v_lshlrev_b32 v78, 16, v107
    v_and_b32 v79, 0xffff0000, v107
    v_pk_add_f32 v[96:97], v[64:65], v[66:67]
    v_pk_mul_f32 v[98:99], v[64:65], v[64:65]
    v_pk_fma_f32 v[98:99], v[66:67], v[66:67], v[98:99]
    v_pk_fma_f32 v[98:99], v[68:69], v[68:69], v[98:99]
    v_pk_add_f32 v[96:97], v[96:97], v[68:69]
    v_pk_fma_f32 v[98:99], v[70:71], v[70:71], v[98:99]
    v_pk_add_f32 v[96:97], v[96:97], v[70:71]
    v_pk_fma_f32 v[98:99], v[72:73], v[72:73], v[98:99]
    v_pk_add_f32 v[96:97], v[96:97], v[72:73]
    v_pk_fma_f32 v[98:99], v[74:75], v[74:75], v[98:99]
    v_pk_add_f32 v[96:97], v[96:97], v[74:75]
    v_pk_fma_f32 v[98:99], v[76:77], v[76:77], v[98:99]
    v_pk_add_f32 v[96:97], v[96:97], v[76:77]
    v_pk_fma_f32 v[98:99], v[78:79], v[78:79], v[98:99]
    v_pk_add_f32 v[96:97], v[96:97], v[78:79]
    v_add_f32 v96, v96, v97
    v_add_f32 v98, v98, v99
    s_nop 1
    v_permlane32_swap_b32 v96, v98
    v_add_f32 v96, v96, v98
    v_mov_b32 v98, v96
    v_mov_b32 v97, v26
    s_nop 0
    v_permlane16_swap_b32 v96, v98
    v_add_f32 v96, v96, v98
    s_cmp_lg_u32 s100, 0
    s_cbranch_scc1 hs_f_9
    buffer_store_dwordx2 v[96:97], v62, s[36:39], s61 offen sc1
    s_branch hs_j_10
hs_f_9:
    buffer_store_dwordx2 v[96:97], v62, s[36:39], s61 offen
hs_j_10:
    ds_write_b64 v23, v[100:101] offset:0
    ds_write_b64 v23, v[102:103] offset:32
    ds_write_b64 v23, v[104:105] offset:64
    ds_write_b64 v23, v[106:107] offset:96
    s_waitcnt vmcnt(1) lgkmcnt(0)
    s_barrier
    ds_read_b128 v[32:35], v24 offset:0
    ds_read_b128 v[36:39], v24 offset:32
    ds_read_b64_tr_b16 a[48:49], v56 offset:16384
    ds_read_b64_tr_b16 a[50:51], v56 offset:17408
    ds_read_b64_tr_b16 a[52:53], v57 offset:16384
    ds_read_b64_tr_b16 a[54:55], v57 offset:17408
    ds_read_b64_tr_b16 a[56:57], v56 offset:18432
    ds_read_b64_tr_b16 a[58:59], v56 offset:19456
    ds_read_b64_tr_b16 a[60:61], v57 offset:18432
    ds_read_b64_tr_b16 a[62:63], v57 offset:19456
    buffer_load_dwordx4 v[108:111], v4, s[36:39], s73 offen sc1
    buffer_load_dwordx4 v[112:115], v4, s[36:39], s73 offen offset:1024 sc1
    ds_read_b64_tr_b16 a[64:65], v56 offset:24576
    ds_read_b64_tr_b16 a[66:67], v56 offset:25600
    ds_read_b64_tr_b16 a[68:69], v57 offset:24576
    ds_read_b64_tr_b16 a[70:71], v57 offset:25600
    ds_read_b64_tr_b16 a[72:73], v56 offset:26624
    ds_read_b64_tr_b16 a[74:75], v56 offset:27648
    ds_read_b64_tr_b16 a[76:77], v57 offset:26624
    ds_read_b64_tr_b16 a[78:79], v57 offset:27648
    ds_read_b64_tr_b16 a[80:81], v56 offset:32768
    ds_read_b64_tr_b16 a[82:83], v56 offset:33792
    ds_read_b64_tr_b16 a[84:85], v57 offset:32768
    ds_read_b64_tr_b16 a[86:87], v57 offset:33792
    ds_read_b64_tr_b16 a[88:89], v56 offset:34816
    ds_read_b64_tr_b16 a[90:91], v56 offset:35840
    ds_read_b64_tr_b16 a[92:93], v57 offset:34816
    ds_read_b64_tr_b16 a[94:95], v57 offset:35840
    ds_read_b64_tr_b16 a[96:97], v56 offset:40960
    ds_read_b64_tr_b16 a[98:99], v56 offset:41984
    ds_read_b64_tr_b16 a[100:101], v57 offset:40960
    ds_read_b64_tr_b16 a[102:103], v57 offset:41984
    ds_read_b64_tr_b16 a[104:105], v56 offset:43008
    ds_read_b64_tr_b16 a[106:107], v56 offset:44032
    ds_read_b64_tr_b16 a[108:109], v57 offset:43008
    ds_read_b64_tr_b16 a[110:111], v57 offset:44032
    ds_read_b64_tr_b16 a[112:113], v58 offset:0
    ds_read_b64_tr_b16 a[114:115], v58 offset:1024
    ds_read_b64_tr_b16 a[116:117], v59 offset:0
    ds_read_b64_tr_b16 a[118:119], v59 offset:1024
    ds_read_b64_tr_b16 a[120:121], v58 offset:2048
    ds_read_b64_tr_b16 a[122:123], v58 offset:3072
    ds_read_b64_tr_b16 a[124:125], v59 offset:2048
    ds_read_b64_tr_b16 a[126:127], v59 offset:3072
    s_waitcnt vmcnt(0)
    s_mov_b32 s70, 30000
chk_11:
    v_xor_b32 v109, v109, v26
    v_xor_b32 v111, v111, v26
    v_xor_b32 v113, v113, v26
    v_xor_b32 v115, v115, v26
    v_or_b32 v109, v109, v111
    v_or3_b32 v109, v109, v113, v115
    v_cmp_ne_u32 vcc, 0, v109
    s_nop 3
    s_cbranch_vccz chk_11_d
    buffer_load_dwordx4 v[108:111], v4, s[36:39], s73 offen sc1
    buffer_load_dwordx4 v[112:115], v4, s[36:39], s73 offen offset:1024 sc1
    s_waitcnt vmcnt(0)
    s_sub_u32 s70, s70, 1
    s_cmp_lg_u32 s70, 0
    s_cbranch_scc1 chk_11
chk_11_d:
    v_add_f32 v96, v108, v112
    v_add_f32 v98, v110, v114
    s_nop 1
    v_permlane32_swap_b32 v96, v98
    v_add_f32 v96, v96, v98
    v_mov_b32 v98, v96
    s_nop 1
    v_permlane16_swap_b32 v96, v98
    v_add_f32 v96, v96, v98
    v_mul_f32 v96, 0x3b000000, v96
    v_mov_b32 v98, v96
    s_nop 1
    v_permlane32_swap_b32 v96, v98
    v_fma_f32 v98, -v96, v96, v98
    v_max_f32 v98, 0, v98
    v_mov_b32 v99, 0x2edbe6ff
    v_fmac_f32 v99, 0x3f800054, v98
    v_rsq_f32 v97, v99
    s_nop 0
    v_mul_f32 v99, v96, v97
    v_pk_fma_f32 v[64:65], v[64:65], v[96:97], v[98:99] op_sel:[0,1,1] op_sel_hi:[1,1,1] neg_lo:[0,0,1] neg_hi:[0,0,1]
    v_pk_fma_f32 v[66:67], v[66:67], v[96:97], v[98:99] op_sel:[0,1,1] op_sel_hi:[1,1,1] neg_lo:[0,0,1] neg_hi:[0,0,1]
    v_cvt_pk_bf16_f32 v100, v64, v65
    v_cvt_pk_bf16_f32 v101, v66, v67
    ds_write_b64 v25, v[100:101] offset:0
    v_pk_fma_f32 v[68:69], v[68:69], v[96:97], v[98:99] op_sel:[0,1,1] op_sel_hi:[1,1,1] neg_lo:[0,0,1] neg_hi:[0,0,1]
    v_pk_fma_f32 v[70:71], v[70:71], v[96:97], v[98:99] op_sel:[0,1,1] op_sel_hi:[1,1,1] neg_lo:[0,0,1] neg_hi:[0,0,1]
    v_cvt_pk_bf16_f32 v102, v68, v69
    v_cvt_pk_bf16_f32 v103, v70, v71
    ds_write_b64 v25, v[102:103] offset:32
    ds_read_b64_tr_b16 v[80:81], v22 offset:0
    ds_read_b64_tr_b16 v[82:83], v22 offset:1088
    v_pk_fma_f32 v[72:73], v[72:73], v[96:97], v[98:99] op_sel:[0,1,1] op_sel_hi:[1,1,1] neg_lo:[0,0,1] neg_hi:[0,0,1]
    v_pk_fma_f32 v[74:75], v[74:75], v[96:97], v[98:99] op_sel:[0,1,1] op_sel_hi:[1,1,1] neg_lo:[0,0,1] neg_hi:[0,0,1]
    v_cvt_pk_bf16_f32 v104, v72, v73
    v_cvt_pk_bf16_f32 v105, v74, v75
    ds_write_b64 v25, v[104:105] offset:64
    v_pk_fma_f32 v[76:77], v[76:77], v[96:97], v[98:99] op_sel:[0,1,1] op_sel_hi:[1,1,1] neg_lo:[0,0,1] neg_hi:[0,0,1]
    v_pk_fma_f32 v[78:79], v[78:79], v[96:97], v[98:99] op_sel:[0,1,1] op_sel_hi:[1,1,1] neg_lo:[0,0,1] neg_hi:[0,0,1]
    v_cvt_pk_bf16_f32 v106, v76, v77
    v_cvt_pk_bf16_f32 v107, v78, v79
    ds_write_b64 v25, v[106:107] offset:96
    ds_read_b64_tr_b16 v[84:85], v22 offset:64
    ds_read_b64_tr_b16 v[86:87], v22 offset:1152
    s_waitcnt lgkmcnt(4)
    buffer_store_dwordx4 v[80:83], v4, s[36:39], s62 offen sc1
    s_waitcnt lgkmcnt(0)
    buffer_store_dwordx4 v[84:87], v4, s[36:39], s74 offen sc1
    s_add_u32 m0, s44, 0
    s_add_u32 s63, s55, 229376
    buffer_load_dwordx4 v8, s[16:19], s63 offen lds
    ds_read_b64_tr_b16 a[128:129], v58 offset:8192
    ds_read_b64_tr_b16 a[130:131], v58 offset:9216
    ds_read_b64_tr_b16 a[132:133], v59 offset:8192
    ds_read_b64_tr_b16 a[134:135], v59 offset:9216
    ds_read_b64_tr_b16 a[136:137], v58 offset:10240
    ds_read_b64_tr_b16 a[138:139], v58 offset:11264
    ds_read_b64_tr_b16 a[140:141], v59 offset:10240
    ds_read_b64_tr_b16 a[142:143], v59 offset:11264
    ds_read_b64_tr_b16 a[144:145], v58 offset:16384
    ds_read_b64_tr_b16 a[146:147], v58 offset:17408
    ds_read_b64_tr_b16 a[148:149], v59 offset:16384
    ds_read_b64_tr_b16 a[150:151], v59 offset:17408
    s_add_u32 m0, s44, 4096
    s_add_u32 s63, s55, 3899392
    buffer_load_dwordx4 v8, s[16:19], s63 offen lds
    ds_read_b64_tr_b16 a[152:153], v58 offset:18432
    ds_read_b64_tr_b16 a[154:155], v58 offset:19456
    ds_read_b64_tr_b16 a[156:157], v59 offset:18432
    ds_read_b64_tr_b16 a[158:159], v59 offset:19456
    ds_read_b64_tr_b16 a[160:161], v58 offset:24576
    ds_read_b64_tr_b16 a[162:163], v58 offset:25600
    ds_read_b64_tr_b16 a[164:165], v59 offset:24576
    ds_read_b64_tr_b16 a[166:167], v59 offset:25600
    ds_read_b64_tr_b16 a[168:169], v58 offset:26624
    ds_read_b64_tr_b16 a[170:171], v58 offset:27648
    ds_read_b64_tr_b16 a[172:173], v59 offset:26624
    ds_read_b64_tr_b16 a[174:175], v59 offset:27648
    s_add_u32 m0, s44, 8192
    s_add_u32 s63, s55, 344064
    buffer_load_dwordx4 v8, s[16:19], s63 offen lds
    ds_read_b64_tr_b16 a[176:177], v58 offset:32768
    ds_read_b64_tr_b16 a[178:179], v58 offset:33792
    ds_read_b64_tr_b16 a[180:181], v59 offset:32768
    ds_read_b64_tr_b16 a[182:183], v59 offset:33792
    ds_read_b64_tr_b16 a[184:185], v58 offset:34816
    ds_read_b64_tr_b16 a[186:187], v58 offset:35840
    ds_read_b64_tr_b16 a[188:189], v59 offset:34816
    ds_read_b64_tr_b16 a[190:191], v59 offset:35840
    ds_read_b64_tr_b16 a[192:193], v58 offset:40960
    ds_read_b64_tr_b16 a[194:195], v58 offset:41984
    ds_read_b64_tr_b16 a[196:197], v59 offset:40960
    ds_read_b64_tr_b16 a[198:199], v59 offset:41984
    s_add_u32 m0, s44, 12288
    s_add_u32 s63, s55, 4014080
    buffer_load_dwordx4 v8, s[16:19], s63 offen lds
    ds_read_b64_tr_b16 a[200:201], v58 offset:43008
    ds_read_b64_tr_b16 a[202:203], v58 offset:44032
    ds_read_b64_tr_b16 a[204:205], v59 offset:43008
    ds_read_b64_tr_b16 a[206:207], v59 offset:44032
    ds_read_b64_tr_b16 a[208:209], v60 offset:0
    ds_read_b64_tr_b16 a[210:211], v60 offset:1024
    ds_read_b64_tr_b16 a[212:213], v61 offset:0
    ds_read_b64_tr_b16 a[214:215], v61 offset:1024
    ds_read_b64_tr_b16 a[216:217], v60 offset:2048
    ds_read_b64_tr_b16 a[218:219], v60 offset:3072
    ds_read_b64_tr_b16 a[220:221], v61 offset:2048
    ds_read_b64_tr_b16 a[222:223], v61 offset:3072
    ds_read_b64_tr_b16 a[224:225], v60 offset:8192
    ds_read_b64_tr_b16 a[226:227], v60 offset:9216
    ds_read_b64_tr_b16 a[228:229], v61 offset:8192
    ds_read_b64_tr_b16 a[230:231], v61 offset:9216
    ds_read_b64_tr_b16 a[232:233], v60 offset:10240
    ds_read_b64_tr_b16 a[234:235], v60 offset:11264
    ds_read_b64_tr_b16 a[236:237], v61 offset:10240
    ds_read_b64_tr_b16 a[238:239], v61 offset:11264
    ds_read_b64_tr_b16 a[240:241], v60 offset:16384
    ds_read_b64_tr_b16 a[242:243], v60 offset:17408
    ds_read_b64_tr_b16 a[244:245], v61 offset:16384
    ds_read_b64_tr_b16 a[246:247], v61 offset:17408
    ds_read_b64_tr_b16 a[248:249], v60 offset:18432
    ds_read_b64_tr_b16 a[250:251], v60 offset:19456
    ds_read_b64_tr_b16 a[252:253], v61 offset:18432
    ds_read_b64_tr_b16 a[254:255], v61 offset:19456
    ds_read_b64_tr_b16 a[0:1], v60 offset:24576
    ds_read_b64_tr_b16 a[2:3], v60 offset:25600
    ds_read_b64_tr_b16 a[4:5], v61 offset:24576
    ds_read_b64_tr_b16 a[6:7], v61 offset:25600
    ds_read_b64_tr_b16 a[8:9], v60 offset:26624
    ds_read_b64_tr_b16 a[10:11], v60 offset:27648
    ds_read_b64_tr_b16 a[12:13], v61 offset:26624
    ds_read_b64_tr_b16 a[14:15], v61 offset:27648
    s_waitcnt vmcnt(4)
    s_waitcnt lgkmcnt(0)
    s_barrier
    s_cmp_lg_u32 s41, 0
    s_cbranch_scc1 pub_12
    s_lshl_b32 s60, s48, 5
    s_add_u32 s60, s60, s47
    s_mul_i32 s60, s60, 128
    s_add_u32 s60, s60, 131072
    v_lshlrev_b32 v62, 2, v1
    s_mov_b32 exec_hi, 0
    s_mov_b32 exec_lo, 0x00000001
    buffer_store_dword v26, v62, s[36:39], s60 offen sc1
    s_mov_b64 exec, -1
pub_12:
    s_cmp_ge_u32 s43, 28
    s_cbranch_scc1 p3skip_13
    s_lshl_b32 s60, s51, 6
    s_add_u32 s60, s60, s55
    v_lshrrev_b32 v22, 5, v1
    v_lshlrev_b32 v22, 3, v22
    buffer_load_dwordx2 v[48:49], v22, s[24:27], s60 offen offset:0
    buffer_load_dwordx2 v[50:51], v22, s[24:27], s60 offen offset:16
    buffer_load_dwordx2 v[52:53], v22, s[24:27], s60 offen offset:32
    buffer_load_dwordx2 v[54:55], v22, s[24:27], s60 offen offset:48
    s_lshl_b32 s72, s49, 1
    s_add_u32 s72, s72, s52
    s_mul_i32 s72, s72, 131072
    s_mul_i32 s3, s51, 65536
    s_add_u32 s72, s72, s3
    s_add_u32 s72, s72, 6291456
    s_add_u32 m0, s44, 131072
    s_add_u32 s63, s55, 0
    buffer_load_dwordx4 v8, s[16:19], s63 offen lds
    s_add_u32 m0, s44, 135168
    s_add_u32 s63, s55, 3670016
    buffer_load_dwordx4 v8, s[16:19], s63 offen lds
    s_add_u32 m0, s44, 139264
    s_add_u32 s63, s55, 114688
    buffer_load_dwordx4 v8, s[16:19], s63 offen lds
    s_add_u32 m0, s44, 143360
    s_add_u32 s63, s55, 3784704
    buffer_load_dwordx4 v8, s[16:19], s63 offen lds
    s_add_u32 m0, s44, 16384
    s_add_u32 s63, s55, 458752
    buffer_load_dwordx4 v8, s[16:19], s63 offen lds
    s_add_u32 m0, s44, 20480
    s_add_u32 s63, s55, 4128768
    buffer_load_dwordx4 v8, s[16:19], s63 offen lds
    s_add_u32 m0, s44, 24576
    s_add_u32 s63, s55, 573440
    buffer_load_dwordx4 v8, s[16:19], s63 offen lds
    s_add_u32 m0, s44, 28672
    s_add_u32 s63, s55, 4243456
    buffer_load_dwordx4 v8, s[16:19], s63 offen lds
    s_add_u32 m0, s44, 32768
    s_add_u32 s63, s55, 688128
    buffer_load_dwordx4 v8, s[16:19], s63 offen lds
    s_add_u32 m0, s44, 36864
    s_add_u32 s63, s55, 4358144
    buffer_load_dwordx4 v8, s[16:19], s63 offen lds
    s_add_u32 m0, s44, 40960
    s_add_u32 s63, s55, 802816
    buffer_load_dwordx4 v8, s[16:19], s63 offen lds
    s_add_u32 m0, s44, 45056
    s_add_u32 s63, s55, 4472832
    buffer_load_dwordx4 v8, s[16:19], s63 offen lds
    s_add_u32 m0, s44, 49152
    s_add_u32 s63, s55, 917504
    buffer_load_dwordx4 v8, s[16:19], s63 offen lds
    s_add_u32 m0, s44, 53248
    s_add_u32 s63, s55, 4587520
    buffer_load_dwordx4 v8, s[16:19], s63 offen lds
    s_add_u32 m0, s44, 57344
    s_add_u32 s63, s55, 1032192
    buffer_load_dwordx4 v8, s[16:19], s63 offen lds
    s_add_u32 m0, s44, 61440
    s_add_u32 s63, s55, 4702208
    buffer_load_dwordx4 v8, s[16:19], s63 offen lds
    s_add_u32 m0, s44, 65536
    s_add_u32 s63, s55, 1146880
    buffer_load_dwordx4 v8, s[16:19], s63 offen lds
    s_add_u32 m0, s44, 69632
    s_add_u32 s63, s55, 4816896
    buffer_load_dwordx4 v8, s[16:19], s63 offen lds
    s_lshl_b32 s74, s49, 1
    s_add_u32 s74, s74, s51
    s_lshl_b32 s74, s74, 4
    s_mul_i32 s74, s74, 128
    s_add_u32 s74, s74, 131072
    v_min_u32 v23, 15, v3
    v_mul_u32_u24 v62, 128, v23
    buffer_load_dword v63, v62, s[36:39], s74 offen sc1
    s_add_u32 m0, s44, 73728
    s_add_u32 s63, s55, 1261568
    buffer_load_dwordx4 v8, s[16:19], s63 offen lds
    s_add_u32 m0, s44, 77824
    s_add_u32 s63, s55, 4931584
    buffer_load_dwordx4 v8, s[16:19], s63 offen lds
    s_add_u32 m0, s44, 81920
    s_add_u32 s63, s55, 1376256
    buffer_load_dwordx4 v8, s[16:19], s63 offen lds
    s_add_u32 m0, s44, 86016
    s_add_u32 s63, s55, 5046272
    buffer_load_dwordx4 v8, s[16:19], s63 offen lds
    s_add_u32 m0, s44, 90112
    s_add_u32 s63, s55, 1490944
    buffer_load_dwordx4 v8, s[16:19], s63 offen lds
    s_add_u32 m0, s44, 94208
    s_add_u32 s63, s55, 5160960
    buffer_load_dwordx4 v8, s[16:19], s63 offen lds
    s_add_u32 m0, s44, 98304
    s_add_u32 s63, s55, 1605632
    buffer_load_dwordx4 v8, s[16:19], s63 offen lds
    s_add_u32 m0, s44, 102400
    s_add_u32 s63, s55, 5275648
    buffer_load_dwordx4 v8, s[16:19], s63 offen lds
    s_add_u32 m0, s44, 106496
    s_add_u32 s63, s55, 1720320
    buffer_load_dwordx4 v8, s[16:19], s63 offen lds
    s_add_u32 m0, s44, 110592
    s_add_u32 s63, s55, 5390336
    buffer_load_dwordx4 v8, s[16:19], s63 offen lds
    s_add_u32 m0, s44, 114688
    s_add_u32 s63, s55, 1835008
    buffer_load_dwordx4 v8, s[16:19], s63 offen lds
    s_add_u32 m0, s44, 118784
    s_add_u32 s63, s55, 5505024
    buffer_load_dwordx4 v8, s[16:19], s63 offen lds
    s_add_u32 m0, s44, 122880
    s_add_u32 s63, s55, 1949696
    buffer_load_dwordx4 v8, s[16:19], s63 offen lds
    s_add_u32 m0, s44, 126976
    s_add_u32 s63, s55, 5619712
    buffer_load_dwordx4 v8, s[16:19], s63 offen lds
    s_waitcnt vmcnt(14)
    s_mov_b32 s70, 30000
chk_15:
    v_cmp_ne_u32 vcc, v63, v26
    s_nop 3
    s_and_b64 vcc, vcc, 0x0000ffff
    s_cbranch_scc0 chk_15_d
    buffer_load_dword v63, v62, s[36:39], s74 offen sc1
    s_waitcnt vmcnt(0)
    s_sub_u32 s70, s70, 1
    s_cmp_lg_u32 s70, 0
    s_cbranch_scc1 chk_15
chk_15_d:
    s_add_u32 s82, s72, 57344
    buffer_load_dwordx4 v[128:131], v4, s[36:39], s82 offen offset:0 sc1
    buffer_load_dwordx4 v[132:135], v4, s[36:39], s82 offen offset:1024 sc1
    buffer_load_dwordx4 v[136:139], v4, s[36:39], s82 offen offset:2048 sc1
    buffer_load_dwordx4 v[140:143], v4, s[36:39], s82 offen offset:3072 sc1
    s_add_u32 s82, s72, 61440
    buffer_load_dwordx4 v[144:147], v4, s[36:39], s82 offen offset:0 sc1
    buffer_load_dwordx4 v[148:151], v4, s[36:39], s82 offen offset:1024 sc1
    buffer_load_dwordx4 v[152:155], v4, s[36:39], s82 offen offset:2048 sc1
    buffer_load_dwordx4 v[156:159], v4, s[36:39], s82 offen offset:3072 sc1
    s_add_u32 s82, s72, 0
    buffer_load_dwordx4 v[160:163], v4, s[36:39], s82 offen offset:0 sc1
    buffer_load_dwordx4 v[164:167], v4, s[36:39], s82 offen offset:1024 sc1
    buffer_load_dwordx4 v[168:171], v4, s[36:39], s82 offen offset:2048 sc1
    buffer_load_dwordx4 v[172:175], v4, s[36:39], s82 offen offset:3072 sc1
    s_add_u32 s82, s72, 4096
    buffer_load_dwordx4 v[176:179], v4, s[36:39], s82 offen offset:0 sc1
    buffer_load_dwordx4 v[180:183], v4, s[36:39], s82 offen offset:1024 sc1
    v_lshlrev_b32 v64, 16, v48
    v_and_b32 v65, 0xffff0000, v48
    v_lshlrev_b32 v66, 16, v49
    v_and_b32 v67, 0xffff0000, v49
    v_lshlrev_b32 v68, 16, v50
    v_and_b32 v69, 0xffff0000, v50
    v_lshlrev_b32 v70, 16, v51
    v_and_b32 v71, 0xffff0000, v51
    v_lshlrev_b32 v72, 16, v52
    v_and_b32 v73, 0xffff0000, v52
    v_lshlrev_b32 v74, 16, v53
    v_and_b32 v75, 0xffff0000, v53
    v_lshlrev_b32 v76, 16, v54
    v_and_b32 v77, 0xffff0000, v54
    v_lshlrev_b32 v78, 16, v55
    v_and_b32 v79, 0xffff0000, v55
    v_mov_b32 v48, 0xbdd2d3e8
    v_mov_b32 v50, 0xc0135761
    s_lshl_b32 s60, s49, 1
    s_add_u32 s60, s60, s52
    s_mul_i32 s60, s60, 56
    s_lshl_b32 s61, s50, 1
    s_add_u32 s60, s60, s61
    s_add_u32 s60, s60, s51
    s_lshl_b32 s60, s60, 11
    s_add_u32 s60, s60, 10485760
    s_lshl_b32 s62, s41, 12
    s_add_u32 s62, s62, 147456
    v_add_u32 v22, s62, v4
    v_xor_b32 v23, 8192, v22
    s_waitcnt vmcnt(13)
    v_mfma_f32_32x32x16_bf16 v[64:79], a[208:211], v[128:131], v[64:79]
    buffer_load_dwordx4 v[184:187], v4, s[36:39], s82 offen offset:2048 sc1
    v_mfma_f32_32x32x16_bf16 v[80:95], a[212:215], v[128:131], 0
    s_waitcnt vmcnt(13)
    v_mfma_f32_32x32x16_bf16 v[64:79], a[216:219], v[132:135], v[64:79]
    buffer_load_dwordx4 v[188:191], v4, s[36:39], s82 offen offset:3072 sc1
    v_mfma_f32_32x32x16_bf16 v[80:95], a[220:223], v[132:135], v[80:95]
    s_waitcnt vmcnt(13)
    v_mfma_f32_32x32x16_bf16 v[64:79], a[224:227], v[136:139], v[64:79]
    s_add_u32 s82, s72, 8192
    buffer_load_dwordx4 v[192:195], v4, s[36:39], s82 offen offset:0 sc1
    v_mfma_f32_32x32x16_bf16 v[80:95], a[228:231], v[136:139], v[80:95]
    s_waitcnt vmcnt(13)
    v_mfma_f32_32x32x16_bf16 v[64:79], a[232:235], v[140:143], v[64:79]
    buffer_load_dwordx4 v[196:199], v4, s[36:39], s82 offen offset:1024 sc1
    v_mfma_f32_32x32x16_bf16 v[80:95], a[236:239], v[140:143], v[80:95]
    s_waitcnt vmcnt(13)
    v_mfma_f32_32x32x16_bf16 v[64:79], a[240:243], v[144:147], v[64:79]
    buffer_load_dwordx4 v[200:203], v4, s[36:39], s82 offen offset:2048 sc1
    v_mfma_f32_32x32x16_bf16 v[80:95], a[244:247], v[144:147], v[80:95]
    s_waitcnt vmcnt(13)
    v_mfma_f32_32x32x16_bf16 v[64:79], a[248:251], v[148:151], v[64:79]
    s_barrier
    ds_read_b64_tr_b16 v[96:97], v60 offset:32768
    ds_read_b64_tr_b16 v[98:99], v60 offset:33792
    buffer_load_dwordx4 v[204:207], v4, s[36:39], s82 offen offset:3072 sc1
    v_mfma_f32_32x32x16_bf16 v[80:95], a[252:255], v[148:151], v[80:95]
    ds_read_b64_tr_b16 v[100:101], v61 offset:32768
    ds_read_b64_tr_b16 v[102:103], v61 offset:33792
    s_waitcnt vmcnt(13)
    v_mfma_f32_32x32x16_bf16 v[64:79], a[0:3], v[152:155], v[64:79]
    ds_read_b64_tr_b16 v[104:105], v60 offset:34816
    ds_read_b64_tr_b16 v[106:107], v60 offset:35840
    s_add_u32 s82, s72, 12288
    buffer_load_dwordx4 v[208:211], v4, s[36:39], s82 offen offset:0 sc1
    v_mfma_f32_32x32x16_bf16 v[80:95], a[4:7], v[152:155], v[80:95]
    ds_read_b64_tr_b16 v[108:109], v61 offset:34816
    ds_read_b64_tr_b16 v[110:111], v61 offset:35840
    s_waitcnt vmcnt(13)
    v_mfma_f32_32x32x16_bf16 v[64:79], a[8:11], v[156:159], v[64:79]
    ds_read_b64_tr_b16 v[112:113], v60 offset:40960
    ds_read_b64_tr_b16 v[114:115], v60 offset:41984
    buffer_load_dwordx4 v[212:215], v4, s[36:39], s82 offen offset:1024 sc1
    v_mfma_f32_32x32x16_bf16 v[80:95], a[12:15], v[156:159], v[80:95]
    ds_read_b64_tr_b16 v[116:117], v61 offset:40960
    ds_read_b64_tr_b16 v[118:119], v61 offset:41984
    s_waitcnt vmcnt(13) lgkmcnt(10)
    v_mfma_f32_32x32x16_bf16 v[64:79], v[96:99], v[160:163], v[64:79]
    ds_read_b64_tr_b16 v[120:121], v60 offset:43008
    ds_read_b64_tr_b16 v[122:123], v60 offset:44032
    buffer_load_dwordx4 v[216:219], v4, s[36:39], s82 offen offset:2048 sc1
    s_waitcnt lgkmcnt(10)
    v_mfma_f32_32x32x16_bf16 v[80:95], v[100:103], v[160:163], v[80:95]
    ds_read_b64_tr_b16 v[124:125], v61 offset:43008
    ds_read_b64_tr_b16 v[126:127], v61 offset:44032
    s_waitcnt vmcnt(13) lgkmcnt(10)
    v_mfma_f32_32x32x16_bf16 v[64:79], v[104:107], v[164:167], v[64:79]
    ds_read_b64_tr_b16 v[96:97], v56 offset:0
    ds_read_b64_tr_b16 v[98:99], v56 offset:1024
    buffer_load_dwordx4 v[220:223], v4, s[36:39], s82 offen offset:3072 sc1
    s_waitcnt lgkmcnt(10)
    v_mfma_f32_32x32x16_bf16 v[80:95], v[108:111], v[164:167], v[80:95]
    ds_read_b64_tr_b16 v[100:101], v57 offset:0
    ds_read_b64_tr_b16 v[102:103], v57 offset:1024
    s_waitcnt vmcnt(13) lgkmcnt(10)
    v_mfma_f32_32x32x16_bf16 v[64:79], v[112:115], v[168:171], v[64:79]
    ds_read_b64_tr_b16 v[104:105], v56 offset:2048
    ds_read_b64_tr_b16 v[106:107], v56 offset:3072
    s_add_u32 s82, s72, 16384
    buffer_load_dwordx4 v[224:227], v4, s[36:39], s82 offen offset:0 sc1
    s_waitcnt lgkmcnt(10)
    v_mfma_f32_32x32x16_bf16 v[80:95], v[116:119], v[168:171], v[80:95]
    ds_read_b64_tr_b16 v[108:109], v57 offset:2048
    ds_read_b64_tr_b16 v[110:111], v57 offset:3072
    s_waitcnt vmcnt(13) lgkmcnt(10)
    v_mfma_f32_32x32x16_bf16 v[64:79], v[120:123], v[172:175], v[64:79]
    ds_read_b64_tr_b16 v[112:113], v56 offset:8192
    ds_read_b64_tr_b16 v[114:115], v56 offset:9216
    buffer_load_dwordx4 v[228:231], v4, s[36:39], s82 offen offset:1024 sc1
    s_waitcnt lgkmcnt(10)
    v_mfma_f32_32x32x16_bf16 v[80:95], v[124:127], v[172:175], v[80:95]
    ds_read_b64_tr_b16 v[116:117], v57 offset:8192
    ds_read_b64_tr_b16 v[118:119], v57 offset:9216
    s_waitcnt vmcnt(13) lgkmcnt(10)
    v_mfma_f32_32x32x16_bf16 v[64:79], v[96:99], v[176:179], v[64:79]
    ds_read_b64_tr_b16 v[120:121], v56 offset:10240
    ds_read_b64_tr_b16 v[122:123], v56 offset:11264
    buffer_load_dwordx4 v[128:131], v4, s[36:39], s82 offen offset:2048 sc1
    s_waitcnt lgkmcnt(10)
    v_mfma_f32_32x32x16_bf16 v[80:95], v[100:103], v[176:179], v[80:95]
    ds_read_b64_tr_b16 v[124:125], v57 offset:10240
    ds_read_b64_tr_b16 v[126:127], v57 offset:11264
    s_waitcnt vmcnt(13) lgkmcnt(10)
    v_mfma_f32_32x32x16_bf16 v[64:79], v[104:107], v[180:183], v[64:79]
    ds_read_b64_tr_b16 v[96:97], v56 offset:16384
    ds_read_b64_tr_b16 v[98:99], v56 offset:17408
    buffer_load_dwordx4 v[132:135], v4, s[36:39], s82 offen offset:3072 sc1
    s_waitcnt lgkmcnt(10)
    v_mfma_f32_32x32x16_bf16 v[80:95], v[108:111], v[180:183], v[80:95]
    ds_read_b64_tr_b16 v[100:101], v57 offset:16384
    ds_read_b64_tr_b16 v[102:103], v57 offset:17408
    s_waitcnt vmcnt(13) lgkmcnt(10)
    v_mfma_f32_32x32x16_bf16 v[64:79], v[112:115], v[184:187], v[64:79]
    ds_read_b64_tr_b16 v[104:105], v56 offset:18432
    ds_read_b64_tr_b16 v[106:107], v56 offset:19456
    s_add_u32 s82, s72, 20480
    buffer_load_dwordx4 v[136:139], v4, s[36:39], s82 offen offset:0 sc1
    s_waitcnt lgkmcnt(10)
    v_mfma_f32_32x32x16_bf16 v[80:95], v[116:119], v[184:187], v[80:95]
    ds_read_b64_tr_b16 v[108:109], v57 offset:18432
    ds_read_b64_tr_b16 v[110:111], v57 offset:19456
    s_waitcnt vmcnt(13) lgkmcnt(10)
    v_mfma_f32_32x32x16_bf16 v[64:79], v[120:123], v[188:191], v[64:79]
    ds_read_b64_tr_b16 v[112:113], v56 offset:24576
    ds_read_b64_tr_b16 v[114:115], v56 offset:25600
    buffer_load_dwordx4 v[140:143], v4, s[36:39], s82 offen offset:1024 sc1
    s_waitcnt lgkmcnt(10)
    v_mfma_f32_32x32x16_bf16 v[80:95], v[124:127], v[188:191], v[80:95]
    ds_read_b64_tr_b16 v[116:117], v57 offset:24576
    ds_read_b64_tr_b16 v[118:119], v57 offset:25600
    s_waitcnt vmcnt(13) lgkmcnt(10)
    v_mfma_f32_32x32x16_bf16 v[64:79], v[96:99], v[192:195], v[64:79]
    ds_read_b64_tr_b16 v[120:121], v56 offset:26624
    ds_read_b64_tr_b16 v[122:123], v56 offset:27648
    buffer_load_dwordx4 v[144:147], v4, s[36:39], s82 offen offset:2048 sc1
    s_waitcnt lgkmcnt(10)
    v_mfma_f32_32x32x16_bf16 v[80:95], v[100:103], v[192:195], v[80:95]
    ds_read_b64_tr_b16 v[124:125], v57 offset:26624
    ds_read_b64_tr_b16 v[126:127], v57 offset:27648
    s_waitcnt vmcnt(13) lgkmcnt(10)
    v_mfma_f32_32x32x16_bf16 v[64:79], v[104:107], v[196:199], v[64:79]
    ds_read_b64_tr_b16 v[96:97], v56 offset:32768
    ds_read_b64_tr_b16 v[98:99], v56 offset:33792
    buffer_load_dwordx4 v[148:151], v4, s[36:39], s82 offen offset:3072 sc1
    s_waitcnt lgkmcnt(10)
    v_mfma_f32_32x32x16_bf16 v[80:95], v[108:111], v[196:199], v[80:95]
    ds_read_b64_tr_b16 v[100:101], v57 offset:32768
    ds_read_b64_tr_b16 v[102:103], v57 offset:33792
    s_waitcnt vmcnt(13) lgkmcnt(10)
    v_mfma_f32_32x32x16_bf16 v[64:79], v[112:115], v[200:203], v[64:79]
    ds_read_b64_tr_b16 v[104:105], v56 offset:34816
    ds_read_b64_tr_b16 v[106:107], v56 offset:35840
    s_add_u32 s82, s72, 24576
    buffer_load_dwordx4 v[152:155], v4, s[36:39], s82 offen offset:0 sc1
    s_waitcnt lgkmcnt(10)
    v_mfma_f32_32x32x16_bf16 v[80:95], v[116:119], v[200:203], v[80:95]
    ds_read_b64_tr_b16 v[108:109], v57 offset:34816
    ds_read_b64_tr_b16 v[110:111], v57 offset:35840
    s_waitcnt vmcnt(13) lgkmcnt(10)
    v_mfma_f32_32x32x16_bf16 v[64:79], v[120:123], v[204:207], v[64:79]
    ds_read_b64_tr_b16 v[112:113], v56 offset:40960
    ds_read_b64_tr_b16 v[114:115], v56 offset:41984
    buffer_load_dwordx4 v[156:159], v4, s[36:39], s82 offen offset:1024 sc1
    s_waitcnt lgkmcnt(10)
    v_mfma_f32_32x32x16_bf16 v[80:95], v[124:127], v[204:207], v[80:95]
    ds_read_b64_tr_b16 v[116:117], v57 offset:40960
    ds_read_b64_tr_b16 v[118:119], v57 offset:41984
    s_waitcnt vmcnt(13) lgkmcnt(10)
    v_mfma_f32_32x32x16_bf16 v[64:79], v[96:99], v[208:211], v[64:79]
    ds_read_b64_tr_b16 v[120:121], v56 offset:43008
    ds_read_b64_tr_b16 v[122:123], v56 offset:44032
    buffer_load_dwordx4 v[160:163], v4, s[36:39], s82 offen offset:2048 sc1
    s_waitcnt lgkmcnt(10)
    v_mfma_f32_32x32x16_bf16 v[80:95], v[100:103], v[208:211], v[80:95]
    ds_read_b64_tr_b16 v[124:125], v57 offset:43008
    ds_read_b64_tr_b16 v[126:127], v57 offset:44032
    s_waitcnt vmcnt(13) lgkmcnt(10)
    v_mfma_f32_32x32x16_bf16 v[64:79], v[104:107], v[212:215], v[64:79]
    ds_read_b64_tr_b16 v[96:97], v58 offset:0
    ds_read_b64_tr_b16 v[98:99], v58 offset:1024
    buffer_load_dwordx4 v[164:167], v4, s[36:39], s82 offen offset:3072 sc1
    s_waitcnt lgkmcnt(10)
    v_mfma_f32_32x32x16_bf16 v[80:95], v[108:111], v[212:215], v[80:95]
    ds_read_b64_tr_b16 v[100:101], v59 offset:0
    ds_read_b64_tr_b16 v[102:103], v59 offset:1024
    s_waitcnt vmcnt(13) lgkmcnt(10)
    v_mfma_f32_32x32x16_bf16 v[64:79], v[112:115], v[216:219], v[64:79]
    ds_read_b64_tr_b16 v[104:105], v58 offset:2048
    ds_read_b64_tr_b16 v[106:107], v58 offset:3072
    s_add_u32 s82, s72, 28672
    buffer_load_dwordx4 v[168:171], v4, s[36:39], s82 offen offset:0 sc1
    s_waitcnt lgkmcnt(10)
    v_mfma_f32_32x32x16_bf16 v[80:95], v[116:119], v[216:219], v[80:95]
    ds_read_b64_tr_b16 v[108:109], v59 offset:2048
    ds_read_b64_tr_b16 v[110:111], v59 offset:3072
    s_waitcnt vmcnt(13) lgkmcnt(10)
    v_mfma_f32_32x32x16_bf16 v[64:79], v[120:123], v[220:223], v[64:79]
    ds_read_b64_tr_b16 v[112:113], v58 offset:8192
    ds_read_b64_tr_b16 v[114:115], v58 offset:9216
    buffer_load_dwordx4 v[172:175], v4, s[36:39], s82 offen offset:1024 sc1
    s_waitcnt lgkmcnt(10)
    v_mfma_f32_32x32x16_bf16 v[80:95], v[124:127], v[220:223], v[80:95]
    ds_read_b64_tr_b16 v[116:117], v59 offset:8192
    ds_read_b64_tr_b16 v[118:119], v59 offset:9216
    s_waitcnt vmcnt(13) lgkmcnt(10)
    v_mfma_f32_32x32x16_bf16 v[64:79], v[96:99], v[224:227], v[64:79]
    ds_read_b64_tr_b16 v[120:121], v58 offset:10240
    ds_read_b64_tr_b16 v[122:123], v58 offset:11264
    buffer_load_dwordx4 v[176:179], v4, s[36:39], s82 offen offset:2048 sc1
    s_waitcnt lgkmcnt(10)
    v_mfma_f32_32x32x16_bf16 v[80:95], v[100:103], v[224:227], v[80:95]
    ds_read_b64_tr_b16 v[124:125], v59 offset:10240
    ds_read_b64_tr_b16 v[126:127], v59 offset:11264
    s_waitcnt vmcnt(13) lgkmcnt(10)
    v_mfma_f32_32x32x16_bf16 v[64:79], v[104:107], v[228:231], v[64:79]
    ds_read_b64_tr_b16 v[96:97], v58 offset:16384
    ds_read_b64_tr_b16 v[98:99], v58 offset:17408
    buffer_load_dwordx4 v[180:183], v4, s[36:39], s82 offen offset:3072 sc1
    s_waitcnt lgkmcnt(10)
    v_mfma_f32_32x32x16_bf16 v[80:95], v[108:111], v[228:231], v[80:95]
    ds_read_b64_tr_b16 v[100:101], v59 offset:16384
    ds_read_b64_tr_b16 v[102:103], v59 offset:17408
    s_waitcnt vmcnt(13) lgkmcnt(10)
    v_mfma_f32_32x32x16_bf16 v[64:79], v[112:115], v[128:131], v[64:79]
    ds_read_b64_tr_b16 v[104:105], v58 offset:18432
    ds_read_b64_tr_b16 v[106:107], v58 offset:19456
    s_add_u32 s82, s72, 32768
    buffer_load_dwordx4 v[184:187], v4, s[36:39], s82 offen offset:0 sc1
    s_waitcnt lgkmcnt(10)
    v_mfma_f32_32x32x16_bf16 v[80:95], v[116:119], v[128:131], v[80:95]
    ds_read_b64_tr_b16 v[108:109], v59 offset:18432
    ds_read_b64_tr_b16 v[110:111], v59 offset:19456
    s_waitcnt vmcnt(13) lgkmcnt(10)
    v_mfma_f32_32x32x16_bf16 v[64:79], v[120:123], v[132:135], v[64:79]
    ds_read_b64_tr_b16 v[112:113], v58 offset:24576
    ds_read_b64_tr_b16 v[114:115], v58 offset:25600
    buffer_load_dwordx4 v[188:191], v4, s[36:39], s82 offen offset:1024 sc1
    s_waitcnt lgkmcnt(10)
    v_mfma_f32_32x32x16_bf16 v[80:95], v[124:127], v[132:135], v[80:95]
    ds_read_b64_tr_b16 v[116:117], v59 offset:24576
    ds_read_b64_tr_b16 v[118:119], v59 offset:25600
    s_waitcnt vmcnt(13) lgkmcnt(10)
    v_mfma_f32_32x32x16_bf16 v[64:79], v[96:99], v[136:139], v[64:79]
    ds_read_b64_tr_b16 v[120:121], v58 offset:26624
    ds_read_b64_tr_b16 v[122:123], v58 offset:27648
    buffer_load_dwordx4 v[192:195], v4, s[36:39], s82 offen offset:2048 sc1
    s_waitcnt lgkmcnt(10)
    v_mfma_f32_32x32x16_bf16 v[80:95], v[100:103], v[136:139], v[80:95]
    ds_read_b64_tr_b16 v[124:125], v59 offset:26624
    ds_read_b64_tr_b16 v[126:127], v59 offset:27648
    s_waitcnt vmcnt(13) lgkmcnt(10)
    v_mfma_f32_32x32x16_bf16 v[64:79], v[104:107], v[140:143], v[64:79]
    ds_read_b64_tr_b16 v[96:97], v58 offset:32768
    ds_read_b64_tr_b16 v[98:99], v58 offset:33792
    buffer_load_dwordx4 v[196:199], v4, s[36:39], s82 offen offset:3072 sc1
    s_waitcnt lgkmcnt(10)
    v_mfma_f32_32x32x16_bf16 v[80:95], v[108:111], v[140:143], v[80:95]
    ds_read_b64_tr_b16 v[100:101], v59 offset:32768
    ds_read_b64_tr_b16 v[102:103], v59 offset:33792
    s_waitcnt vmcnt(13) lgkmcnt(10)
    v_mfma_f32_32x32x16_bf16 v[64:79], v[112:115], v[144:147], v[64:79]
    ds_read_b64_tr_b16 v[104:105], v58 offset:34816
    ds_read_b64_tr_b16 v[106:107], v58 offset:35840
    s_add_u32 s82, s72, 36864
    buffer_load_dwordx4 v[200:203], v4, s[36:39], s82 offen offset:0 sc1
    s_waitcnt lgkmcnt(10)
    v_mfma_f32_32x32x16_bf16 v[80:95], v[116:119], v[144:147], v[80:95]
    ds_read_b64_tr_b16 v[108:109], v59 offset:34816
    ds_read_b64_tr_b16 v[110:111], v59 offset:35840
    s_waitcnt vmcnt(13) lgkmcnt(10)
    v_mfma_f32_32x32x16_bf16 v[64:79], v[120:123], v[148:151], v[64:79]
    ds_read_b64_tr_b16 v[112:113], v58 offset:40960
    ds_read_b64_tr_b16 v[114:115], v58 offset:41984
    buffer_load_dwordx4 v[204:207], v4, s[36:39], s82 offen offset:1024 sc1
    s_waitcnt lgkmcnt(10)
    v_mfma_f32_32x32x16_bf16 v[80:95], v[124:127], v[148:151], v[80:95]
    ds_read_b64_tr_b16 v[116:117], v59 offset:40960
    ds_read_b64_tr_b16 v[118:119], v59 offset:41984
    s_waitcnt vmcnt(13) lgkmcnt(10)
    v_mfma_f32_32x32x16_bf16 v[64:79], v[96:99], v[152:155], v[64:79]
    ds_read_b64_tr_b16 v[120:121], v58 offset:43008
    ds_read_b64_tr_b16 v[122:123], v58 offset:44032
    buffer_load_dwordx4 v[208:211], v4, s[36:39], s82 offen offset:2048 sc1
    s_waitcnt lgkmcnt(10)
    v_mfma_f32_32x32x16_bf16 v[80:95], v[100:103], v[152:155], v[80:95]
    ds_read_b64_tr_b16 v[124:125], v59 offset:43008
    ds_read_b64_tr_b16 v[126:127], v59 offset:44032
    s_waitcnt vmcnt(13) lgkmcnt(10)
    v_mfma_f32_32x32x16_bf16 v[64:79], v[104:107], v[156:159], v[64:79]
    ds_read_b64_tr_b16 v[96:97], v60 offset:0
    ds_read_b64_tr_b16 v[98:99], v60 offset:1024
    buffer_load_dwordx4 v[212:215], v4, s[36:39], s82 offen offset:3072 sc1
    s_waitcnt lgkmcnt(10)
    v_mfma_f32_32x32x16_bf16 v[80:95], v[108:111], v[156:159], v[80:95]
    ds_read_b64_tr_b16 v[100:101], v61 offset:0
    ds_read_b64_tr_b16 v[102:103], v61 offset:1024
    s_waitcnt vmcnt(13) lgkmcnt(10)
    v_mfma_f32_32x32x16_bf16 v[64:79], v[112:115], v[160:163], v[64:79]
    ds_read_b64_tr_b16 v[104:105], v60 offset:2048
    ds_read_b64_tr_b16 v[106:107], v60 offset:3072
    s_add_u32 s82, s72, 40960
    buffer_load_dwordx4 v[216:219], v4, s[36:39], s82 offen offset:0 sc1
    s_waitcnt lgkmcnt(10)
    v_mfma_f32_32x32x16_bf16 v[80:95], v[116:119], v[160:163], v[80:95]
    ds_read_b64_tr_b16 v[108:109], v61 offset:2048
    ds_read_b64_tr_b16 v[110:111], v61 offset:3072
    s_waitcnt vmcnt(13) lgkmcnt(10)
    v_mfma_f32_32x32x16_bf16 v[64:79], v[120:123], v[164:167], v[64:79]
    ds_read_b64_tr_b16 v[112:113], v60 offset:8192
    ds_read_b64_tr_b16 v[114:115], v60 offset:9216
    buffer_load_dwordx4 v[220:223], v4, s[36:39], s82 offen offset:1024 sc1
    s_waitcnt lgkmcnt(10)
    v_mfma_f32_32x32x16_bf16 v[80:95], v[124:127], v[164:167], v[80:95]
    ds_read_b64_tr_b16 v[116:117], v61 offset:8192
    ds_read_b64_tr_b16 v[118:119], v61 offset:9216
    s_waitcnt vmcnt(13) lgkmcnt(10)
    v_mfma_f32_32x32x16_bf16 v[64:79], v[96:99], v[168:171], v[64:79]
    ds_read_b64_tr_b16 v[120:121], v60 offset:10240
    ds_read_b64_tr_b16 v[122:123], v60 offset:11264
    buffer_load_dwordx4 v[224:227], v4, s[36:39], s82 offen offset:2048 sc1
    s_waitcnt lgkmcnt(10)
    v_mfma_f32_32x32x16_bf16 v[80:95], v[100:103], v[168:171], v[80:95]
    ds_read_b64_tr_b16 v[124:125], v61 offset:10240
    ds_read_b64_tr_b16 v[126:127], v61 offset:11264
    s_waitcnt vmcnt(13) lgkmcnt(10)
    v_mfma_f32_32x32x16_bf16 v[64:79], v[104:107], v[172:175], v[64:79]
    ds_read_b64_tr_b16 v[96:97], v60 offset:16384
    ds_read_b64_tr_b16 v[98:99], v60 offset:17408
    buffer_load_dwordx4 v[228:231], v4, s[36:39], s82 offen offset:3072 sc1
    s_waitcnt lgkmcnt(10)
    v_mfma_f32_32x32x16_bf16 v[80:95], v[108:111], v[172:175], v[80:95]
    ds_read_b64_tr_b16 v[100:101], v61 offset:16384
    ds_read_b64_tr_b16 v[102:103], v61 offset:17408
    s_waitcnt vmcnt(13) lgkmcnt(10)
    v_mfma_f32_32x32x16_bf16 v[64:79], v[112:115], v[176:179], v[64:79]
    ds_read_b64_tr_b16 v[104:105], v60 offset:18432
    ds_read_b64_tr_b16 v[106:107], v60 offset:19456
    s_add_u32 s82, s72, 45056
    buffer_load_dwordx4 v[128:131], v4, s[36:39], s82 offen offset:0 sc1
    s_waitcnt lgkmcnt(10)
    v_mfma_f32_32x32x16_bf16 v[80:95], v[116:119], v[176:179], v[80:95]
    ds_read_b64_tr_b16 v[108:109], v61 offset:18432
    ds_read_b64_tr_b16 v[110:111], v61 offset:19456
    s_waitcnt vmcnt(13) lgkmcnt(10)
    v_mfma_f32_32x32x16_bf16 v[64:79], v[120:123], v[180:183], v[64:79]
    ds_read_b64_tr_b16 v[112:113], v60 offset:24576
    ds_read_b64_tr_b16 v[114:115], v60 offset:25600
    buffer_load_dwordx4 v[132:135], v4, s[36:39], s82 offen offset:1024 sc1
    s_waitcnt lgkmcnt(10)
    v_mfma_f32_32x32x16_bf16 v[80:95], v[124:127], v[180:183], v[80:95]
    ds_read_b64_tr_b16 v[116:117], v61 offset:24576
    ds_read_b64_tr_b16 v[118:119], v61 offset:25600
    s_waitcnt vmcnt(13) lgkmcnt(10)
    v_mfma_f32_32x32x16_bf16 v[64:79], v[96:99], v[184:187], v[64:79]
    ds_read_b64_tr_b16 v[120:121], v60 offset:26624
    ds_read_b64_tr_b16 v[122:123], v60 offset:27648
    buffer_load_dwordx4 v[136:139], v4, s[36:39], s82 offen offset:2048 sc1
    s_waitcnt lgkmcnt(10)
    v_mfma_f32_32x32x16_bf16 v[80:95], v[100:103], v[184:187], v[80:95]
    ds_read_b64_tr_b16 v[124:125], v61 offset:26624
    ds_read_b64_tr_b16 v[126:127], v61 offset:27648
    s_waitcnt vmcnt(13) lgkmcnt(10)
    v_mfma_f32_32x32x16_bf16 v[64:79], v[104:107], v[188:191], v[64:79]
    buffer_load_dwordx4 v[140:143], v4, s[36:39], s82 offen offset:3072 sc1
    s_waitcnt lgkmcnt(8)
    v_mfma_f32_32x32x16_bf16 v[80:95], v[108:111], v[188:191], v[80:95]
    s_waitcnt vmcnt(13) lgkmcnt(6)
    v_mfma_f32_32x32x16_bf16 v[64:79], v[112:115], v[192:195], v[64:79]
    s_add_u32 s82, s72, 49152
    buffer_load_dwordx4 v[144:147], v4, s[36:39], s82 offen offset:0 sc1
    s_waitcnt lgkmcnt(4)
    v_mfma_f32_32x32x16_bf16 v[80:95], v[116:119], v[192:195], v[80:95]
    s_waitcnt vmcnt(13) lgkmcnt(2)
    v_mfma_f32_32x32x16_bf16 v[64:79], v[120:123], v[196:199], v[64:79]
    buffer_load_dwordx4 v[148:151], v4, s[36:39], s82 offen offset:1024 sc1
    s_waitcnt lgkmcnt(0)
    v_mfma_f32_32x32x16_bf16 v[80:95], v[124:127], v[196:199], v[80:95]
    s_barrier
    s_waitcnt vmcnt(13)
    v_mfma_f32_32x32x16_bf16 v[64:79], a[48:51], v[200:203], v[64:79]
    buffer_load_dwordx4 v[152:155], v4, s[36:39], s82 offen offset:2048 sc1
    v_mfma_f32_32x32x16_bf16 v[80:95], a[52:55], v[200:203], v[80:95]
    s_waitcnt vmcnt(13)
    v_mfma_f32_32x32x16_bf16 v[64:79], a[56:59], v[204:207], v[64:79]
    buffer_load_dwordx4 v[156:159], v4, s[36:39], s82 offen offset:3072 sc1
    v_mfma_f32_32x32x16_bf16 v[80:95], a[60:63], v[204:207], v[80:95]
    s_waitcnt vmcnt(13)
    v_mfma_f32_32x32x16_bf16 v[64:79], a[64:67], v[208:211], v[64:79]
    s_add_u32 s82, s72, 53248
    buffer_load_dwordx4 v[160:163], v4, s[36:39], s82 offen offset:0 sc1
    v_mfma_f32_32x32x16_bf16 v[80:95], a[68:71], v[208:211], v[80:95]
    s_waitcnt vmcnt(13)
    v_mfma_f32_32x32x16_bf16 v[64:79], a[72:75], v[212:215], v[64:79]
    buffer_load_dwordx4 v[164:167], v4, s[36:39], s82 offen offset:1024 sc1
    v_mfma_f32_32x32x16_bf16 v[80:95], a[76:79], v[212:215], v[80:95]
    s_waitcnt vmcnt(13)
    v_mfma_f32_32x32x16_bf16 v[64:79], a[80:83], v[216:219], v[64:79]
    buffer_load_dwordx4 v[168:171], v4, s[36:39], s82 offen offset:2048 sc1
    v_mfma_f32_32x32x16_bf16 v[80:95], a[84:87], v[216:219], v[80:95]
    s_waitcnt vmcnt(13)
    v_mfma_f32_32x32x16_bf16 v[64:79], a[88:91], v[220:223], v[64:79]
    buffer_load_dwordx4 v[172:175], v4, s[36:39], s82 offen offset:3072 sc1
    v_mfma_f32_32x32x16_bf16 v[80:95], a[92:95], v[220:223], v[80:95]
    s_waitcnt vmcnt(13)
    v_mfma_f32_32x32x16_bf16 v[64:79], a[96:99], v[224:227], v[64:79]
    s_add_u32 m0, s44, 65536
    s_add_u32 s63, s56, 2359296
    buffer_load_dwordx4 v9, s[20:23], s63 offen lds
    v_mfma_f32_32x32x16_bf16 v[80:95], a[100:103], v[224:227], v[80:95]
    s_waitcnt vmcnt(13)
    v_mfma_f32_32x32x16_bf16 v[64:79], a[104:107], v[228:231], v[64:79]
    s_add_u32 m0, s44, 69632
    s_add_u32 s63, s56, 6029312
    buffer_load_dwordx4 v9, s[20:23], s63 offen lds
    v_mfma_f32_32x32x16_bf16 v[80:95], a[108:111], v[228:231], v[80:95]
    s_waitcnt vmcnt(13)
    v_mfma_f32_32x32x16_bf16 v[64:79], a[112:115], v[128:131], v[64:79]
    s_add_u32 m0, s44, 73728
    s_add_u32 s63, s56, 2490368
    buffer_load_dwordx4 v9, s[20:23], s63 offen lds
    v_mfma_f32_32x32x16_bf16 v[80:95], a[116:119], v[128:131], v[80:95]
    s_waitcnt vmcnt(13)
    v_mfma_f32_32x32x16_bf16 v[64:79], a[120:123], v[132:135], v[64:79]
    s_add_u32 m0, s44, 77824
    s_add_u32 s63, s56, 6160384
    buffer_load_dwordx4 v9, s[20:23], s63 offen lds
    v_mfma_f32_32x32x16_bf16 v[80:95], a[124:127], v[132:135], v[80:95]
    s_waitcnt vmcnt(13)
    v_mfma_f32_32x32x16_bf16 v[64:79], a[128:131], v[136:139], v[64:79]
    s_add_u32 m0, s44, 81920
    s_add_u32 s63, s56, 2621440
    buffer_load_dwordx4 v9, s[20:23], s63 offen lds
    v_mfma_f32_32x32x16_bf16 v[80:95], a[132:135], v[136:139], v[80:95]
    s_waitcnt vmcnt(13)
    v_mfma_f32_32x32x16_bf16 v[64:79], a[136:139], v[140:143], v[64:79]
    s_add_u32 m0, s44, 86016
    s_add_u32 s63, s56, 6291456
    buffer_load_dwordx4 v9, s[20:23], s63 offen lds
    v_mfma_f32_32x32x16_bf16 v[80:95], a[140:143], v[140:143], v[80:95]
    s_waitcnt vmcnt(13)
    v_mfma_f32_32x32x16_bf16 v[64:79], a[144:147], v[144:147], v[64:79]
    s_add_u32 m0, s44, 90112
    s_add_u32 s63, s56, 2752512
    buffer_load_dwordx4 v9, s[20:23], s63 offen lds
    v_mfma_f32_32x32x16_bf16 v[80:95], a[148:151], v[144:147], v[80:95]
    s_waitcnt vmcnt(13)
    v_mfma_f32_32x32x16_bf16 v[64:79], a[152:155], v[148:151], v[64:79]
    s_add_u32 m0, s44, 94208
    s_add_u32 s63, s56, 6422528
    buffer_load_dwordx4 v9, s[20:23], s63 offen lds
    v_mfma_f32_32x32x16_bf16 v[80:95], a[156:159], v[148:151], v[80:95]
    s_waitcnt vmcnt(13)
    v_mfma_f32_32x32x16_bf16 v[64:79], a[160:163], v[152:155], v[64:79]
    s_add_u32 m0, s44, 98304
    s_add_u32 s63, s56, 2883584
    buffer_load_dwordx4 v9, s[20:23], s63 offen lds
    v_mfma_f32_32x32x16_bf16 v[80:95], a[164:167], v[152:155], v[80:95]
    s_waitcnt vmcnt(13)
    v_mfma_f32_32x32x16_bf16 v[64:79], a[168:171], v[156:159], v[64:79]
    s_add_u32 m0, s44, 102400
    s_add_u32 s63, s56, 6553600
    buffer_load_dwordx4 v9, s[20:23], s63 offen lds
    v_mfma_f32_32x32x16_bf16 v[80:95], a[172:175], v[156:159], v[80:95]
    s_waitcnt vmcnt(13)
    v_mfma_f32_32x32x16_bf16 v[64:79], a[176:179], v[160:163], v[64:79]
    s_add_u32 m0, s44, 106496
    s_add_u32 s63, s56, 3014656
    buffer_load_dwordx4 v9, s[20:23], s63 offen lds
    v_mfma_f32_32x32x16_bf16 v[80:95], a[180:183], v[160:163], v[80:95]
    s_waitcnt vmcnt(13)
    v_mfma_f32_32x32x16_bf16 v[64:79], a[184:187], v[164:167], v[64:79]
    s_add_u32 m0, s44, 110592
    s_add_u32 s63, s56, 6684672
    buffer_load_dwordx4 v9, s[20:23], s63 offen lds
    v_mfma_f32_32x32x16_bf16 v[80:95], a[188:191], v[164:167], v[80:95]
    s_waitcnt vmcnt(13)
    v_mfma_f32_32x32x16_bf16 v[80:95], a[196:199], v[168:171], v[80:95]
    s_waitcnt vmcnt(12)
    v_mfma_f32_32x32x16_bf16 v[80:95], a[204:207], v[172:175], v[80:95]
    v_mfma_f32_32x32x16_bf16 v[64:79], a[192:195], v[168:171], v[64:79]
    s_add_u32 m0, s44, 114688
    s_add_u32 s63, s56, 3145728
    buffer_load_dwordx4 v9, s[20:23], s63 offen lds
    v_mfma_f32_32x32x16_bf16 v[64:79], a[200:203], v[172:175], v[64:79]
    s_add_u32 m0, s44, 118784
    s_add_u32 s63, s56, 6815744
    buffer_load_dwordx4 v9, s[20:23], s63 offen lds
    s_nop 3
    ds_write_b128 v22, v[80:83] offset:0
    ds_write_b128 v22, v[84:87] offset:1024
    ds_write_b128 v22, v[88:91] offset:2048
    ds_write_b128 v22, v[92:95] offset:3072
    s_waitcnt lgkmcnt(0)
    s_barrier
    ds_read_b128 v[96:99], v23 offset:0
    ds_read_b128 v[100:103], v23 offset:1024
    ds_read_b128 v[104:107], v23 offset:2048
    ds_read_b128 v[108:111], v23 offset:3072
    s_add_u32 m0, s44, 122880
    s_add_u32 s63, s56, 3276800
    buffer_load_dwordx4 v9, s[20:23], s63 offen lds
    s_add_u32 m0, s44, 126976
    s_add_u32 s63, s56, 6946816
    buffer_load_dwordx4 v9, s[20:23], s63 offen lds
    s_waitcnt lgkmcnt(3)
    v_pk_add_f32 v[64:65], v[64:65], v[96:97]
    v_pk_add_f32 v[66:67], v[66:67], v[98:99]
    s_waitcnt lgkmcnt(2)
    v_pk_add_f32 v[68:69], v[68:69], v[100:101]
    s_add_u32 m0, s44, 131072
    s_add_u32 s63, s56, 3407872
    buffer_load_dwordx4 v9, s[20:23], s63 offen lds
    v_pk_add_f32 v[70:71], v[70:71], v[102:103]
    v_pk_mul_f32 v[80:81], v[64:65], v[64:65]
    v_pk_mul_f32 v[82:83], v[66:67], v[66:67]
    v_pk_mul_f32 v[84:85], v[68:69], v[68:69]
    v_pk_mul_f32 v[86:87], v[70:71], v[70:71]
    v_pk_fma_f32 v[80:81], v[80:81], v[48:49], v[50:51] op_sel_hi:[1,0,0]
    v_pk_fma_f32 v[82:83], v[82:83], v[48:49], v[50:51] op_sel_hi:[1,0,0]
    v_pk_fma_f32 v[84:85], v[84:85], v[48:49], v[50:51] op_sel_hi:[1,0,0]
    s_add_u32 m0, s44, 135168
    s_add_u32 s63, s56, 7077888
    buffer_load_dwordx4 v9, s[20:23], s63 offen lds
    v_pk_fma_f32 v[86:87], v[86:87], v[48:49], v[50:51] op_sel_hi:[1,0,0]
    v_pk_mul_f32 v[80:81], v[80:81], v[64:65]
    v_pk_mul_f32 v[82:83], v[82:83], v[66:67]
    v_pk_mul_f32 v[84:85], v[84:85], v[68:69]
    v_pk_mul_f32 v[86:87], v[86:87], v[70:71]
    v_exp_f32 v80, v80
    v_exp_f32 v81, v81
    v_exp_f32 v82, v82
    s_add_u32 m0, s44, 139264
    s_add_u32 s63, s56, 3538944
    buffer_load_dwordx4 v9, s[20:23], s63 offen lds
    v_exp_f32 v83, v83
    v_exp_f32 v84, v84
    v_exp_f32 v85, v85
    v_exp_f32 v86, v86
    v_exp_f32 v87, v87
    v_pk_add_f32 v[80:81], v[80:81], 1.0 op_sel_hi:[1,0]
    v_pk_add_f32 v[82:83], v[82:83], 1.0 op_sel_hi:[1,0]
    v_pk_add_f32 v[84:85], v[84:85], 1.0 op_sel_hi:[1,0]
    s_add_u32 m0, s44, 143360
    s_add_u32 s63, s56, 7208960
    buffer_load_dwordx4 v9, s[20:23], s63 offen lds
    v_pk_add_f32 v[86:87], v[86:87], 1.0 op_sel_hi:[1,0]
    v_rcp_f32 v80, v80
    v_rcp_f32 v81, v81
    v_rcp_f32 v82, v82
    v_rcp_f32 v83, v83
    v_rcp_f32 v84, v84
    v_rcp_f32 v85, v85
    v_rcp_f32 v86, v86
    s_add_u32 m0, s44, 0
    s_add_u32 s63, s56, 0
    buffer_load_dwordx4 v9, s[20:23], s63 offen lds
    v_rcp_f32 v87, v87
    v_pk_mul_f32 v[64:65], v[64:65], v[80:81]
    v_pk_mul_f32 v[66:67], v[66:67], v[82:83]
    v_pk_mul_f32 v[68:69], v[68:69], v[84:85]
    v_pk_mul_f32 v[70:71], v[70:71], v[86:87]
    v_cvt_pk_bf16_f32 v116, v64, v65
    v_cvt_pk_bf16_f32 v117, v66, v67
    v_cvt_pk_bf16_f32 v118, v68, v69
    s_add_u32 m0, s44, 4096
    s_add_u32 s63, s56, 3670016
    buffer_load_dwordx4 v9, s[20:23], s63 offen lds
    v_cvt_pk_bf16_f32 v119, v70, v71
    buffer_store_dwordx4 v[116:119], v4, s[36:39], s60 offen offset:0 sc1
    s_waitcnt lgkmcnt(1)
    v_pk_add_f32 v[72:73], v[72:73], v[104:105]
    v_pk_add_f32 v[74:75], v[74:75], v[106:107]
    s_waitcnt lgkmcnt(0)
    v_pk_add_f32 v[76:77], v[76:77], v[108:109]
    v_pk_add_f32 v[78:79], v[78:79], v[110:111]
    v_pk_mul_f32 v[88:89], v[72:73], v[72:73]
    v_pk_mul_f32 v[90:91], v[74:75], v[74:75]
    v_pk_mul_f32 v[92:93], v[76:77], v[76:77]
    s_add_u32 m0, s44, 8192
    s_add_u32 s63, s56, 131072
    buffer_load_dwordx4 v9, s[20:23], s63 offen lds
    v_pk_mul_f32 v[94:95], v[78:79], v[78:79]
    v_pk_fma_f32 v[88:89], v[88:89], v[48:49], v[50:51] op_sel_hi:[1,0,0]
    v_pk_fma_f32 v[90:91], v[90:91], v[48:49], v[50:51] op_sel_hi:[1,0,0]
    v_pk_fma_f32 v[92:93], v[92:93], v[48:49], v[50:51] op_sel_hi:[1,0,0]
    v_pk_fma_f32 v[94:95], v[94:95], v[48:49], v[50:51] op_sel_hi:[1,0,0]
    v_pk_mul_f32 v[88:89], v[88:89], v[72:73]
    v_pk_mul_f32 v[90:91], v[90:91], v[74:75]
    v_pk_mul_f32 v[92:93], v[92:93], v[76:77]
    s_add_u32 m0, s44, 12288
    s_add_u32 s63, s56, 3801088
    buffer_load_dwordx4 v9, s[20:23], s63 offen lds
    v_pk_mul_f32 v[94:95], v[94:95], v[78:79]
    v_exp_f32 v88, v88
    v_exp_f32 v89, v89
    v_exp_f32 v90, v90
    v_exp_f32 v91, v91
    v_exp_f32 v92, v92
    v_exp_f32 v93, v93
    v_exp_f32 v94, v94
    s_add_u32 m0, s44, 16384
    s_add_u32 s63, s56, 262144
    buffer_load_dwordx4 v9, s[20:23], s63 offen lds
    v_exp_f32 v95, v95
    v_pk_add_f32 v[88:89], v[88:89], 1.0 op_sel_hi:[1,0]
    v_pk_add_f32 v[90:91], v[90:91], 1.0 op_sel_hi:[1,0]
    v_pk_add_f32 v[92:93], v[92:93], 1.0 op_sel_hi:[1,0]
    v_pk_add_f32 v[94:95], v[94:95], 1.0 op_sel_hi:[1,0]
    v_rcp_f32 v88, v88
    v_rcp_f32 v89, v89
    v_rcp_f32 v90, v90
    s_add_u32 m0, s44, 20480
    s_add_u32 s63, s56, 3932160
    buffer_load_dwordx4 v9, s[20:23], s63 offen lds
    v_rcp_f32 v91, v91
    v_rcp_f32 v92, v92
    v_rcp_f32 v93, v93
    v_rcp_f32 v94, v94
    v_rcp_f32 v95, v95
    v_pk_mul_f32 v[72:73], v[72:73], v[88:89]
    v_pk_mul_f32 v[74:75], v[74:75], v[90:91]
    v_pk_mul_f32 v[76:77], v[76:77], v[92:93]
    s_add_u32 m0, s44, 24576
    s_add_u32 s63, s56, 393216
    buffer_load_dwordx4 v9, s[20:23], s63 offen lds
    v_pk_mul_f32 v[78:79], v[78:79], v[94:95]
    v_cvt_pk_bf16_f32 v120, v72, v73
    v_cvt_pk_bf16_f32 v121, v74, v75
    v_cvt_pk_bf16_f32 v122, v76, v77
    v_cvt_pk_bf16_f32 v123, v78, v79
    buffer_store_dwordx4 v[120:123], v4, s[36:39], s60 offen offset:1024 sc1
    s_waitcnt vmcnt(9)
    s_barrier
    s_add_u32 m0, s44, 28672
    s_add_u32 s63, s56, 4063232
    buffer_load_dwordx4 v9, s[20:23], s63 offen lds
    ds_read_b64_tr_b16 a[0:1], v58 offset:16384
    ds_read_b64_tr_b16 a[2:3], v58 offset:17408
    ds_read_b64_tr_b16 a[4:5], v59 offset:16384
    ds_read_b64_tr_b16 a[6:7], v59 offset:17408
    ds_read_b64_tr_b16 a[8:9], v58 offset:18432
    ds_read_b64_tr_b16 a[10:11], v58 offset:19456
    s_add_u32 m0, s44, 32768
    s_add_u32 s63, s56, 524288
    buffer_load_dwordx4 v9, s[20:23], s63 offen lds
    ds_read_b64_tr_b16 a[12:13], v59 offset:18432
    ds_read_b64_tr_b16 a[14:15], v59 offset:19456
    ds_read_b64_tr_b16 a[16:17], v58 offset:24576
    ds_read_b64_tr_b16 a[18:19], v58 offset:25600
    ds_read_b64_tr_b16 a[20:21], v59 offset:24576
    ds_read_b64_tr_b16 a[22:23], v59 offset:25600
    s_add_u32 m0, s44, 36864
    s_add_u32 s63, s56, 4194304
    buffer_load_dwordx4 v9, s[20:23], s63 offen lds
    ds_read_b64_tr_b16 a[24:25], v58 offset:26624
    ds_read_b64_tr_b16 a[26:27], v58 offset:27648
    ds_read_b64_tr_b16 a[28:29], v59 offset:26624
    ds_read_b64_tr_b16 a[30:31], v59 offset:27648
    ds_read_b64_tr_b16 a[32:33], v58 offset:32768
    ds_read_b64_tr_b16 a[34:35], v58 offset:33792
    s_add_u32 m0, s44, 40960
    s_add_u32 s63, s56, 655360
    buffer_load_dwordx4 v9, s[20:23], s63 offen lds
    ds_read_b64_tr_b16 a[36:37], v59 offset:32768
    ds_read_b64_tr_b16 a[38:39], v59 offset:33792
    ds_read_b64_tr_b16 a[40:41], v58 offset:34816
    ds_read_b64_tr_b16 a[42:43], v58 offset:35840
    ds_read_b64_tr_b16 a[44:45], v59 offset:34816
    ds_read_b64_tr_b16 a[46:47], v59 offset:35840
    s_add_u32 m0, s44, 45056
    s_add_u32 s63, s56, 4325376
    buffer_load_dwordx4 v9, s[20:23], s63 offen lds
    ds_read_b64_tr_b16 a[48:49], v58 offset:40960
    ds_read_b64_tr_b16 a[50:51], v58 offset:41984
    ds_read_b64_tr_b16 a[52:53], v59 offset:40960
    ds_read_b64_tr_b16 a[54:55], v59 offset:41984
    ds_read_b64_tr_b16 a[56:57], v58 offset:43008
    ds_read_b64_tr_b16 a[58:59], v58 offset:44032
    s_add_u32 m0, s44, 49152
    s_add_u32 s63, s56, 786432
    buffer_load_dwordx4 v9, s[20:23], s63 offen lds
    ds_read_b64_tr_b16 a[60:61], v59 offset:43008
    ds_read_b64_tr_b16 a[62:63], v59 offset:44032
    ds_read_b64_tr_b16 a[64:65], v60 offset:0
    ds_read_b64_tr_b16 a[66:67], v60 offset:1024
    ds_read_b64_tr_b16 a[68:69], v61 offset:0
    ds_read_b64_tr_b16 a[70:71], v61 offset:1024
    s_add_u32 m0, s44, 53248
    s_add_u32 s63, s56, 4456448
    buffer_load_dwordx4 v9, s[20:23], s63 offen lds
    ds_read_b64_tr_b16 a[72:73], v60 offset:2048
    ds_read_b64_tr_b16 a[74:75], v60 offset:3072
    ds_read_b64_tr_b16 a[76:77], v61 offset:2048
    ds_read_b64_tr_b16 a[78:79], v61 offset:3072
    ds_read_b64_tr_b16 a[80:81], v60 offset:8192
    ds_read_b64_tr_b16 a[82:83], v60 offset:9216
    s_add_u32 m0, s44, 57344
    s_add_u32 s63, s56, 917504
    buffer_load_dwordx4 v9, s[20:23], s63 offen lds
    ds_read_b64_tr_b16 a[84:85], v61 offset:8192
    ds_read_b64_tr_b16 a[86:87], v61 offset:9216
    ds_read_b64_tr_b16 a[88:89], v60 offset:10240
    ds_read_b64_tr_b16 a[90:91], v60 offset:11264
    ds_read_b64_tr_b16 a[92:93], v61 offset:10240
    ds_read_b64_tr_b16 a[94:95], v61 offset:11264
    s_add_u32 m0, s44, 61440
    s_add_u32 s63, s56, 4587520
    buffer_load_dwordx4 v9, s[20:23], s63 offen lds
    ds_read_b64_tr_b16 a[96:97], v60 offset:16384
    ds_read_b64_tr_b16 a[98:99], v60 offset:17408
    ds_read_b64_tr_b16 a[100:101], v61 offset:16384
    ds_read_b64_tr_b16 a[102:103], v61 offset:17408
    ds_read_b64_tr_b16 a[104:105], v60 offset:18432
    ds_read_b64_tr_b16 a[106:107], v60 offset:19456
    ds_read_b64_tr_b16 a[108:109], v61 offset:18432
    ds_read_b64_tr_b16 a[110:111], v61 offset:19456
    ds_read_b64_tr_b16 a[112:113], v60 offset:24576
    ds_read_b64_tr_b16 a[114:115], v60 offset:25600
    ds_read_b64_tr_b16 a[116:117], v61 offset:24576
    ds_read_b64_tr_b16 a[118:119], v61 offset:25600
    ds_read_b64_tr_b16 a[120:121], v60 offset:26624
    ds_read_b64_tr_b16 a[122:123], v60 offset:27648
    ds_read_b64_tr_b16 a[124:125], v61 offset:26624
    ds_read_b64_tr_b16 a[126:127], v61 offset:27648
    ds_read_b64_tr_b16 a[128:129], v60 offset:32768
    ds_read_b64_tr_b16 a[130:131], v60 offset:33792
    ds_read_b64_tr_b16 a[132:133], v61 offset:32768
    ds_read_b64_tr_b16 a[134:135], v61 offset:33792
    ds_read_b64_tr_b16 a[136:137], v60 offset:34816
    ds_read_b64_tr_b16 a[138:139], v60 offset:35840
    ds_read_b64_tr_b16 a[140:141], v61 offset:34816
    ds_read_b64_tr_b16 a[142:143], v61 offset:35840
    ds_read_b64_tr_b16 a[144:145], v60 offset:40960
    ds_read_b64_tr_b16 a[146:147], v60 offset:41984
    ds_read_b64_tr_b16 a[148:149], v61 offset:40960
    ds_read_b64_tr_b16 a[150:151], v61 offset:41984
    ds_read_b64_tr_b16 a[152:153], v60 offset:43008
    ds_read_b64_tr_b16 a[154:155], v60 offset:44032
    ds_read_b64_tr_b16 a[156:157], v61 offset:43008
    ds_read_b64_tr_b16 a[158:159], v61 offset:44032
    s_waitcnt vmcnt(9)
    s_waitcnt lgkmcnt(0)
    s_barrier
    s_cmp_lg_u32 s41, 0
    s_cbranch_scc1 pub_16
    s_lshl_b32 s60, s49, 5
    s_add_u32 s60, s60, s50
    s_mul_i32 s60, s60, 128
    s_add_u32 s60, s60, 131076
    v_lshlrev_b32 v62, 2, v1
    s_mov_b32 exec_hi, 0
    s_mov_b32 exec_lo, 0x00000001
    buffer_store_dword v26, v62, s[36:39], s60 offen sc1
    s_mov_b64 exec, -1
pub_16:
    s_branch p3end_14
p3skip_13:
    v_lshlrev_b32 v22, 12, v1
    s_and_b32 s60, s43, 3
    s_lshl_b32 s61, s42, 2
    s_add_u32 s60, s60, s61
    s_lshl_b32 s60, s60, 7
    s_mul_i32 s61, s51, 3670016
    s_add_u32 s60, s60, s61
    s_lshl_b32 s61, s52, 18
    s_add_u32 s60, s60, s61
    s_add_u32 s61, s60, 2097152
    buffer_load_dword v68, v22, s[20:23], s61 offen
    s_add_u32 s61, s60, 2621440
    buffer_load_dword v69, v22, s[20:23], s61 offen
    s_add_u32 s61, s60, 3145728
    buffer_load_dword v70, v22, s[20:23], s61 offen
    s_add_u32 m0, s44, 65536
    s_add_u32 s63, s56, 2359296
    buffer_load_dwordx4 v9, s[20:23], s63 offen lds
    s_add_u32 m0, s44, 69632
    s_add_u32 s63, s56, 6029312
    buffer_load_dwordx4 v9, s[20:23], s63 offen lds
    s_add_u32 m0, s44, 73728
    s_add_u32 s63, s56, 2490368
    buffer_load_dwordx4 v9, s[20:23], s63 offen lds
    s_add_u32 m0, s44, 77824
    s_add_u32 s63, s56, 6160384
    buffer_load_dwordx4 v9, s[20:23], s63 offen lds
    s_add_u32 m0, s44, 81920
    s_add_u32 s63, s56, 2621440
    buffer_load_dwordx4 v9, s[20:23], s63 offen lds
    s_add_u32 m0, s44, 86016
    s_add_u32 s63, s56, 6291456
    buffer_load_dwordx4 v9, s[20:23], s63 offen lds
    s_add_u32 m0, s44, 90112
    s_add_u32 s63, s56, 2752512
    buffer_load_dwordx4 v9, s[20:23], s63 offen lds
    s_add_u32 m0, s44, 94208
    s_add_u32 s63, s56, 6422528
    buffer_load_dwordx4 v9, s[20:23], s63 offen lds
    s_add_u32 m0, s44, 98304
    s_add_u32 s63, s56, 2883584
    buffer_load_dwordx4 v9, s[20:23], s63 offen lds
    s_add_u32 m0, s44, 102400
    s_add_u32 s63, s56, 6553600
    buffer_load_dwordx4 v9, s[20:23], s63 offen lds
    s_add_u32 m0, s44, 106496
    s_add_u32 s63, s56, 3014656
    buffer_load_dwordx4 v9, s[20:23], s63 offen lds
    s_add_u32 m0, s44, 110592
    s_add_u32 s63, s56, 6684672
    buffer_load_dwordx4 v9, s[20:23], s63 offen lds
    s_add_u32 m0, s44, 114688
    s_add_u32 s63, s56, 3145728
    buffer_load_dwordx4 v9, s[20:23], s63 offen lds
    s_add_u32 m0, s44, 118784
    s_add_u32 s63, s56, 6815744
    buffer_load_dwordx4 v9, s[20:23], s63 offen lds
    s_add_u32 m0, s44, 122880
    s_add_u32 s63, s56, 3276800
    buffer_load_dwordx4 v9, s[20:23], s63 offen lds
    s_add_u32 m0, s44, 126976
    s_add_u32 s63, s56, 6946816
    buffer_load_dwordx4 v9, s[20:23], s63 offen lds
    s_add_u32 m0, s44, 131072
    s_add_u32 s63, s56, 3407872
    buffer_load_dwordx4 v9, s[20:23], s63 offen lds
    s_add_u32 m0, s44, 135168
    s_add_u32 s63, s56, 7077888
    buffer_load_dwordx4 v9, s[20:23], s63 offen lds
    s_add_u32 m0, s44, 139264
    s_add_u32 s63, s56, 3538944
    buffer_load_dwordx4 v9, s[20:23], s63 offen lds
    s_add_u32 m0, s44, 143360
    s_add_u32 s63, s56, 7208960
    buffer_load_dwordx4 v9, s[20:23], s63 offen lds
    s_add_u32 s61, s60, 0
    buffer_load_dword v64, v22, s[20:23], s61 offen
    s_add_u32 s61, s60, 524288
    buffer_load_dword v65, v22, s[20:23], s61 offen
    s_waitcnt vmcnt(2)
    s_barrier
    ds_read_b64_tr_b16 a[0:1], v58 offset:16384
    ds_read_b64_tr_b16 a[2:3], v58 offset:17408
    ds_read_b64_tr_b16 a[4:5], v59 offset:16384
    ds_read_b64_tr_b16 a[6:7], v59 offset:17408
    ds_read_b64_tr_b16 a[8:9], v58 offset:18432
    ds_read_b64_tr_b16 a[10:11], v58 offset:19456
    ds_read_b64_tr_b16 a[12:13], v59 offset:18432
    ds_read_b64_tr_b16 a[14:15], v59 offset:19456
    ds_read_b64_tr_b16 a[16:17], v58 offset:24576
    ds_read_b64_tr_b16 a[18:19], v58 offset:25600
    ds_read_b64_tr_b16 a[20:21], v59 offset:24576
    ds_read_b64_tr_b16 a[22:23], v59 offset:25600
    ds_read_b64_tr_b16 a[24:25], v58 offset:26624
    ds_read_b64_tr_b16 a[26:27], v58 offset:27648
    ds_read_b64_tr_b16 a[28:29], v59 offset:26624
    ds_read_b64_tr_b16 a[30:31], v59 offset:27648
    ds_read_b64_tr_b16 a[32:33], v58 offset:32768
    ds_read_b64_tr_b16 a[34:35], v58 offset:33792
    ds_read_b64_tr_b16 a[36:37], v59 offset:32768
    ds_read_b64_tr_b16 a[38:39], v59 offset:33792
    ds_read_b64_tr_b16 a[40:41], v58 offset:34816
    ds_read_b64_tr_b16 a[42:43], v58 offset:35840
    ds_read_b64_tr_b16 a[44:45], v59 offset:34816
    ds_read_b64_tr_b16 a[46:47], v59 offset:35840
    ds_read_b64_tr_b16 a[48:49], v58 offset:40960
    ds_read_b64_tr_b16 a[50:51], v58 offset:41984
    ds_read_b64_tr_b16 a[52:53], v59 offset:40960
    ds_read_b64_tr_b16 a[54:55], v59 offset:41984
    ds_read_b64_tr_b16 a[56:57], v58 offset:43008
    ds_read_b64_tr_b16 a[58:59], v58 offset:44032
    ds_read_b64_tr_b16 a[60:61], v59 offset:43008
    ds_read_b64_tr_b16 a[62:63], v59 offset:44032
    ds_read_b64_tr_b16 a[64:65], v60 offset:0
    ds_read_b64_tr_b16 a[66:67], v60 offset:1024
    ds_read_b64_tr_b16 a[68:69], v61 offset:0
    ds_read_b64_tr_b16 a[70:71], v61 offset:1024
    ds_read_b64_tr_b16 a[72:73], v60 offset:2048
    ds_read_b64_tr_b16 a[74:75], v60 offset:3072
    ds_read_b64_tr_b16 a[76:77], v61 offset:2048
    ds_read_b64_tr_b16 a[78:79], v61 offset:3072
    ds_read_b64_tr_b16 a[80:81], v60 offset:8192
    ds_read_b64_tr_b16 a[82:83], v60 offset:9216
    ds_read_b64_tr_b16 a[84:85], v61 offset:8192
    ds_read_b64_tr_b16 a[86:87], v61 offset:9216
    ds_read_b64_tr_b16 a[88:89], v60 offset:10240
    ds_read_b64_tr_b16 a[90:91], v60 offset:11264
    ds_read_b64_tr_b16 a[92:93], v61 offset:10240
    ds_read_b64_tr_b16 a[94:95], v61 offset:11264
    ds_read_b64_tr_b16 a[96:97], v60 offset:16384
    ds_read_b64_tr_b16 a[98:99], v60 offset:17408
    ds_read_b64_tr_b16 a[100:101], v61 offset:16384
    ds_read_b64_tr_b16 a[102:103], v61 offset:17408
    ds_read_b64_tr_b16 a[104:105], v60 offset:18432
    ds_read_b64_tr_b16 a[106:107], v60 offset:19456
    ds_read_b64_tr_b16 a[108:109], v61 offset:18432
    ds_read_b64_tr_b16 a[110:111], v61 offset:19456
    ds_read_b64_tr_b16 a[112:113], v60 offset:24576
    ds_read_b64_tr_b16 a[114:115], v60 offset:25600
    ds_read_b64_tr_b16 a[116:117], v61 offset:24576
    ds_read_b64_tr_b16 a[118:119], v61 offset:25600
    ds_read_b64_tr_b16 a[120:121], v60 offset:26624
    ds_read_b64_tr_b16 a[122:123], v60 offset:27648
    ds_read_b64_tr_b16 a[124:125], v61 offset:26624
    ds_read_b64_tr_b16 a[126:127], v61 offset:27648
    ds_read_b64_tr_b16 a[128:129], v60 offset:32768
    ds_read_b64_tr_b16 a[130:131], v60 offset:33792
    ds_read_b64_tr_b16 a[132:133], v61 offset:32768
    ds_read_b64_tr_b16 a[134:135], v61 offset:33792
    ds_read_b64_tr_b16 a[136:137], v60 offset:34816
    ds_read_b64_tr_b16 a[138:139], v60 offset:35840
    ds_read_b64_tr_b16 a[140:141], v61 offset:34816
    ds_read_b64_tr_b16 a[142:143], v61 offset:35840
    ds_read_b64_tr_b16 a[144:145], v60 offset:40960
    ds_read_b64_tr_b16 a[146:147], v60 offset:41984
    ds_read_b64_tr_b16 a[148:149], v61 offset:40960
    ds_read_b64_tr_b16 a[150:151], v61 offset:41984
    ds_read_b64_tr_b16 a[152:153], v60 offset:43008
    ds_read_b64_tr_b16 a[154:155], v60 offset:44032
    ds_read_b64_tr_b16 a[156:157], v61 offset:43008
    ds_read_b64_tr_b16 a[158:159], v61 offset:44032
    s_add_u32 s61, s60, 1048576
    buffer_load_dword v66, v22, s[20:23], s61 offen
    s_add_u32 s61, s60, 1572864
    buffer_load_dword v67, v22, s[20:23], s61 offen
    s_add_u32 m0, s44, 0
    s_add_u32 s63, s56, 0
    buffer_load_dwordx4 v9, s[20:23], s63 offen lds
    s_add_u32 m0, s44, 4096
    s_add_u32 s63, s56, 3670016
    buffer_load_dwordx4 v9, s[20:23], s63 offen lds
    s_add_u32 m0, s44, 8192
    s_add_u32 s63, s56, 131072
    buffer_load_dwordx4 v9, s[20:23], s63 offen lds
    s_add_u32 m0, s44, 12288
    s_add_u32 s63, s56, 3801088
    buffer_load_dwordx4 v9, s[20:23], s63 offen lds
    s_add_u32 m0, s44, 16384
    s_add_u32 s63, s56, 262144
    buffer_load_dwordx4 v9, s[20:23], s63 offen lds
    s_add_u32 m0, s44, 20480
    s_add_u32 s63, s56, 3932160
    buffer_load_dwordx4 v9, s[20:23], s63 offen lds
    s_add_u32 m0, s44, 24576
    s_add_u32 s63, s56, 393216
    buffer_load_dwordx4 v9, s[20:23], s63 offen lds
    s_add_u32 m0, s44, 28672
    s_add_u32 s63, s56, 4063232
    buffer_load_dwordx4 v9, s[20:23], s63 offen lds
    s_add_u32 m0, s44, 32768
    s_add_u32 s63, s56, 524288
    buffer_load_dwordx4 v9, s[20:23], s63 offen lds
    s_add_u32 m0, s44, 36864
    s_add_u32 s63, s56, 4194304
    buffer_load_dwordx4 v9, s[20:23], s63 offen lds
    s_add_u32 m0, s44, 40960
    s_add_u32 s63, s56, 655360
    buffer_load_dwordx4 v9, s[20:23], s63 offen lds
    s_add_u32 m0, s44, 45056
    s_add_u32 s63, s56, 4325376
    buffer_load_dwordx4 v9, s[20:23], s63 offen lds
    s_add_u32 m0, s44, 49152
    s_add_u32 s63, s56, 786432
    buffer_load_dwordx4 v9, s[20:23], s63 offen lds
    s_add_u32 m0, s44, 53248
    s_add_u32 s63, s56, 4456448
    buffer_load_dwordx4 v9, s[20:23], s63 offen lds
    s_add_u32 m0, s44, 57344
    s_add_u32 s63, s56, 917504
    buffer_load_dwordx4 v9, s[20:23], s63 offen lds
    s_add_u32 m0, s44, 61440
    s_add_u32 s63, s56, 4587520
    buffer_load_dwordx4 v9, s[20:23], s63 offen lds
    s_waitcnt lgkmcnt(0)
    s_barrier
p3end_14:
    s_lshl_b32 s60, s51, 6
    s_add_u32 s60, s60, s56
    v_and_b32 v22, 31, v1
    v_lshlrev_b32 v22, 1, v22
    buffer_load_ushort v48, v22, s[28:31], s60 offen
    s_lshl_b32 s3, s43, 2
    s_add_u32 s3, s3, s41
    s_mul_i32 s60, s3, 12288
    s_add_u32 s60, s60, 384
    v_lshlrev_b32 v23, 10, v1
    s_mov_b64 exec, 0xfff
    buffer_load_dword v53, v23, s[8:11], s60 offen
    s_mov_b64 exec, -1
    s_lshl_b32 s60, s47, 2
    s_add_u32 s60, s60, s41
    s_lshl_b32 s60, s60, 11
    s_lshl_b32 s61, s48, 18
    s_add_u32 s60, s60, s61
    s_add_u32 s60, s60, 6291456
    v_lshlrev_b32 v23, 7, v1
    s_mov_b64 exec, 0xffff
    buffer_load_dword v49, v23, s[36:39], s60 offen
    s_lshl_b32 s60, s47, 3
    s_add_u32 s60, s60, s48
    s_mul_i32 s60, s60, 128
    s_add_u32 s60, s60, 65540
    s_mov_b64 exec, 1
    buffer_load_dword v51, v21, s[36:39], s60 offen
    s_lshl_b32 s60, s47, 3
    s_add_u32 s60, s60, s48
    s_lshl_b32 s60, s60, 2
    s_add_u32 s60, s60, s41
    s_lshl_b32 s60, s60, 8
    s_add_u32 s60, s60, 1048576
    s_mov_b64 exec, 3
    buffer_load_dword v52, v21, s[36:39], s60 offen
    s_mov_b64 exec, -1
    s_lshl_b32 s72, s48, 1
    s_add_u32 s72, s72, s52
    s_lshl_b32 s72, s72, 1
    s_add_u32 s72, s72, s51
    s_mul_i32 s72, s72, 57344
    s_add_u32 s72, s72, 10485760
    s_add_u32 m0, s44, 65536
    s_add_u32 s63, s56, 1048576
    buffer_load_dwordx4 v9, s[20:23], s63 offen lds
    s_add_u32 m0, s44, 69632
    s_add_u32 s63, s56, 4718592
    buffer_load_dwordx4 v9, s[20:23], s63 offen lds
    s_add_u32 m0, s44, 73728
    s_add_u32 s63, s56, 1179648
    buffer_load_dwordx4 v9, s[20:23], s63 offen lds
    s_add_u32 m0, s44, 77824
    s_add_u32 s63, s56, 4849664
    buffer_load_dwordx4 v9, s[20:23], s63 offen lds
    s_add_u32 m0, s44, 81920
    s_add_u32 s63, s56, 1310720
    buffer_load_dwordx4 v9, s[20:23], s63 offen lds
    s_add_u32 m0, s44, 86016
    s_add_u32 s63, s56, 4980736
    buffer_load_dwordx4 v9, s[20:23], s63 offen lds
    s_add_u32 m0, s44, 90112
    s_add_u32 s63, s56, 1441792
    buffer_load_dwordx4 v9, s[20:23], s63 offen lds
    s_add_u32 m0, s44, 94208
    s_add_u32 s63, s56, 5111808
    buffer_load_dwordx4 v9, s[20:23], s63 offen lds
    s_add_u32 m0, s44, 98304
    s_add_u32 s63, s56, 1572864
    buffer_load_dwordx4 v9, s[20:23], s63 offen lds
    s_add_u32 m0, s44, 102400
    s_add_u32 s63, s56, 5242880
    buffer_load_dwordx4 v9, s[20:23], s63 offen lds
    s_lshl_b32 s74, s48, 5
    s_mul_i32 s3, s51, 14
    s_add_u32 s74, s74, s3
    s_mul_i32 s74, s74, 128
    s_add_u32 s74, s74, 131076
    v_min_u32 v23, 13, v3
    v_mul_u32_u24 v62, 128, v23
    buffer_load_dword v63, v62, s[36:39], s74 offen sc1
    s_add_u32 m0, s44, 106496
    s_add_u32 s63, s56, 1703936
    buffer_load_dwordx4 v9, s[20:23], s63 offen lds
    s_add_u32 m0, s44, 110592
    s_add_u32 s63, s56, 5373952
    buffer_load_dwordx4 v9, s[20:23], s63 offen lds
    s_add_u32 m0, s44, 114688
    s_add_u32 s63, s56, 1835008
    buffer_load_dwordx4 v9, s[20:23], s63 offen lds
    s_add_u32 m0, s44, 118784
    s_add_u32 s63, s56, 5505024
    buffer_load_dwordx4 v9, s[20:23], s63 offen lds
    s_add_u32 m0, s44, 122880
    s_add_u32 s63, s56, 1966080
    buffer_load_dwordx4 v9, s[20:23], s63 offen lds
    s_add_u32 m0, s44, 126976
    s_add_u32 s63, s56, 5636096
    buffer_load_dwordx4 v9, s[20:23], s63 offen lds
    s_add_u32 m0, s44, 131072
    s_add_u32 s63, s56, 2097152
    buffer_load_dwordx4 v9, s[20:23], s63 offen lds
    s_add_u32 m0, s44, 135168
    s_add_u32 s63, s56, 5767168
    buffer_load_dwordx4 v9, s[20:23], s63 offen lds
    s_add_u32 m0, s44, 139264
    s_add_u32 s63, s56, 2228224
    buffer_load_dwordx4 v9, s[20:23], s63 offen lds
    s_add_u32 m0, s44, 143360
    s_add_u32 s63, s56, 5898240
    buffer_load_dwordx4 v9, s[20:23], s63 offen lds
    s_waitcnt vmcnt(10)
    s_mov_b32 s70, 30000
chk_17:
    v_cmp_ne_u32 vcc, v63, v26
    s_nop 3
    s_and_b64 vcc, vcc, 0x0000ffff
    s_cbranch_scc0 chk_17_d
    buffer_load_dword v63, v62, s[36:39], s74 offen sc1
    s_waitcnt vmcnt(0)
    s_sub_u32 s70, s70, 1
    s_cmp_lg_u32 s70, 0
    s_cbranch_scc1 chk_17
chk_17_d:
    s_add_u32 s82, s72, 49152
    buffer_load_dwordx4 v[128:131], v4, s[36:39], s82 offen offset:0 sc1
    buffer_load_dwordx4 v[132:135], v4, s[36:39], s82 offen offset:1024 sc1
    buffer_load_dwordx4 v[136:139], v4, s[36:39], s82 offen offset:2048 sc1
    buffer_load_dwordx4 v[140:143], v4, s[36:39], s82 offen offset:3072 sc1
    s_add_u32 s82, s72, 53248
    buffer_load_dwordx4 v[144:147], v4, s[36:39], s82 offen offset:0 sc1
    buffer_load_dwordx4 v[148:151], v4, s[36:39], s82 offen offset:1024 sc1
    buffer_load_dwordx4 v[152:155], v4, s[36:39], s82 offen offset:2048 sc1
    buffer_load_dwordx4 v[156:159], v4, s[36:39], s82 offen offset:3072 sc1
    s_add_u32 s82, s72, 0
    buffer_load_dwordx4 v[160:163], v4, s[36:39], s82 offen offset:0 sc1
    buffer_load_dwordx4 v[164:167], v4, s[36:39], s82 offen offset:1024 sc1
    buffer_load_dwordx4 v[168:171], v4, s[36:39], s82 offen offset:2048 sc1
    buffer_load_dwordx4 v[172:175], v4, s[36:39], s82 offen offset:3072 sc1
    s_add_u32 s82, s72, 4096
    buffer_load_dwordx4 v[176:179], v4, s[36:39], s82 offen offset:0 sc1
    buffer_load_dwordx4 v[180:183], v4, s[36:39], s82 offen offset:1024 sc1
    v_lshlrev_b32 v48, 16, v48
    v_lshlrev_b32 v64, 16, v32
    v_and_b32 v65, 0xffff0000, v32
    v_lshlrev_b32 v66, 16, v33
    v_and_b32 v67, 0xffff0000, v33
    v_lshlrev_b32 v68, 16, v34
    v_and_b32 v69, 0xffff0000, v34
    v_lshlrev_b32 v70, 16, v35
    v_and_b32 v71, 0xffff0000, v35
    v_lshlrev_b32 v72, 16, v36
    v_and_b32 v73, 0xffff0000, v36
    v_lshlrev_b32 v74, 16, v37
    v_and_b32 v75, 0xffff0000, v37
    v_lshlrev_b32 v76, 16, v38
    v_and_b32 v77, 0xffff0000, v38
    v_lshlrev_b32 v78, 16, v39
    v_and_b32 v79, 0xffff0000, v39
    v_pk_add_f32 v[64:65], v[64:65], v[48:49] op_sel_hi:[1,0]
    v_pk_add_f32 v[66:67], v[66:67], v[48:49] op_sel_hi:[1,0]
    v_pk_add_f32 v[68:69], v[68:69], v[48:49] op_sel_hi:[1,0]
    v_pk_add_f32 v[70:71], v[70:71], v[48:49] op_sel_hi:[1,0]
    v_pk_add_f32 v[72:73], v[72:73], v[48:49] op_sel_hi:[1,0]
    v_pk_add_f32 v[74:75], v[74:75], v[48:49] op_sel_hi:[1,0]
    v_pk_add_f32 v[76:77], v[76:77], v[48:49] op_sel_hi:[1,0]
    v_pk_add_f32 v[78:79], v[78:79], v[48:49] op_sel_hi:[1,0]
    s_lshl_b32 s60, s47, 1
    s_add_u32 s60, s60, s51
    v_lshrrev_b32 v25, 5, v1
    s_lshl_b32 s61, s48, 1
    s_add_u32 s61, s61, s52
    s_lshl_b32 s73, s60, 12
    s_lshl_b32 s3, s61, 3
    s_add_u32 s73, s73, s3
    s_add_u32 s73, s73, 1048576
    v_and_b32 v50, 31, v1
    v_lshlrev_b32 v50, 7, v50
    v_lshl_add_u32 v50, v25, 2, v50
    s_lshl_b32 s60, s60, 12
    s_lshl_b32 s61, s61, 10
    s_lshl_b32 s3, s48, 18
    s_add_u32 s60, s60, s3
    s_lshl_b32 s3, s52, 10
    s_add_u32 s60, s60, s3
    s_add_u32 s60, s60, 6291456
    v_and_b32 v24, 1, v2
    v_lshlrev_b32 v24, 11, v24
    v_lshl_add_u32 v24, v25, 8, v24
    v_lshl_add_u32 v24, v3, 4, v24
    s_lshl_b32 s62, s41, 12
    s_add_u32 s62, s62, 147456
    v_add_u32 v22, s62, v4
    v_xor_b32 v23, 8192, v22
    s_waitcnt vmcnt(13)
    v_mfma_f32_32x32x16_bf16 v[64:79], v[128:131], a[96:99], v[64:79]
    buffer_load_dwordx4 v[184:187], v4, s[36:39], s82 offen offset:2048 sc1
    v_mfma_f32_32x32x16_bf16 v[80:95], v[128:131], a[100:103], 0
    s_waitcnt vmcnt(13)
    v_mfma_f32_32x32x16_bf16 v[64:79], v[132:135], a[104:107], v[64:79]
    buffer_load_dwordx4 v[188:191], v4, s[36:39], s82 offen offset:3072 sc1
    v_mfma_f32_32x32x16_bf16 v[80:95], v[132:135], a[108:111], v[80:95]
    s_waitcnt vmcnt(13)
    v_mfma_f32_32x32x16_bf16 v[64:79], v[136:139], a[112:115], v[64:79]
    s_add_u32 s82, s72, 8192
    buffer_load_dwordx4 v[192:195], v4, s[36:39], s82 offen offset:0 sc1
    v_mfma_f32_32x32x16_bf16 v[80:95], v[136:139], a[116:119], v[80:95]
    s_waitcnt vmcnt(13)
    v_mfma_f32_32x32x16_bf16 v[64:79], v[140:143], a[120:123], v[64:79]
    buffer_load_dwordx4 v[196:199], v4, s[36:39], s82 offen offset:1024 sc1
    v_mfma_f32_32x32x16_bf16 v[80:95], v[140:143], a[124:127], v[80:95]
    s_waitcnt vmcnt(13)
    v_mfma_f32_32x32x16_bf16 v[64:79], v[144:147], a[128:131], v[64:79]
    buffer_load_dwordx4 v[200:203], v4, s[36:39], s82 offen offset:2048 sc1
    v_mfma_f32_32x32x16_bf16 v[80:95], v[144:147], a[132:135], v[80:95]
    s_waitcnt vmcnt(13)
    v_mfma_f32_32x32x16_bf16 v[64:79], v[148:151], a[136:139], v[64:79]
    s_barrier
    ds_read_b64_tr_b16 v[96:97], v56 offset:0
    ds_read_b64_tr_b16 v[98:99], v56 offset:1024
    buffer_load_dwordx4 v[204:207], v4, s[36:39], s82 offen offset:3072 sc1
    v_mfma_f32_32x32x16_bf16 v[80:95], v[148:151], a[140:143], v[80:95]
    ds_read_b64_tr_b16 v[100:101], v57 offset:0
    ds_read_b64_tr_b16 v[102:103], v57 offset:1024
    s_waitcnt vmcnt(13)
    v_mfma_f32_32x32x16_bf16 v[64:79], v[152:155], a[144:147], v[64:79]
    ds_read_b64_tr_b16 v[104:105], v56 offset:2048
    ds_read_b64_tr_b16 v[106:107], v56 offset:3072
    s_add_u32 s82, s72, 12288
    buffer_load_dwordx4 v[208:211], v4, s[36:39], s82 offen offset:0 sc1
    v_mfma_f32_32x32x16_bf16 v[80:95], v[152:155], a[148:151], v[80:95]
    ds_read_b64_tr_b16 v[108:109], v57 offset:2048
    ds_read_b64_tr_b16 v[110:111], v57 offset:3072
    s_waitcnt vmcnt(13)
    v_mfma_f32_32x32x16_bf16 v[64:79], v[156:159], a[152:155], v[64:79]
    ds_read_b64_tr_b16 v[112:113], v56 offset:8192
    ds_read_b64_tr_b16 v[114:115], v56 offset:9216
    buffer_load_dwordx4 v[212:215], v4, s[36:39], s82 offen offset:1024 sc1
    v_mfma_f32_32x32x16_bf16 v[80:95], v[156:159], a[156:159], v[80:95]
    ds_read_b64_tr_b16 v[116:117], v57 offset:8192
    ds_read_b64_tr_b16 v[118:119], v57 offset:9216
    s_waitcnt vmcnt(13) lgkmcnt(10)
    v_mfma_f32_32x32x16_bf16 v[64:79], v[160:163], v[96:99], v[64:79]
    ds_read_b64_tr_b16 v[120:121], v56 offset:10240
    ds_read_b64_tr_b16 v[122:123], v56 offset:11264
    buffer_load_dwordx4 v[216:219], v4, s[36:39], s82 offen offset:2048 sc1
    s_waitcnt lgkmcnt(10)
    v_mfma_f32_32x32x16_bf16 v[80:95], v[160:163], v[100:103], v[80:95]
    ds_read_b64_tr_b16 v[124:125], v57 offset:10240
    ds_read_b64_tr_b16 v[126:127], v57 offset:11264
    s_waitcnt vmcnt(13) lgkmcnt(10)
    v_mfma_f32_32x32x16_bf16 v[64:79], v[164:167], v[104:107], v[64:79]
    ds_read_b64_tr_b16 v[96:97], v56 offset:16384
    ds_read_b64_tr_b16 v[98:99], v56 offset:17408
    buffer_load_dwordx4 v[220:223], v4, s[36:39], s82 offen offset:3072 sc1
    s_waitcnt lgkmcnt(10)
    v_mfma_f32_32x32x16_bf16 v[80:95], v[164:167], v[108:111], v[80:95]
    ds_read_b64_tr_b16 v[100:101], v57 offset:16384
    ds_read_b64_tr_b16 v[102:103], v57 offset:17408
    s_waitcnt vmcnt(13) lgkmcnt(10)
    v_mfma_f32_32x32x16_bf16 v[64:79], v[168:171], v[112:115], v[64:79]
    ds_read_b64_tr_b16 v[104:105], v56 offset:18432
    ds_read_b64_tr_b16 v[106:107], v56 offset:19456
    s_add_u32 s82, s72, 16384
    buffer_load_dwordx4 v[224:227], v4, s[36:39], s82 offen offset:0 sc1
    s_waitcnt lgkmcnt(10)
    v_mfma_f32_32x32x16_bf16 v[80:95], v[168:171], v[116:119], v[80:95]
    ds_read_b64_tr_b16 v[108:109], v57 offset:18432
    ds_read_b64_tr_b16 v[110:111], v57 offset:19456
    s_waitcnt vmcnt(13) lgkmcnt(10)
    v_mfma_f32_32x32x16_bf16 v[64:79], v[172:175], v[120:123], v[64:79]
    ds_read_b64_tr_b16 v[112:113], v56 offset:24576
    ds_read_b64_tr_b16 v[114:115], v56 offset:25600
    buffer_load_dwordx4 v[228:231], v4, s[36:39], s82 offen offset:1024 sc1
    s_waitcnt lgkmcnt(10)
    v_mfma_f32_32x32x16_bf16 v[80:95], v[172:175], v[124:127], v[80:95]
    ds_read_b64_tr_b16 v[116:117], v57 offset:24576
    ds_read_b64_tr_b16 v[118:119], v57 offset:25600
    s_waitcnt vmcnt(13) lgkmcnt(10)
    v_mfma_f32_32x32x16_bf16 v[64:79], v[176:179], v[96:99], v[64:79]
    ds_read_b64_tr_b16 v[120:121], v56 offset:26624
    ds_read_b64_tr_b16 v[122:123], v56 offset:27648
    buffer_load_dwordx4 v[128:131], v4, s[36:39], s82 offen offset:2048 sc1
    s_waitcnt lgkmcnt(10)
    v_mfma_f32_32x32x16_bf16 v[80:95], v[176:179], v[100:103], v[80:95]
    ds_read_b64_tr_b16 v[124:125], v57 offset:26624
    ds_read_b64_tr_b16 v[126:127], v57 offset:27648
    s_waitcnt vmcnt(13) lgkmcnt(10)
    v_mfma_f32_32x32x16_bf16 v[64:79], v[180:183], v[104:107], v[64:79]
    ds_read_b64_tr_b16 v[96:97], v56 offset:32768
    ds_read_b64_tr_b16 v[98:99], v56 offset:33792
    buffer_load_dwordx4 v[132:135], v4, s[36:39], s82 offen offset:3072 sc1
    s_waitcnt lgkmcnt(10)
    v_mfma_f32_32x32x16_bf16 v[80:95], v[180:183], v[108:111], v[80:95]
    ds_read_b64_tr_b16 v[100:101], v57 offset:32768
    ds_read_b64_tr_b16 v[102:103], v57 offset:33792
    s_waitcnt vmcnt(13) lgkmcnt(10)
    v_mfma_f32_32x32x16_bf16 v[64:79], v[184:187], v[112:115], v[64:79]
    ds_read_b64_tr_b16 v[104:105], v56 offset:34816
    ds_read_b64_tr_b16 v[106:107], v56 offset:35840
    s_add_u32 s82, s72, 20480
    buffer_load_dwordx4 v[136:139], v4, s[36:39], s82 offen offset:0 sc1
    s_waitcnt lgkmcnt(10)
    v_mfma_f32_32x32x16_bf16 v[80:95], v[184:187], v[116:119], v[80:95]
    ds_read_b64_tr_b16 v[108:109], v57 offset:34816
    ds_read_b64_tr_b16 v[110:111], v57 offset:35840
    s_waitcnt vmcnt(13) lgkmcnt(10)
    v_mfma_f32_32x32x16_bf16 v[64:79], v[188:191], v[120:123], v[64:79]
    ds_read_b64_tr_b16 v[112:113], v56 offset:40960
    ds_read_b64_tr_b16 v[114:115], v56 offset:41984
    buffer_load_dwordx4 v[140:143], v4, s[36:39], s82 offen offset:1024 sc1
    s_waitcnt lgkmcnt(10)
    v_mfma_f32_32x32x16_bf16 v[80:95], v[188:191], v[124:127], v[80:95]
    ds_read_b64_tr_b16 v[116:117], v57 offset:40960
    ds_read_b64_tr_b16 v[118:119], v57 offset:41984
    s_waitcnt vmcnt(13) lgkmcnt(10)
    v_mfma_f32_32x32x16_bf16 v[64:79], v[192:195], v[96:99], v[64:79]
    ds_read_b64_tr_b16 v[120:121], v56 offset:43008
    ds_read_b64_tr_b16 v[122:123], v56 offset:44032
    buffer_load_dwordx4 v[144:147], v4, s[36:39], s82 offen offset:2048 sc1
    s_waitcnt lgkmcnt(10)
    v_mfma_f32_32x32x16_bf16 v[80:95], v[192:195], v[100:103], v[80:95]
    ds_read_b64_tr_b16 v[124:125], v57 offset:43008
    ds_read_b64_tr_b16 v[126:127], v57 offset:44032
    s_waitcnt vmcnt(13) lgkmcnt(10)
    v_mfma_f32_32x32x16_bf16 v[64:79], v[196:199], v[104:107], v[64:79]
    ds_read_b64_tr_b16 v[96:97], v58 offset:0
    ds_read_b64_tr_b16 v[98:99], v58 offset:1024
    buffer_load_dwordx4 v[148:151], v4, s[36:39], s82 offen offset:3072 sc1
    s_waitcnt lgkmcnt(10)
    v_mfma_f32_32x32x16_bf16 v[80:95], v[196:199], v[108:111], v[80:95]
    ds_read_b64_tr_b16 v[100:101], v59 offset:0
    ds_read_b64_tr_b16 v[102:103], v59 offset:1024
    s_waitcnt vmcnt(13) lgkmcnt(10)
    v_mfma_f32_32x32x16_bf16 v[64:79], v[200:203], v[112:115], v[64:79]
    ds_read_b64_tr_b16 v[104:105], v58 offset:2048
    ds_read_b64_tr_b16 v[106:107], v58 offset:3072
    s_add_u32 s82, s72, 24576
    buffer_load_dwordx4 v[152:155], v4, s[36:39], s82 offen offset:0 sc1
    s_waitcnt lgkmcnt(10)
    v_mfma_f32_32x32x16_bf16 v[80:95], v[200:203], v[116:119], v[80:95]
    ds_read_b64_tr_b16 v[108:109], v59 offset:2048
    ds_read_b64_tr_b16 v[110:111], v59 offset:3072
    s_waitcnt vmcnt(13) lgkmcnt(10)
    v_mfma_f32_32x32x16_bf16 v[64:79], v[204:207], v[120:123], v[64:79]
    ds_read_b64_tr_b16 v[112:113], v58 offset:8192
    ds_read_b64_tr_b16 v[114:115], v58 offset:9216
    buffer_load_dwordx4 v[156:159], v4, s[36:39], s82 offen offset:1024 sc1
    s_waitcnt lgkmcnt(10)
    v_mfma_f32_32x32x16_bf16 v[80:95], v[204:207], v[124:127], v[80:95]
    ds_read_b64_tr_b16 v[116:117], v59 offset:8192
    ds_read_b64_tr_b16 v[118:119], v59 offset:9216
    s_waitcnt vmcnt(13) lgkmcnt(10)
    v_mfma_f32_32x32x16_bf16 v[64:79], v[208:211], v[96:99], v[64:79]
    ds_read_b64_tr_b16 v[120:121], v58 offset:10240
    ds_read_b64_tr_b16 v[122:123], v58 offset:11264
    buffer_load_dwordx4 v[160:163], v4, s[36:39], s82 offen offset:2048 sc1
    s_waitcnt lgkmcnt(10)
    v_mfma_f32_32x32x16_bf16 v[80:95], v[208:211], v[100:103], v[80:95]
    ds_read_b64_tr_b16 v[124:125], v59 offset:10240
    ds_read_b64_tr_b16 v[126:127], v59 offset:11264
    s_waitcnt vmcnt(13) lgkmcnt(10)
    v_mfma_f32_32x32x16_bf16 v[64:79], v[212:215], v[104:107], v[64:79]
    ds_read_b64_tr_b16 v[96:97], v58 offset:16384
    ds_read_b64_tr_b16 v[98:99], v58 offset:17408
    buffer_load_dwordx4 v[164:167], v4, s[36:39], s82 offen offset:3072 sc1
    s_waitcnt lgkmcnt(10)
    v_mfma_f32_32x32x16_bf16 v[80:95], v[212:215], v[108:111], v[80:95]
    ds_read_b64_tr_b16 v[100:101], v59 offset:16384
    ds_read_b64_tr_b16 v[102:103], v59 offset:17408
    s_waitcnt vmcnt(13) lgkmcnt(10)
    v_mfma_f32_32x32x16_bf16 v[64:79], v[216:219], v[112:115], v[64:79]
    ds_read_b64_tr_b16 v[104:105], v58 offset:18432
    ds_read_b64_tr_b16 v[106:107], v58 offset:19456
    s_add_u32 s82, s72, 28672
    buffer_load_dwordx4 v[168:171], v4, s[36:39], s82 offen offset:0 sc1
    s_waitcnt lgkmcnt(10)
    v_mfma_f32_32x32x16_bf16 v[80:95], v[216:219], v[116:119], v[80:95]
    ds_read_b64_tr_b16 v[108:109], v59 offset:18432
    ds_read_b64_tr_b16 v[110:111], v59 offset:19456
    s_waitcnt vmcnt(13) lgkmcnt(10)
    v_mfma_f32_32x32x16_bf16 v[64:79], v[220:223], v[120:123], v[64:79]
    ds_read_b64_tr_b16 v[112:113], v58 offset:24576
    ds_read_b64_tr_b16 v[114:115], v58 offset:25600
    buffer_load_dwordx4 v[172:175], v4, s[36:39], s82 offen offset:1024 sc1
    s_waitcnt lgkmcnt(10)
    v_mfma_f32_32x32x16_bf16 v[80:95], v[220:223], v[124:127], v[80:95]
    ds_read_b64_tr_b16 v[116:117], v59 offset:24576
    ds_read_b64_tr_b16 v[118:119], v59 offset:25600
    s_waitcnt vmcnt(13) lgkmcnt(10)
    v_mfma_f32_32x32x16_bf16 v[64:79], v[224:227], v[96:99], v[64:79]
    ds_read_b64_tr_b16 v[120:121], v58 offset:26624
    ds_read_b64_tr_b16 v[122:123], v58 offset:27648
    buffer_load_dwordx4 v[176:179], v4, s[36:39], s82 offen offset:2048 sc1
    s_waitcnt lgkmcnt(10)
    v_mfma_f32_32x32x16_bf16 v[80:95], v[224:227], v[100:103], v[80:95]
    ds_read_b64_tr_b16 v[124:125], v59 offset:26624
    ds_read_b64_tr_b16 v[126:127], v59 offset:27648
    s_waitcnt vmcnt(13) lgkmcnt(10)
    v_mfma_f32_32x32x16_bf16 v[64:79], v[228:231], v[104:107], v[64:79]
    ds_read_b64_tr_b16 v[96:97], v58 offset:32768
    ds_read_b64_tr_b16 v[98:99], v58 offset:33792
    buffer_load_dwordx4 v[180:183], v4, s[36:39], s82 offen offset:3072 sc1
    s_waitcnt lgkmcnt(10)
    v_mfma_f32_32x32x16_bf16 v[80:95], v[228:231], v[108:111], v[80:95]
    ds_read_b64_tr_b16 v[100:101], v59 offset:32768
    ds_read_b64_tr_b16 v[102:103], v59 offset:33792
    s_waitcnt vmcnt(13) lgkmcnt(10)
    v_mfma_f32_32x32x16_bf16 v[64:79], v[128:131], v[112:115], v[64:79]
    ds_read_b64_tr_b16 v[104:105], v58 offset:34816
    ds_read_b64_tr_b16 v[106:107], v58 offset:35840
    s_add_u32 s82, s72, 32768
    buffer_load_dwordx4 v[184:187], v4, s[36:39], s82 offen offset:0 sc1
    s_waitcnt lgkmcnt(10)
    v_mfma_f32_32x32x16_bf16 v[80:95], v[128:131], v[116:119], v[80:95]
    ds_read_b64_tr_b16 v[108:109], v59 offset:34816
    ds_read_b64_tr_b16 v[110:111], v59 offset:35840
    s_waitcnt vmcnt(13) lgkmcnt(10)
    v_mfma_f32_32x32x16_bf16 v[64:79], v[132:135], v[120:123], v[64:79]
    ds_read_b64_tr_b16 v[112:113], v58 offset:40960
    ds_read_b64_tr_b16 v[114:115], v58 offset:41984
    buffer_load_dwordx4 v[188:191], v4, s[36:39], s82 offen offset:1024 sc1
    s_waitcnt lgkmcnt(10)
    v_mfma_f32_32x32x16_bf16 v[80:95], v[132:135], v[124:127], v[80:95]
    ds_read_b64_tr_b16 v[116:117], v59 offset:40960
    ds_read_b64_tr_b16 v[118:119], v59 offset:41984
    s_waitcnt vmcnt(13) lgkmcnt(10)
    v_mfma_f32_32x32x16_bf16 v[64:79], v[136:139], v[96:99], v[64:79]
    ds_read_b64_tr_b16 v[120:121], v58 offset:43008
    ds_read_b64_tr_b16 v[122:123], v58 offset:44032
    buffer_load_dwordx4 v[192:195], v4, s[36:39], s82 offen offset:2048 sc1
    s_waitcnt lgkmcnt(10)
    v_mfma_f32_32x32x16_bf16 v[80:95], v[136:139], v[100:103], v[80:95]
    ds_read_b64_tr_b16 v[124:125], v59 offset:43008
    ds_read_b64_tr_b16 v[126:127], v59 offset:44032
    s_waitcnt vmcnt(13) lgkmcnt(10)
    v_mfma_f32_32x32x16_bf16 v[64:79], v[140:143], v[104:107], v[64:79]
    ds_read_b64_tr_b16 v[96:97], v60 offset:0
    ds_read_b64_tr_b16 v[98:99], v60 offset:1024
    buffer_load_dwordx4 v[196:199], v4, s[36:39], s82 offen offset:3072 sc1
    s_waitcnt lgkmcnt(10)
    v_mfma_f32_32x32x16_bf16 v[80:95], v[140:143], v[108:111], v[80:95]
    ds_read_b64_tr_b16 v[100:101], v61 offset:0
    ds_read_b64_tr_b16 v[102:103], v61 offset:1024
    s_waitcnt vmcnt(13) lgkmcnt(10)
    v_mfma_f32_32x32x16_bf16 v[64:79], v[144:147], v[112:115], v[64:79]
    ds_read_b64_tr_b16 v[104:105], v60 offset:2048
    ds_read_b64_tr_b16 v[106:107], v60 offset:3072
    s_add_u32 s82, s72, 36864
    buffer_load_dwordx4 v[200:203], v4, s[36:39], s82 offen offset:0 sc1
    s_waitcnt lgkmcnt(10)
    v_mfma_f32_32x32x16_bf16 v[80:95], v[144:147], v[116:119], v[80:95]
    ds_read_b64_tr_b16 v[108:109], v61 offset:2048
    ds_read_b64_tr_b16 v[110:111], v61 offset:3072
    s_waitcnt vmcnt(13) lgkmcnt(10)
    v_mfma_f32_32x32x16_bf16 v[64:79], v[148:151], v[120:123], v[64:79]
    ds_read_b64_tr_b16 v[112:113], v60 offset:8192
    ds_read_b64_tr_b16 v[114:115], v60 offset:9216
    buffer_load_dwordx4 v[204:207], v4, s[36:39], s82 offen offset:1024 sc1
    s_waitcnt lgkmcnt(10)
    v_mfma_f32_32x32x16_bf16 v[80:95], v[148:151], v[124:127], v[80:95]
    ds_read_b64_tr_b16 v[116:117], v61 offset:8192
    ds_read_b64_tr_b16 v[118:119], v61 offset:9216
    s_waitcnt vmcnt(13) lgkmcnt(10)
    v_mfma_f32_32x32x16_bf16 v[64:79], v[152:155], v[96:99], v[64:79]
    ds_read_b64_tr_b16 v[120:121], v60 offset:10240
    ds_read_b64_tr_b16 v[122:123], v60 offset:11264
    buffer_load_dwordx4 v[208:211], v4, s[36:39], s82 offen offset:2048 sc1
    s_waitcnt lgkmcnt(10)
    v_mfma_f32_32x32x16_bf16 v[80:95], v[152:155], v[100:103], v[80:95]
    ds_read_b64_tr_b16 v[124:125], v61 offset:10240
    ds_read_b64_tr_b16 v[126:127], v61 offset:11264
    s_waitcnt vmcnt(13) lgkmcnt(10)
    v_mfma_f32_32x32x16_bf16 v[64:79], v[156:159], v[104:107], v[64:79]
    ds_read_b64_tr_b16 v[96:97], v60 offset:16384
    ds_read_b64_tr_b16 v[98:99], v60 offset:17408
    buffer_load_dwordx4 v[212:215], v4, s[36:39], s82 offen offset:3072 sc1
    s_waitcnt lgkmcnt(10)
    v_mfma_f32_32x32x16_bf16 v[80:95], v[156:159], v[108:111], v[80:95]
    ds_read_b64_tr_b16 v[100:101], v61 offset:16384
    ds_read_b64_tr_b16 v[102:103], v61 offset:17408
    s_waitcnt vmcnt(13) lgkmcnt(10)
    v_mfma_f32_32x32x16_bf16 v[64:79], v[160:163], v[112:115], v[64:79]
    ds_read_b64_tr_b16 v[104:105], v60 offset:18432
    ds_read_b64_tr_b16 v[106:107], v60 offset:19456
    s_add_u32 s82, s72, 40960
    buffer_load_dwordx4 v[216:219], v4, s[36:39], s82 offen offset:0 sc1
    s_waitcnt lgkmcnt(10)
    v_mfma_f32_32x32x16_bf16 v[80:95], v[160:163], v[116:119], v[80:95]
    ds_read_b64_tr_b16 v[108:109], v61 offset:18432
    ds_read_b64_tr_b16 v[110:111], v61 offset:19456
    s_waitcnt vmcnt(13) lgkmcnt(10)
    v_mfma_f32_32x32x16_bf16 v[64:79], v[164:167], v[120:123], v[64:79]
    ds_read_b64_tr_b16 v[112:113], v60 offset:24576
    ds_read_b64_tr_b16 v[114:115], v60 offset:25600
    buffer_load_dwordx4 v[220:223], v4, s[36:39], s82 offen offset:1024 sc1
    s_waitcnt lgkmcnt(10)
    v_mfma_f32_32x32x16_bf16 v[80:95], v[164:167], v[124:127], v[80:95]
    ds_read_b64_tr_b16 v[116:117], v61 offset:24576
    ds_read_b64_tr_b16 v[118:119], v61 offset:25600
    s_waitcnt vmcnt(13) lgkmcnt(10)
    v_mfma_f32_32x32x16_bf16 v[64:79], v[168:171], v[96:99], v[64:79]
    ds_read_b64_tr_b16 v[120:121], v60 offset:26624
    ds_read_b64_tr_b16 v[122:123], v60 offset:27648
    buffer_load_dwordx4 v[224:227], v4, s[36:39], s82 offen offset:2048 sc1
    s_waitcnt lgkmcnt(10)
    v_mfma_f32_32x32x16_bf16 v[80:95], v[168:171], v[100:103], v[80:95]
    ds_read_b64_tr_b16 v[124:125], v61 offset:26624
    ds_read_b64_tr_b16 v[126:127], v61 offset:27648
    s_waitcnt vmcnt(13) lgkmcnt(10)
    v_mfma_f32_32x32x16_bf16 v[64:79], v[172:175], v[104:107], v[64:79]
    ds_read_b64_tr_b16 v[96:97], v60 offset:32768
    ds_read_b64_tr_b16 v[98:99], v60 offset:33792
    buffer_load_dwordx4 v[228:231], v4, s[36:39], s82 offen offset:3072 sc1
    s_waitcnt lgkmcnt(10)
    v_mfma_f32_32x32x16_bf16 v[80:95], v[172:175], v[108:111], v[80:95]
    ds_read_b64_tr_b16 v[100:101], v61 offset:32768
    ds_read_b64_tr_b16 v[102:103], v61 offset:33792
    s_waitcnt vmcnt(13) lgkmcnt(10)
    v_mfma_f32_32x32x16_bf16 v[64:79], v[176:179], v[112:115], v[64:79]
    ds_read_b64_tr_b16 v[104:105], v60 offset:34816
    ds_read_b64_tr_b16 v[106:107], v60 offset:35840
    s_add_u32 s82, s72, 45056
    buffer_load_dwordx4 v[128:131], v4, s[36:39], s82 offen offset:0 sc1
    s_waitcnt lgkmcnt(10)
    v_mfma_f32_32x32x16_bf16 v[80:95], v[176:179], v[116:119], v[80:95]
    ds_read_b64_tr_b16 v[108:109], v61 offset:34816
    ds_read_b64_tr_b16 v[110:111], v61 offset:35840
    s_waitcnt vmcnt(13) lgkmcnt(10)
    v_mfma_f32_32x32x16_bf16 v[64:79], v[180:183], v[120:123], v[64:79]
    ds_read_b64_tr_b16 v[112:113], v60 offset:40960
    ds_read_b64_tr_b16 v[114:115], v60 offset:41984
    buffer_load_dwordx4 v[132:135], v4, s[36:39], s82 offen offset:1024 sc1
    s_waitcnt lgkmcnt(10)
    v_mfma_f32_32x32x16_bf16 v[80:95], v[180:183], v[124:127], v[80:95]
    ds_read_b64_tr_b16 v[116:117], v61 offset:40960
    ds_read_b64_tr_b16 v[118:119], v61 offset:41984
    s_waitcnt vmcnt(13) lgkmcnt(10)
    v_mfma_f32_32x32x16_bf16 v[64:79], v[184:187], v[96:99], v[64:79]
    ds_read_b64_tr_b16 v[120:121], v60 offset:43008
    ds_read_b64_tr_b16 v[122:123], v60 offset:44032
    buffer_load_dwordx4 v[136:139], v4, s[36:39], s82 offen offset:2048 sc1
    s_waitcnt lgkmcnt(10)
    v_mfma_f32_32x32x16_bf16 v[80:95], v[184:187], v[100:103], v[80:95]
    ds_read_b64_tr_b16 v[124:125], v61 offset:43008
    ds_read_b64_tr_b16 v[126:127], v61 offset:44032
    s_waitcnt vmcnt(13) lgkmcnt(10)
    v_mfma_f32_32x32x16_bf16 v[64:79], v[188:191], v[104:107], v[64:79]
    buffer_load_dwordx4 v[140:143], v4, s[36:39], s82 offen offset:3072 sc1
    s_waitcnt lgkmcnt(8)
    v_mfma_f32_32x32x16_bf16 v[80:95], v[188:191], v[108:111], v[80:95]
    s_waitcnt vmcnt(13) lgkmcnt(6)
    v_mfma_f32_32x32x16_bf16 v[64:79], v[192:195], v[112:115], v[64:79]
    s_waitcnt lgkmcnt(4)
    v_mfma_f32_32x32x16_bf16 v[80:95], v[192:195], v[116:119], v[80:95]
    s_waitcnt vmcnt(12) lgkmcnt(2)
    v_mfma_f32_32x32x16_bf16 v[64:79], v[196:199], v[120:123], v[64:79]
    s_waitcnt lgkmcnt(0)
    v_mfma_f32_32x32x16_bf16 v[80:95], v[196:199], v[124:127], v[80:95]
    s_barrier
    s_waitcnt vmcnt(11)
    v_mfma_f32_32x32x16_bf16 v[64:79], v[200:203], a[0:3], v[64:79]
    s_add_u32 m0, s44, 0
    s_add_u32 s63, s84, 0
    buffer_load_dwordx4 v6, s[8:11], s63 offen lds
    v_mfma_f32_32x32x16_bf16 v[80:95], v[200:203], a[4:7], v[80:95]
    s_waitcnt vmcnt(11)
    v_mfma_f32_32x32x16_bf16 v[64:79], v[204:207], a[8:11], v[64:79]
    s_add_u32 m0, s44, 4096
    s_add_u32 s63, s84, 1024
    buffer_load_dwordx4 v6, s[8:11], s63 offen lds
    v_mfma_f32_32x32x16_bf16 v[80:95], v[204:207], a[12:15], v[80:95]
    s_waitcnt vmcnt(11)
    v_mfma_f32_32x32x16_bf16 v[64:79], v[208:211], a[16:19], v[64:79]
    s_add_u32 m0, s44, 8192
    s_add_u32 s63, s84, 2048
    buffer_load_dwordx4 v6, s[8:11], s63 offen lds
    v_mfma_f32_32x32x16_bf16 v[80:95], v[208:211], a[20:23], v[80:95]
    s_waitcnt vmcnt(11)
    v_mfma_f32_32x32x16_bf16 v[64:79], v[212:215], a[24:27], v[64:79]
    s_add_u32 m0, s44, 12288
    s_add_u32 s63, s85, 0
    buffer_load_dwordx4 v6, s[8:11], s63 offen lds
    v_mfma_f32_32x32x16_bf16 v[80:95], v[212:215], a[28:31], v[80:95]
    s_waitcnt vmcnt(11)
    v_mfma_f32_32x32x16_bf16 v[64:79], v[216:219], a[32:35], v[64:79]
    s_add_u32 m0, s44, 16384
    s_add_u32 s63, s85, 1024
    buffer_load_dwordx4 v6, s[8:11], s63 offen lds
    v_mfma_f32_32x32x16_bf16 v[80:95], v[216:219], a[36:39], v[80:95]
    s_waitcnt vmcnt(11)
    v_mfma_f32_32x32x16_bf16 v[64:79], v[220:223], a[40:43], v[64:79]
    s_add_u32 m0, s44, 20480
    s_add_u32 s63, s85, 2048
    buffer_load_dwordx4 v6, s[8:11], s63 offen lds
    v_mfma_f32_32x32x16_bf16 v[80:95], v[220:223], a[44:47], v[80:95]
    s_waitcnt vmcnt(11)
    v_mfma_f32_32x32x16_bf16 v[64:79], v[224:227], a[48:51], v[64:79]
    s_add_u32 m0, s44, 24576
    s_add_u32 s63, s86, 0
    buffer_load_dwordx4 v6, s[8:11], s63 offen lds
    v_mfma_f32_32x32x16_bf16 v[80:95], v[224:227], a[52:55], v[80:95]
    s_waitcnt vmcnt(11)
    v_mfma_f32_32x32x16_bf16 v[64:79], v[228:231], a[56:59], v[64:79]
    s_add_u32 m0, s44, 28672
    s_add_u32 s63, s86, 1024
    buffer_load_dwordx4 v6, s[8:11], s63 offen lds
    v_mfma_f32_32x32x16_bf16 v[80:95], v[228:231], a[60:63], v[80:95]
    s_waitcnt vmcnt(11)
    v_mfma_f32_32x32x16_bf16 v[64:79], v[128:131], a[64:67], v[64:79]
    s_add_u32 m0, s44, 32768
    s_add_u32 s63, s86, 2048
    buffer_load_dwordx4 v6, s[8:11], s63 offen lds
    v_mfma_f32_32x32x16_bf16 v[80:95], v[128:131], a[68:71], v[80:95]
    s_waitcnt vmcnt(11)
    v_mfma_f32_32x32x16_bf16 v[64:79], v[132:135], a[72:75], v[64:79]
    s_add_u32 m0, s44, 36864
    s_add_u32 s63, s87, 0
    buffer_load_dwordx4 v6, s[8:11], s63 offen lds
    v_mfma_f32_32x32x16_bf16 v[80:95], v[132:135], a[76:79], v[80:95]
    s_waitcnt vmcnt(11)
    v_mfma_f32_32x32x16_bf16 v[80:95], v[136:139], a[84:87], v[80:95]
    s_waitcnt vmcnt(10)
    v_mfma_f32_32x32x16_bf16 v[80:95], v[140:143], a[92:95], v[80:95]
    v_mfma_f32_32x32x16_bf16 v[64:79], v[136:139], a[80:83], v[64:79]
    s_add_u32 m0, s44, 40960
    s_add_u32 s63, s87, 1024
    buffer_load_dwordx4 v6, s[8:11], s63 offen lds
    v_mfma_f32_32x32x16_bf16 v[64:79], v[140:143], a[88:91], v[64:79]
    s_add_u32 m0, s44, 45056
    s_add_u32 s63, s87, 2048
    buffer_load_dwordx4 v6, s[8:11], s63 offen lds
    s_nop 3
    ds_write_b128 v22, v[80:83] offset:0
    ds_write_b128 v22, v[84:87] offset:1024
    ds_write_b128 v22, v[88:91] offset:2048
    ds_write_b128 v22, v[92:95] offset:3072
    s_waitcnt lgkmcnt(0)
    s_barrier
    ds_read_b128 v[96:99], v23 offset:0
    ds_read_b128 v[100:103], v23 offset:1024
    ds_read_b128 v[104:107], v23 offset:2048
    ds_read_b128 v[108:111], v23 offset:3072
    s_add_u32 m0, s44, 49152
    s_add_u32 s63, s88, 0
    buffer_load_dwordx4 v6, s[8:11], s63 offen lds
    s_add_u32 m0, s44, 53248
    s_add_u32 s63, s88, 1024
    buffer_load_dwordx4 v6, s[8:11], s63 offen lds
    s_waitcnt lgkmcnt(3)
    v_pk_add_f32 v[64:65], v[64:65], v[96:97]
    v_pk_add_f32 v[66:67], v[66:67], v[98:99]
    s_waitcnt lgkmcnt(2)
    v_pk_add_f32 v[68:69], v[68:69], v[100:101]
    v_pk_add_f32 v[70:71], v[70:71], v[102:103]
    v_cvt_pk_bf16_f32 v80, v64, v65
    v_cvt_pk_bf16_f32 v81, v66, v67
    v_cvt_pk_bf16_f32 v82, v68, v69
    v_cvt_pk_bf16_f32 v83, v70, v71
    s_cmp_lg_u32 s100, 0
    s_cbranch_scc1 hs_f_18
    buffer_store_dwordx4 v[80:83], v24, s[36:39], s60 offen offset:0 sc1
    s_branch hs_j_19
hs_f_18:
    buffer_store_dwordx4 v[80:83], v24, s[36:39], s60 offen offset:0
hs_j_19:
    s_waitcnt lgkmcnt(1)
    v_pk_add_f32 v[72:73], v[72:73], v[104:105]
    v_pk_add_f32 v[74:75], v[74:75], v[106:107]
    s_waitcnt lgkmcnt(0)
    v_pk_add_f32 v[76:77], v[76:77], v[108:109]
    v_pk_add_f32 v[78:79], v[78:79], v[110:111]
    v_cvt_pk_bf16_f32 v84, v72, v73
    v_cvt_pk_bf16_f32 v85, v74, v75
    v_cvt_pk_bf16_f32 v86, v76, v77
    v_cvt_pk_bf16_f32 v87, v78, v79
    s_cmp_lg_u32 s100, 0
    s_cbranch_scc1 hs_f_20
    buffer_store_dwordx4 v[84:87], v24, s[36:39], s60 offen offset:512 sc1
    s_branch hs_j_21
hs_f_20:
    buffer_store_dwordx4 v[84:87], v24, s[36:39], s60 offen offset:512
hs_j_21:
    v_lshlrev_b32 v64, 16, v80
    v_and_b32 v65, 0xffff0000, v80
    v_lshlrev_b32 v66, 16, v81
    v_and_b32 v67, 0xffff0000, v81
    v_lshlrev_b32 v68, 16, v82
    v_and_b32 v69, 0xffff0000, v82
    v_lshlrev_b32 v70, 16, v83
    v_and_b32 v71, 0xffff0000, v83
    v_lshlrev_b32 v72, 16, v84
    v_and_b32 v73, 0xffff0000, v84
    v_lshlrev_b32 v74, 16, v85
    v_and_b32 v75, 0xffff0000, v85
    v_lshlrev_b32 v76, 16, v86
    v_and_b32 v77, 0xffff0000, v86
    v_lshlrev_b32 v78, 16, v87
    v_and_b32 v79, 0xffff0000, v87
    v_pk_add_f32 v[96:97], v[64:65], v[66:67]
    v_pk_mul_f32 v[98:99], v[64:65], v[64:65]
    v_pk_fma_f32 v[98:99], v[66:67], v[66:67], v[98:99]
    v_pk_fma_f32 v[98:99], v[68:69], v[68:69], v[98:99]
    v_pk_add_f32 v[96:97], v[96:97], v[68:69]
    v_pk_fma_f32 v[98:99], v[70:71], v[70:71], v[98:99]
    v_pk_add_f32 v[96:97], v[96:97], v[70:71]
    v_pk_fma_f32 v[98:99], v[72:73], v[72:73], v[98:99]
    v_pk_add_f32 v[96:97], v[96:97], v[72:73]
    v_pk_fma_f32 v[98:99], v[74:75], v[74:75], v[98:99]
    v_pk_add_f32 v[96:97], v[96:97], v[74:75]
    v_pk_fma_f32 v[98:99], v[76:77], v[76:77], v[98:99]
    v_pk_add_f32 v[96:97], v[96:97], v[76:77]
    v_pk_fma_f32 v[98:99], v[78:79], v[78:79], v[98:99]
    v_pk_add_f32 v[96:97], v[96:97], v[78:79]
    v_add_f32 v96, v96, v97
    v_add_f32 v98, v98, v99
    s_nop 1
    v_permlane32_swap_b32 v96, v98
    v_add_f32 v96, v96, v98
    s_cmp_lg_u32 s100, 0
    s_cbranch_scc1 hs_f_22
    buffer_store_dword v96, v50, s[36:39], s73 offen sc1
    s_branch hs_j_23
hs_f_22:
    buffer_store_dword v96, v50, s[36:39], s73 offen
hs_j_23:
    v_xor_b32 v26, 0x5bd1e995, v26
    s_lshr_b32 s62, s47, 1
    s_lshl_b32 s60, s62, 14
    s_add_u32 s60, s60, s61
    s_add_u32 s60, s60, 1587200
    s_add_u32 s62, s62, 1
    s_lshl_b32 s62, s62, 11
    s_lshr_b32 s61, s61, 3
    s_add_u32 s62, s62, s61
    s_add_u32 s62, s62, 131080
    s_and_b32 s61, s47, s51
    s_and_b32 s61, s61, 1
    s_cmp_eq_u32 s61, 0
    s_cselect_b32 s60, 0x40000000, s60
    s_cselect_b32 s62, 0x40000000, s62
    s_mov_b32 exec_lo, 0xffff0000
    s_mov_b32 exec_hi, 0xffff0000
    buffer_store_dwordx4 v[80:83], v24, s[36:39], s60 offen offset:0 sc1
    buffer_store_dwordx4 v[84:87], v24, s[36:39], s60 offen offset:512 sc1
    s_mov_b64 exec, -1
    s_add_u32 m0, s44, 57344
    s_add_u32 s63, s88, 2048
    buffer_load_dwordx4 v6, s[8:11], s63 offen lds
    s_add_u32 m0, s44, 61440
    s_add_u32 s63, s89, 0
    buffer_load_dwordx4 v6, s[8:11], s63 offen lds
    s_waitcnt vmcnt(4)
    s_waitcnt lgkmcnt(0)
    s_barrier
    s_cmp_lg_u32 s41, 0
    s_cbranch_scc1 pub_24
    s_lshl_b32 s60, s47, 3
    s_add_u32 s60, s60, s48
    s_mul_i32 s60, s60, 128
    s_add_u32 s60, s60, 65540
    v_lshlrev_b32 v62, 2, v1
    s_mov_b32 exec_hi, 0
    s_mov_b32 exec_lo, 0x00000001
    s_cmp_lg_u32 s100, 0
    s_cbranch_scc1 hs_f_25
    buffer_store_dword v26, v62, s[36:39], s60 offen sc1
    s_branch hs_j_26
hs_f_25:
    buffer_store_dword v26, v62, s[36:39], s60 offen
hs_j_26:
    s_mov_b64 exec, -1
pub_24:
    s_mul_i32 s60, s51, 4608
    s_lshl_b32 s61, s52, 6
    s_add_u32 s60, s60, s61
    s_add_u32 s60, s60, 131072
    v_and_b32 v24, 31, v1
    v_mul_u32_u24 v24, 144, v24
    v_lshl_add_u32 v24, v25, 4, v24
    v_add_u32 v24, s60, v24
    ds_write_b128 v24, v[80:83] offset:0
    ds_write_b128 v24, v[84:87] offset:32
    s_add_u32 m0, s44, 65536
    s_add_u32 s63, s89, 1024
    buffer_load_dwordx4 v6, s[8:11], s63 offen lds
    s_add_u32 m0, s44, 69632
    s_add_u32 s63, s89, 2048
    buffer_load_dwordx4 v6, s[8:11], s63 offen lds
    s_add_u32 m0, s44, 73728
    s_add_u32 s63, s90, 0
    buffer_load_dwordx4 v6, s[8:11], s63 offen lds
    s_waitcnt vmcnt(5)
    v_mov_b32 v22, 0
    s_mov_b64 exec, 1
    buffer_store_dword v26, v22, s[36:39], s62 offen sc1
    s_mov_b64 exec, -1
    s_lshl_b32 s72, s45, 3
    s_lshl_b32 s61, s41, 1
    s_add_u32 s72, s72, s61
    s_lshl_b32 s72, s72, 14
    s_lshl_b32 s78, s45, 4
    s_add_u32 s78, s78, s46
    s_lshl_b32 s78, s78, 3
    s_add_u32 s78, s78, s61
    s_lshr_b32 s72, s72, 3
    s_add_u32 s72, s72, 6291456
    s_lshl_b32 s74, s45, 14
    s_add_u32 s74, s74, 1572864
    s_cmp_eq_u32 s45, 0
    s_cselect_b32 s74, 6291456, s74
    v_lshlrev_b32 v16, 4, v3
    s_add_u32 m0, s44, 77824
    s_add_u32 s63, s90, 1024
    buffer_load_dwordx4 v6, s[8:11], s63 offen lds
    s_add_u32 m0, s44, 81920
    s_add_u32 s63, s90, 2048
    buffer_load_dwordx4 v6, s[8:11], s63 offen lds
    s_add_u32 m0, s44, 86016
    s_add_u32 s63, s91, 0
    buffer_load_dwordx4 v6, s[8:11], s63 offen lds
    s_add_u32 m0, s44, 90112
    s_add_u32 s63, s91, 1024
    buffer_load_dwordx4 v6, s[8:11], s63 offen lds
    s_add_u32 m0, s44, 94208
    s_add_u32 s63, s91, 2048
    buffer_load_dwordx4 v6, s[8:11], s63 offen lds
    s_lshl_b32 s3, s78, 7
    s_add_u32 s3, s3, 1048576
    s_cmp_lg_u32 s41, 0
    s_cbranch_scc1 poll_27_d
    s_lshl_b32 s60, s45, 4
    s_mul_i32 s60, s60, 128
    s_add_u32 s60, s60, 65540
    v_min_u32 v62, 15, v1
    v_mul_u32_u24 v62, 128, v62
    s_mov_b32 s70, 30000
poll_27:
    buffer_load_dword v63, v62, s[36:39], s60 offen sc1
    s_waitcnt vmcnt(0)
    v_cmp_ne_u32 vcc, v63, v26
    s_nop 3
    s_cbranch_vccz poll_27_d
    s_sub_u32 s70, s70, 1
    s_cmp_lg_u32 s70, 0
    s_cbranch_scc1 poll_27
poll_27_d:
    s_waitcnt vmcnt(0) lgkmcnt(0)
    s_barrier
    buffer_load_dwordx4 v[132:135], v16, s[36:39], s3 offen sc1
    s_lshl_b32 s73, s92, 18
    s_add_u32 s73, s73, s72
    buffer_load_dwordx4 v[136:139], v4, s[36:39], s73 offen offset:0 sc1
    buffer_load_dwordx4 v[140:143], v4, s[36:39], s73 offen offset:2048 sc1
    buffer_load_dwordx4 v[144:147], v4, s[36:39], s73 offen offset:1024 sc1
    buffer_load_dwordx4 v[148:151], v4, s[36:39], s73 offen offset:3072 sc1
    s_lshl_b32 s73, s93, 18
    s_add_u32 s73, s73, s72
    buffer_load_dwordx4 v[152:155], v4, s[36:39], s73 offen offset:0 sc1
    buffer_load_dwordx4 v[156:159], v4, s[36:39], s73 offen offset:2048 sc1
    buffer_load_dwordx4 v[160:163], v4, s[36:39], s73 offen offset:1024 sc1
    buffer_load_dwordx4 v[164:167], v4, s[36:39], s73 offen offset:3072 sc1
    s_mul_i32 s61, s41, 2304
    s_add_u32 s61, s61, 131072
    v_mul_u32_u24 v23, 144, v3
    v_lshl_add_u32 v23, v2, 3, v23
    v_add_u32 v23, s61, v23
    ds_read_b64 v[32:33], v23 offset:0
    ds_read_b64 v[34:35], v23 offset:32
    ds_read_b64 v[36:37], v23 offset:64
    ds_read_b64 v[38:39], v23 offset:96
    v_lshrrev_b32 v22, 2, v1
    v_and_b32 v22, 3, v22
    v_lshl_add_u32 v22, v2, 3, v22
    v_lshlrev_b32 v22, 6, v22
    v_and_b32 v23, 3, v1
    v_lshl_add_u32 v22, v23, 3, v22
    v_and_b32 v23, 1, v2
    v_lshl_add_u32 v10, v23, 5, v22
    v_add_u32 v11, 49152, v10
    v_xor_b32 v12, 32, v10
    v_xor_b32 v13, 32, v11
    v_lshrrev_b32 v22, 3, v1
    v_mul_u32_u24 v24, 3584, v22
    v_and_b32 v23, 7, v1
    v_min_u32 v20, 6, v23
    v_lshl_add_u32 v20, v20, 7, v24
    v_lshlrev_b32 v22, 14, v22
    v_lshl_add_u32 v21, v23, 7, v22
    s_lshl_b32 s60, s52, 5
    v_xor_b32 v24, s60, v10
    v_xor_b32 v25, s60, v11
    s_lshl_b32 s60, s51, 12
    s_add_u32 s60, s60, 4096
    v_add_u32 v14, s60, v24
    v_add_u32 v15, s60, v25
    v_add_u32 v18, 147456, v4
    v_add_u32 v19, 1024, v18
    s_lshl_b32 s60, s41, 12
    v_add_u32 v25, s60, v18
    v_lshlrev_b32 v16, 4, v3
    v_lshlrev_b32 v22, 8, v1
    v_add_u32 v22, 147456, v22
    ds_write_b128 v22, v[28:31]
    s_waitcnt vmcnt(8)
    v_add_f32 v132, v132, v134
    v_add_f32 v133, v133, v135
    s_nop 0
    v_add_f32_dpp v132, v132, v132 quad_perm:[1,0,3,2] row_mask:0xf bank_mask:0xf
    v_add_f32_dpp v133, v133, v133 quad_perm:[1,0,3,2] row_mask:0xf bank_mask:0xf
    s_nop 0
    v_add_f32_dpp v132, v132, v132 quad_perm:[2,3,0,1] row_mask:0xf bank_mask:0xf
    v_add_f32_dpp v133, v133, v133 quad_perm:[2,3,0,1] row_mask:0xf bank_mask:0xf
    s_nop 0
    v_add_f32_dpp v132, v132, v132 row_half_mirror row_mask:0xf bank_mask:0xf
    v_add_f32_dpp v133, v133, v133 row_half_mirror row_mask:0xf bank_mask:0xf
    v_mul_f32 v132, 0x3b000000, v132
    v_mul_f32 v133, 0x3b000000, v133
    v_fma_f32 v133, -v132, v132, v133
    v_max_f32 v133, 0, v133
    v_add_f32 v134, 0x3727c5ac, v133
    v_rsq_f32 v120, v134
    s_nop 0
    v_mul_f32 v122, v132, v120
    v_sub_f32 v122, 0, v122
    v_mov_b32 v121, v26
    v_mov_b32 v123, v26
    v_lshrrev_b32 v23, 3, v1
    v_lshlrev_b32 v23, 4, v23
    s_lshl_b32 s3, s78, 4
    s_add_u32 s3, s3, 720896
    s_mov_b64 exec, 0x101
    buffer_store_dwordx4 v[120:123], v23, s[36:39], s3 offen sc1
    s_mov_b64 exec, -1
    s_lshl_b32 s60, s41, 11
    s_add_u32 s60, s60, 131072
    v_lshlrev_b32 v50, 6, v3
    v_lshl_add_u32 v50, v2, 3, v50
    v_add_u32 v48, s60, v50
    v_lshrrev_b32 v51, 2, v1
    v_lshlrev_b32 v51, 6, v51
    v_and_b32 v49, 3, v1
    v_lshl_add_u32 v51, v49, 3, v51
    v_add_u32 v51, s60, v51
    s_add_u32 s60, s44, 140288
    v_add_u32 v49, s60, v27
    s_lshl_b32 s60, s52, 9
    s_add_u32 s60, s60, 140288
    s_lshl_b32 s3, s52, 5
    s_add_u32 s3, s3, 131072
    s_cmp_lg_u32 s51, 0
    s_cselect_b32 s60, s3, s60
    s_cselect_b64 vcc, -1, 0
    v_cndmask_b32 v50, v27, v50, vcc
    v_add_u32 v50, s60, v50
    ds_read_b64_tr_b16 a[0:1], v10 offset:0
    ds_read_b64_tr_b16 a[2:3], v10 offset:256
    ds_read_b64_tr_b16 a[4:5], v12 offset:0
    ds_read_b64_tr_b16 a[6:7], v12 offset:256
    ds_read_b64_tr_b16 a[8:9], v10 offset:4096
    ds_read_b64_tr_b16 a[10:11], v10 offset:4352
    ds_read_b64_tr_b16 a[12:13], v12 offset:4096
    ds_read_b64_tr_b16 a[14:15], v12 offset:4352
    ds_read_b64_tr_b16 a[16:17], v10 offset:8192
    ds_read_b64_tr_b16 a[18:19], v10 offset:8448
    s_waitcnt vmcnt(7)
    s_waitcnt lgkmcnt(6)
    v_mfma_f32_16x16x32_bf16 v[64:67], a[0:3], v[136:139], 0
    ds_read_b64_tr_b16 a[20:21], v12 offset:8192
    s_lshl_b32 s73, s94, 18
    s_add_u32 s73, s73, s72
    buffer_load_dwordx4 v[168:171], v4, s[36:39], s73 offen offset:0 sc1
    v_mfma_f32_16x16x32_bf16 v[88:91], a[0:3], v[140:143], 0
    ds_read_b64_tr_b16 a[22:23], v12 offset:8448
    v_mfma_f32_16x16x32_bf16 v[68:71], a[4:7], v[136:139], 0
    ds_read_b64_tr_b16 a[24:25], v10 offset:2048
    v_mfma_f32_16x16x32_bf16 v[92:95], a[4:7], v[140:143], 0
    ds_read_b64_tr_b16 a[26:27], v10 offset:2304
    buffer_load_dwordx4 v[172:175], v4, s[36:39], s73 offen offset:2048 sc1
    s_waitcnt lgkmcnt(6)
    v_mfma_f32_16x16x32_bf16 v[72:75], a[8:11], v[136:139], 0
    ds_read_b64_tr_b16 a[28:29], v12 offset:2048
    v_mfma_f32_16x16x32_bf16 v[96:99], a[8:11], v[140:143], 0
    ds_read_b64_tr_b16 a[30:31], v12 offset:2304
    v_mfma_f32_16x16x32_bf16 v[76:79], a[12:15], v[136:139], 0
    ds_read_b64_tr_b16 a[32:33], v10 offset:6144
    buffer_load_dwordx4 v[176:179], v4, s[36:39], s73 offen offset:1024 sc1
    v_mfma_f32_16x16x32_bf16 v[100:103], a[12:15], v[140:143], 0
    ds_read_b64_tr_b16 a[34:35], v10 offset:6400
    s_waitcnt lgkmcnt(6)
    v_mfma_f32_16x16x32_bf16 v[80:83], a[16:19], v[136:139], 0
    ds_read_b64_tr_b16 a[36:37], v12 offset:6144
    v_mfma_f32_16x16x32_bf16 v[104:107], a[16:19], v[140:143], 0
    ds_read_b64_tr_b16 a[38:39], v12 offset:6400
    buffer_load_dwordx4 v[180:183], v4, s[36:39], s73 offen offset:3072 sc1
    v_mfma_f32_16x16x32_bf16 v[84:87], a[20:23], v[136:139], 0
    ds_read_b64_tr_b16 a[40:41], v10 offset:10240
    v_mfma_f32_16x16x32_bf16 v[108:111], a[20:23], v[140:143], 0
    ds_read_b64_tr_b16 a[42:43], v10 offset:10496
    s_waitcnt vmcnt(9)
    s_waitcnt lgkmcnt(6)
    v_mfma_f32_16x16x32_bf16 v[64:67], a[24:27], v[144:147], v[64:67]
    ds_read_b64_tr_b16 a[44:45], v12 offset:10240
    s_lshl_b32 s73, s95, 18
    s_add_u32 s73, s73, s72
    buffer_load_dwordx4 v[184:187], v4, s[36:39], s73 offen offset:0 sc1
    v_mfma_f32_16x16x32_bf16 v[88:91], a[24:27], v[148:151], v[88:91]
    ds_read_b64_tr_b16 a[46:47], v12 offset:10496
    v_mfma_f32_16x16x32_bf16 v[68:71], a[28:31], v[144:147], v[68:71]
    ds_read_b64_tr_b16 a[0:1], v10 offset:12288
    v_mfma_f32_16x16x32_bf16 v[92:95], a[28:31], v[148:151], v[92:95]
    ds_read_b64_tr_b16 a[2:3], v10 offset:12544
    buffer_load_dwordx4 v[188:191], v4, s[36:39], s73 offen offset:2048 sc1
    s_waitcnt lgkmcnt(6)
    v_mfma_f32_16x16x32_bf16 v[72:75], a[32:35], v[144:147], v[72:75]
    ds_read_b64_tr_b16 a[4:5], v12 offset:12288
    v_mfma_f32_16x16x32_bf16 v[96:99], a[32:35], v[148:151], v[96:99]
    ds_read_b64_tr_b16 a[6:7], v12 offset:12544
    v_mfma_f32_16x16x32_bf16 v[76:79], a[36:39], v[144:147], v[76:79]
    ds_read_b64_tr_b16 a[8:9], v10 offset:16384
    buffer_load_dwordx4 v[192:195], v4, s[36:39], s73 offen offset:1024 sc1
    v_mfma_f32_16x16x32_bf16 v[100:103], a[36:39], v[148:151], v[100:103]
    ds_read_b64_tr_b16 a[10:11], v10 offset:16640
    s_waitcnt lgkmcnt(6)
    v_mfma_f32_16x16x32_bf16 v[80:83], a[40:43], v[144:147], v[80:83]
    ds_read_b64_tr_b16 a[12:13], v12 offset:16384
    v_mfma_f32_16x16x32_bf16 v[104:107], a[40:43], v[148:151], v[104:107]
    ds_read_b64_tr_b16 a[14:15], v12 offset:16640
    buffer_load_dwordx4 v[196:199], v4, s[36:39], s73 offen offset:3072 sc1
    v_mfma_f32_16x16x32_bf16 v[84:87], a[44:47], v[144:147], v[84:87]
    ds_read_b64_tr_b16 a[16:17], v10 offset:20480
    v_mfma_f32_16x16x32_bf16 v[108:111], a[44:47], v[148:151], v[108:111]
    ds_read_b64_tr_b16 a[18:19], v10 offset:20736
    s_waitcnt vmcnt(11)
    s_waitcnt lgkmcnt(6)
    v_mfma_f32_16x16x32_bf16 v[64:67], a[0:3], v[152:155], v[64:67]
    ds_read_b64_tr_b16 a[20:21], v12 offset:20480
    v_mul_u32_u24 v62, 128, v3
    s_mul_i32 s61, s45, 2048
    s_add_u32 s61, s61, 131080
    s_cmp_eq_u32 s45, 0
    s_cselect_b32 s61, 65540, s61
    buffer_load_dword v63, v62, s[36:39], s61 offen sc1
    v_mfma_f32_16x16x32_bf16 v[88:91], a[0:3], v[156:159], v[88:91]
    ds_read_b64_tr_b16 a[22:23], v12 offset:20736
    v_mfma_f32_16x16x32_bf16 v[68:71], a[4:7], v[152:155], v[68:71]
    ds_read_b64_tr_b16 a[24:25], v10 offset:14336
    v_mfma_f32_16x16x32_bf16 v[92:95], a[4:7], v[156:159], v[92:95]
    ds_read_b64_tr_b16 a[26:27], v10 offset:14592
    s_lshl_b32 s73, s96, 18
    s_add_u32 s73, s73, s72
    buffer_load_dwordx4 v[200:203], v4, s[36:39], s73 offen offset:0 sc1
    s_waitcnt lgkmcnt(6)
    v_mfma_f32_16x16x32_bf16 v[72:75], a[8:11], v[152:155], v[72:75]
    ds_read_b64_tr_b16 a[28:29], v12 offset:14336
    v_mfma_f32_16x16x32_bf16 v[96:99], a[8:11], v[156:159], v[96:99]
    ds_read_b64_tr_b16 a[30:31], v12 offset:14592
    v_mfma_f32_16x16x32_bf16 v[76:79], a[12:15], v[152:155], v[76:79]
    ds_read_b64_tr_b16 a[32:33], v10 offset:18432
    buffer_load_dwordx4 v[204:207], v4, s[36:39], s73 offen offset:2048 sc1
    v_mfma_f32_16x16x32_bf16 v[100:103], a[12:15], v[156:159], v[100:103]
    ds_read_b64_tr_b16 a[34:35], v10 offset:18688
    s_waitcnt lgkmcnt(6)
    v_mfma_f32_16x16x32_bf16 v[80:83], a[16:19], v[152:155], v[80:83]
    ds_read_b64_tr_b16 a[36:37], v12 offset:18432
    v_mfma_f32_16x16x32_bf16 v[104:107], a[16:19], v[156:159], v[104:107]
    ds_read_b64_tr_b16 a[38:39], v12 offset:18688
    buffer_load_dwordx4 v[208:211], v4, s[36:39], s73 offen offset:1024 sc1
    v_mfma_f32_16x16x32_bf16 v[84:87], a[20:23], v[152:155], v[84:87]
    ds_read_b64_tr_b16 a[40:41], v10 offset:22528
    v_mfma_f32_16x16x32_bf16 v[108:111], a[20:23], v[156:159], v[108:111]
    ds_read_b64_tr_b16 a[42:43], v10 offset:22784
    s_waitcnt vmcnt(13)
    s_waitcnt lgkmcnt(6)
    v_mfma_f32_16x16x32_bf16 v[64:67], a[24:27], v[160:163], v[64:67]
    ds_read_b64_tr_b16 a[44:45], v12 offset:22528
    s_lshl_b32 s3, s43, 2
    s_add_u32 s3, s3, s41
    s_lshl_b32 s3, s3, 12
    s_add_u32 s3, s3, 384
    v_lshlrev_b32 v23, 10, v1
    s_mov_b64 exec, 15
    buffer_load_dword a245, v23, s[12:15], s3 offen
    s_mov_b64 exec, -1
    v_mfma_f32_16x16x32_bf16 v[88:91], a[24:27], v[164:167], v[88:91]
    ds_read_b64_tr_b16 a[46:47], v12 offset:22784
    v_mfma_f32_16x16x32_bf16 v[68:71], a[28:31], v[160:163], v[68:71]
    ds_read_b64_tr_b16 a[0:1], v10 offset:24576
    v_mfma_f32_16x16x32_bf16 v[92:95], a[28:31], v[164:167], v[92:95]
    ds_read_b64_tr_b16 a[2:3], v10 offset:24832
    buffer_load_dwordx4 v[212:215], v4, s[36:39], s73 offen offset:3072 sc1
    s_waitcnt lgkmcnt(6)
    v_mfma_f32_16x16x32_bf16 v[72:75], a[32:35], v[160:163], v[72:75]
    ds_read_b64_tr_b16 a[4:5], v12 offset:24576
    v_mfma_f32_16x16x32_bf16 v[96:99], a[32:35], v[164:167], v[96:99]
    ds_read_b64_tr_b16 a[6:7], v12 offset:24832
    v_mfma_f32_16x16x32_bf16 v[76:79], a[36:39], v[160:163], v[76:79]
    ds_read_b64_tr_b16 a[8:9], v10 offset:28672
    s_lshl_b32 s73, s97, 18
    s_add_u32 s73, s73, s72
    buffer_load_dwordx4 v[216:219], v4, s[36:39], s73 offen offset:0 sc1
    v_mfma_f32_16x16x32_bf16 v[100:103], a[36:39], v[164:167], v[100:103]
    ds_read_b64_tr_b16 a[10:11], v10 offset:28928
    s_waitcnt lgkmcnt(6)
    v_mfma_f32_16x16x32_bf16 v[80:83], a[40:43], v[160:163], v[80:83]
    ds_read_b64_tr_b16 a[12:13], v12 offset:28672
    v_mfma_f32_16x16x32_bf16 v[104:107], a[40:43], v[164:167], v[104:107]
    ds_read_b64_tr_b16 a[14:15], v12 offset:28928
    buffer_load_dwordx4 v[220:223], v4, s[36:39], s73 offen offset:2048 sc1
    v_mfma_f32_16x16x32_bf16 v[84:87], a[44:47], v[160:163], v[84:87]
    ds_read_b64_tr_b16 a[16:17], v10 offset:32768
    v_mfma_f32_16x16x32_bf16 v[108:111], a[44:47], v[164:167], v[108:111]
    ds_read_b64_tr_b16 a[18:19], v10 offset:33024
    s_waitcnt vmcnt(14)
    s_waitcnt lgkmcnt(6)
    v_mfma_f32_16x16x32_bf16 v[64:67], a[0:3], v[168:171], v[64:67]
    ds_read_b64_tr_b16 a[20:21], v12 offset:32768
    buffer_load_dwordx4 v[224:227], v4, s[36:39], s73 offen offset:1024 sc1
    v_mfma_f32_16x16x32_bf16 v[88:91], a[0:3], v[172:175], v[88:91]
    ds_read_b64_tr_b16 a[22:23], v12 offset:33024
    v_mfma_f32_16x16x32_bf16 v[68:71], a[4:7], v[168:171], v[68:71]
    ds_read_b64_tr_b16 a[24:25], v10 offset:26624
    v_mfma_f32_16x16x32_bf16 v[92:95], a[4:7], v[172:175], v[92:95]
    ds_read_b64_tr_b16 a[26:27], v10 offset:26880
    buffer_load_dwordx4 v[228:231], v4, s[36:39], s73 offen offset:3072 sc1
    s_waitcnt lgkmcnt(6)
    v_mfma_f32_16x16x32_bf16 v[72:75], a[8:11], v[168:171], v[72:75]
    ds_read_b64_tr_b16 a[28:29], v12 offset:26624
    v_mfma_f32_16x16x32_bf16 v[96:99], a[8:11], v[172:175], v[96:99]
    ds_read_b64_tr_b16 a[30:31], v12 offset:26880
    v_mfma_f32_16x16x32_bf16 v[76:79], a[12:15], v[168:171], v[76:79]
    ds_read_b64_tr_b16 a[32:33], v10 offset:30720
    s_lshl_b32 s73, s98, 18
    s_add_u32 s73, s73, s72
    buffer_load_dwordx4 v[136:139], v4, s[36:39], s73 offen offset:0 sc1
    v_mfma_f32_16x16x32_bf16 v[100:103], a[12:15], v[172:175], v[100:103]
    ds_read_b64_tr_b16 a[34:35], v10 offset:30976
    s_waitcnt lgkmcnt(6)
    v_mfma_f32_16x16x32_bf16 v[80:83], a[16:19], v[168:171], v[80:83]
    ds_read_b64_tr_b16 a[36:37], v12 offset:30720
    v_mfma_f32_16x16x32_bf16 v[104:107], a[16:19], v[172:175], v[104:107]
    ds_read_b64_tr_b16 a[38:39], v12 offset:30976
    buffer_load_dwordx4 v[140:143], v4, s[36:39], s73 offen offset:2048 sc1
    v_mfma_f32_16x16x32_bf16 v[84:87], a[20:23], v[168:171], v[84:87]
    ds_read_b64_tr_b16 a[40:41], v10 offset:34816
    v_mfma_f32_16x16x32_bf16 v[108:111], a[20:23], v[172:175], v[108:111]
    ds_read_b64_tr_b16 a[42:43], v10 offset:35072
    s_waitcnt vmcnt(16)
    s_waitcnt lgkmcnt(6)
    v_mfma_f32_16x16x32_bf16 v[64:67], a[24:27], v[176:179], v[64:67]
    ds_read_b64_tr_b16 a[44:45], v12 offset:34816
    buffer_load_dwordx4 v[144:147], v4, s[36:39], s73 offen offset:1024 sc1
    v_mfma_f32_16x16x32_bf16 v[88:91], a[24:27], v[180:183], v[88:91]
    ds_read_b64_tr_b16 a[46:47], v12 offset:35072
    v_mfma_f32_16x16x32_bf16 v[68:71], a[28:31], v[176:179], v[68:71]
    ds_read_b64_tr_b16 a[0:1], v10 offset:36864
    v_mfma_f32_16x16x32_bf16 v[92:95], a[28:31], v[180:183], v[92:95]
    ds_read_b64_tr_b16 a[2:3], v10 offset:37120
    buffer_load_dwordx4 v[148:151], v4, s[36:39], s73 offen offset:3072 sc1
    s_waitcnt lgkmcnt(6)
    v_mfma_f32_16x16x32_bf16 v[72:75], a[32:35], v[176:179], v[72:75]
    ds_read_b64_tr_b16 a[4:5], v12 offset:36864
    v_mfma_f32_16x16x32_bf16 v[96:99], a[32:35], v[180:183], v[96:99]
    ds_read_b64_tr_b16 a[6:7], v12 offset:37120
    v_mfma_f32_16x16x32_bf16 v[76:79], a[36:39], v[176:179], v[76:79]
    ds_read_b64_tr_b16 a[8:9], v10 offset:40960
    s_lshl_b32 s73, s99, 18
    s_add_u32 s73, s73, s72
    buffer_load_dwordx4 v[152:155], v4, s[36:39], s73 offen offset:0 sc1
    v_mfma_f32_16x16x32_bf16 v[100:103], a[36:39], v[180:183], v[100:103]
    ds_read_b64_tr_b16 a[10:11], v10 offset:41216
    s_waitcnt lgkmcnt(6)
    v_mfma_f32_16x16x32_bf16 v[80:83], a[40:43], v[176:179], v[80:83]
    ds_read_b64_tr_b16 a[12:13], v12 offset:40960
    v_mfma_f32_16x16x32_bf16 v[104:107], a[40:43], v[180:183], v[104:107]
    ds_read_b64_tr_b16 a[14:15], v12 offset:41216
    buffer_load_dwordx4 v[156:159], v4, s[36:39], s73 offen offset:2048 sc1
    v_mfma_f32_16x16x32_bf16 v[84:87], a[44:47], v[176:179], v[84:87]
    ds_read_b64_tr_b16 a[16:17], v10 offset:45056
    v_mfma_f32_16x16x32_bf16 v[108:111], a[44:47], v[180:183], v[108:111]
    ds_read_b64_tr_b16 a[18:19], v10 offset:45312
    s_waitcnt vmcnt(18)
    s_waitcnt lgkmcnt(6)
    v_mfma_f32_16x16x32_bf16 v[64:67], a[0:3], v[184:187], v[64:67]
    ds_read_b64_tr_b16 a[20:21], v12 offset:45056
    s_waitcnt vmcnt(15)
    s_mov_b32 s70, 30000
chk_28:
    v_cmp_ne_u32 vcc, v63, v26
    s_nop 3
    s_cbranch_vccz chk_28_d
    buffer_load_dword v63, v62, s[36:39], s61 offen sc1
    s_waitcnt vmcnt(0)
    s_sub_u32 s70, s70, 1
    s_cmp_lg_u32 s70, 0
    s_cbranch_scc1 chk_28
chk_28_d:
    s_lshl_b32 s3, s41, 1
    s_add_u32 s3, s3, s57
    s_add_u32 s3, s3, 0
    s_and_b32 s3, s3, 7
    s_lshl_b32 s3, s3, 11
    s_add_u32 s61, s3, s74
    buffer_load_dwordx4 a[96:99], v4, s[36:39], s61 offen offset:0 sc1
    v_mfma_f32_16x16x32_bf16 v[88:91], a[0:3], v[188:191], v[88:91]
    ds_read_b64_tr_b16 a[22:23], v12 offset:45312
    v_mfma_f32_16x16x32_bf16 v[68:71], a[4:7], v[184:187], v[68:71]
    ds_read_b64_tr_b16 a[24:25], v10 offset:38912
    v_mfma_f32_16x16x32_bf16 v[92:95], a[4:7], v[188:191], v[92:95]
    ds_read_b64_tr_b16 a[26:27], v10 offset:39168
    buffer_load_dwordx4 a[100:103], v4, s[36:39], s61 offen offset:1024 sc1
    s_waitcnt lgkmcnt(6)
    v_mfma_f32_16x16x32_bf16 v[72:75], a[8:11], v[184:187], v[72:75]
    ds_read_b64_tr_b16 a[28:29], v12 offset:38912
    v_mfma_f32_16x16x32_bf16 v[96:99], a[8:11], v[188:191], v[96:99]
    ds_read_b64_tr_b16 a[30:31], v12 offset:39168
    v_mfma_f32_16x16x32_bf16 v[76:79], a[12:15], v[184:187], v[76:79]
    ds_read_b64_tr_b16 a[32:33], v10 offset:43008
    s_lshl_b32 s3, s41, 1
    s_add_u32 s3, s3, s57
    s_add_u32 s3, s3, 1
    s_and_b32 s3, s3, 7
    s_lshl_b32 s3, s3, 11
    s_add_u32 s61, s3, s74
    buffer_load_dwordx4 a[104:107], v4, s[36:39], s61 offen offset:0 sc1
    v_mfma_f32_16x16x32_bf16 v[100:103], a[12:15], v[188:191], v[100:103]
    ds_read_b64_tr_b16 a[34:35], v10 offset:43264
    s_waitcnt lgkmcnt(6)
    v_mfma_f32_16x16x32_bf16 v[80:83], a[16:19], v[184:187], v[80:83]
    ds_read_b64_tr_b16 a[36:37], v12 offset:43008
    v_mfma_f32_16x16x32_bf16 v[104:107], a[16:19], v[188:191], v[104:107]
    ds_read_b64_tr_b16 a[38:39], v12 offset:43264
    buffer_load_dwordx4 a[108:111], v4, s[36:39], s61 offen offset:1024 sc1
    v_mfma_f32_16x16x32_bf16 v[84:87], a[20:23], v[184:187], v[84:87]
    ds_read_b64_tr_b16 a[40:41], v10 offset:47104
    v_mfma_f32_16x16x32_bf16 v[108:111], a[20:23], v[188:191], v[108:111]
    ds_read_b64_tr_b16 a[42:43], v10 offset:47360
    s_waitcnt vmcnt(20)
    s_waitcnt lgkmcnt(6)
    v_mfma_f32_16x16x32_bf16 v[64:67], a[24:27], v[192:195], v[64:67]
    ds_read_b64_tr_b16 a[44:45], v12 offset:47104
    buffer_load_dwordx4 v[160:163], v4, s[36:39], s73 offen offset:1024 sc1
    v_mfma_f32_16x16x32_bf16 v[88:91], a[24:27], v[196:199], v[88:91]
    ds_read_b64_tr_b16 a[46:47], v12 offset:47360
    v_mfma_f32_16x16x32_bf16 v[68:71], a[28:31], v[192:195], v[68:71]
    ds_read_b64_tr_b16 a[0:1], v11 offset:0
    v_mfma_f32_16x16x32_bf16 v[92:95], a[28:31], v[196:199], v[92:95]
    ds_read_b64_tr_b16 a[2:3], v11 offset:256
    buffer_load_dwordx4 v[164:167], v4, s[36:39], s73 offen offset:3072 sc1
    s_waitcnt lgkmcnt(6)
    v_mfma_f32_16x16x32_bf16 v[72:75], a[32:35], v[192:195], v[72:75]
    ds_read_b64_tr_b16 a[4:5], v13 offset:0
    v_mfma_f32_16x16x32_bf16 v[96:99], a[32:35], v[196:199], v[96:99]
    ds_read_b64_tr_b16 a[6:7], v13 offset:256
    v_mfma_f32_16x16x32_bf16 v[76:79], a[36:39], v[192:195], v[76:79]
    ds_read_b64_tr_b16 a[8:9], v11 offset:4096
    v_mfma_f32_16x16x32_bf16 v[100:103], a[36:39], v[196:199], v[100:103]
    ds_read_b64_tr_b16 a[10:11], v11 offset:4352
    s_waitcnt lgkmcnt(6)
    v_mfma_f32_16x16x32_bf16 v[80:83], a[40:43], v[192:195], v[80:83]
    ds_read_b64_tr_b16 a[12:13], v13 offset:4096
    v_mfma_f32_16x16x32_bf16 v[104:107], a[40:43], v[196:199], v[104:107]
    ds_read_b64_tr_b16 a[14:15], v13 offset:4352
    v_mfma_f32_16x16x32_bf16 v[84:87], a[44:47], v[192:195], v[84:87]
    ds_read_b64_tr_b16 a[16:17], v11 offset:8192
    v_mfma_f32_16x16x32_bf16 v[108:111], a[44:47], v[196:199], v[108:111]
    ds_read_b64_tr_b16 a[18:19], v11 offset:8448
    s_waitcnt vmcnt(19)
    s_waitcnt lgkmcnt(6)
    v_mfma_f32_16x16x32_bf16 v[64:67], a[0:3], v[200:203], v[64:67]
    ds_read_b64_tr_b16 a[20:21], v13 offset:8192
    s_add_u32 s3, s77, 2097152
    s_mov_b64 exec, 0xffff
    buffer_load_dword a249, v21, s[36:39], s3 offen
    s_mov_b64 exec, -1
    v_mfma_f32_16x16x32_bf16 v[88:91], a[0:3], v[204:207], v[88:91]
    ds_read_b64_tr_b16 a[22:23], v13 offset:8448
    v_mfma_f32_16x16x32_bf16 v[68:71], a[4:7], v[200:203], v[68:71]
    ds_read_b64_tr_b16 a[24:25], v11 offset:2048
    v_mfma_f32_16x16x32_bf16 v[92:95], a[4:7], v[204:207], v[92:95]
    ds_read_b64_tr_b16 a[26:27], v11 offset:2304
    s_add_u32 s3, s76, 3211264
    s_mov_b64 exec, 0xffff
    buffer_load_dword v55, v20, s[16:19], s3 offen
    s_mov_b64 exec, -1
    s_waitcnt lgkmcnt(6)
    v_mfma_f32_16x16x32_bf16 v[72:75], a[8:11], v[200:203], v[72:75]
    ds_read_b64_tr_b16 a[28:29], v13 offset:2048
    v_mfma_f32_16x16x32_bf16 v[96:99], a[8:11], v[204:207], v[96:99]
    ds_read_b64_tr_b16 a[30:31], v13 offset:2304
    v_mfma_f32_16x16x32_bf16 v[76:79], a[12:15], v[200:203], v[76:79]
    ds_read_b64_tr_b16 a[32:33], v11 offset:6144
    v_mfma_f32_16x16x32_bf16 v[100:103], a[12:15], v[204:207], v[100:103]
    ds_read_b64_tr_b16 a[34:35], v11 offset:6400
    s_waitcnt lgkmcnt(6)
    v_mfma_f32_16x16x32_bf16 v[80:83], a[16:19], v[200:203], v[80:83]
    ds_read_b64_tr_b16 a[36:37], v13 offset:6144
    v_mfma_f32_16x16x32_bf16 v[104:107], a[16:19], v[204:207], v[104:107]
    ds_read_b64_tr_b16 a[38:39], v13 offset:6400
    v_mfma_f32_16x16x32_bf16 v[84:87], a[20:23], v[200:203], v[84:87]
    ds_read_b64_tr_b16 a[40:41], v11 offset:10240
    v_mfma_f32_16x16x32_bf16 v[108:111], a[20:23], v[204:207], v[108:111]
    ds_read_b64_tr_b16 a[42:43], v11 offset:10496
    s_waitcnt vmcnt(18)
    s_waitcnt lgkmcnt(6)
    v_mfma_f32_16x16x32_bf16 v[64:67], a[24:27], v[208:211], v[64:67]
    ds_read_b64_tr_b16 a[44:45], v13 offset:10240
    s_add_u32 s3, s76, 2752512
    s_mov_b64 exec, 0xffff
    buffer_load_dword v55, v20, s[16:19], s3 offen
    s_mov_b64 exec, -1
    v_mfma_f32_16x16x32_bf16 v[88:91], a[24:27], v[212:215], v[88:91]
    ds_read_b64_tr_b16 a[46:47], v13 offset:10496
    v_mfma_f32_16x16x32_bf16 v[68:71], a[28:31], v[208:211], v[68:71]
    ds_read_b64_tr_b16 a[0:1], v11 offset:12288
    v_mfma_f32_16x16x32_bf16 v[92:95], a[28:31], v[212:215], v[92:95]
    ds_read_b64_tr_b16 a[2:3], v11 offset:12544
    s_waitcnt lgkmcnt(6)
    v_mfma_f32_16x16x32_bf16 v[72:75], a[32:35], v[208:211], v[72:75]
    ds_read_b64_tr_b16 a[4:5], v13 offset:12288
    v_mfma_f32_16x16x32_bf16 v[96:99], a[32:35], v[212:215], v[96:99]
    ds_read_b64_tr_b16 a[6:7], v13 offset:12544
    v_mfma_f32_16x16x32_bf16 v[76:79], a[36:39], v[208:211], v[76:79]
    ds_read_b64_tr_b16 a[8:9], v11 offset:16384
    v_mfma_f32_16x16x32_bf16 v[100:103], a[36:39], v[212:215], v[100:103]
    ds_read_b64_tr_b16 a[10:11], v11 offset:16640
    s_waitcnt lgkmcnt(6)
    v_mfma_f32_16x16x32_bf16 v[80:83], a[40:43], v[208:211], v[80:83]
    ds_read_b64_tr_b16 a[12:13], v13 offset:16384
    v_mfma_f32_16x16x32_bf16 v[104:107], a[40:43], v[212:215], v[104:107]
    ds_read_b64_tr_b16 a[14:15], v13 offset:16640
    v_mfma_f32_16x16x32_bf16 v[84:87], a[44:47], v[208:211], v[84:87]
    ds_read_b64_tr_b16 a[16:17], v11 offset:20480
    v_mfma_f32_16x16x32_bf16 v[108:111], a[44:47], v[212:215], v[108:111]
    ds_read_b64_tr_b16 a[18:19], v11 offset:20736
    s_waitcnt vmcnt(5)
    s_mov_b32 exec_lo, 0xfffefffe
    s_mov_b32 exec_hi, 0xfffefffe
    ds_write_b128 v25, a[96:99] offset:0
    ds_write_b128 v25, a[100:103] offset:1024
    ds_write_b128 v25, a[104:107] offset:2048
    ds_write_b128 v25, a[108:111] offset:3072
    s_mov_b64 exec, -1
    s_waitcnt lgkmcnt(0)
    s_barrier
    s_waitcnt vmcnt(17)
    s_waitcnt lgkmcnt(10)
    v_mfma_f32_16x16x32_bf16 v[64:67], a[0:3], v[216:219], v[64:67]
    ds_read_b64_tr_b16 a[20:21], v13 offset:20480
    s_add_u32 s3, s76, 2293760
    s_mov_b64 exec, 0xffff
    buffer_load_dword v55, v20, s[16:19], s3 offen
    s_mov_b64 exec, -1
    v_mfma_f32_16x16x32_bf16 v[88:91], a[0:3], v[220:223], v[88:91]
    ds_read_b64_tr_b16 a[22:23], v13 offset:20736
    ds_read_b128 a[48:51], v18 offset:0
    ds_read_b64_tr_b16 a[52:53], v14 offset:0
    ds_read_b64_tr_b16 a[54:55], v14 offset:256
    v_mfma_f32_16x16x32_bf16 v[68:71], a[4:7], v[216:219], v[68:71]
    ds_read_b64_tr_b16 a[24:25], v11 offset:14336
    v_mfma_f32_16x16x32_bf16 v[92:95], a[4:7], v[220:223], v[92:95]
    ds_read_b64_tr_b16 a[26:27], v11 offset:14592
    s_waitcnt lgkmcnt(13)
    v_mfma_f32_16x16x32_bf16 v[72:75], a[8:11], v[216:219], v[72:75]
    ds_read_b64_tr_b16 a[28:29], v13 offset:14336
    v_mfma_f32_16x16x32_bf16 v[96:99], a[8:11], v[220:223], v[96:99]
    ds_read_b64_tr_b16 a[30:31], v13 offset:14592
    ds_read_b128 a[60:63], v19 offset:0
    ds_read_b64_tr_b16 a[64:65], v14 offset:2048
    ds_read_b64_tr_b16 a[66:67], v14 offset:2304
    v_mfma_f32_16x16x32_bf16 v[76:79], a[12:15], v[216:219], v[76:79]
    ds_read_b64_tr_b16 a[32:33], v11 offset:18432
    v_mfma_f32_16x16x32_bf16 v[100:103], a[12:15], v[220:223], v[100:103]
    ds_read_b64_tr_b16 a[34:35], v11 offset:18688
    s_waitcnt lgkmcnt(12)
    v_mfma_f32_16x16x32_bf16 v[80:83], a[16:19], v[216:219], v[80:83]
    ds_read_b64_tr_b16 a[36:37], v13 offset:18432
    v_mfma_f32_16x16x32_bf16 v[104:107], a[16:19], v[220:223], v[104:107]
    ds_read_b64_tr_b16 a[38:39], v13 offset:18688
    s_waitcnt lgkmcnt(11)
    v_mfma_f32_16x16x32_bf16 v[112:115], a[52:55], a[48:51], 0
    ds_read_b128 a[72:75], v18 offset:2048
    ds_read_b64_tr_b16 a[76:77], v14 offset:12288
    ds_read_b64_tr_b16 a[78:79], v14 offset:12544
    v_mfma_f32_16x16x32_bf16 v[84:87], a[20:23], v[216:219], v[84:87]
    ds_read_b64_tr_b16 a[40:41], v11 offset:22528
    v_mfma_f32_16x16x32_bf16 v[108:111], a[20:23], v[220:223], v[108:111]
    ds_read_b64_tr_b16 a[42:43], v11 offset:22784
    s_waitcnt vmcnt(16)
    s_waitcnt lgkmcnt(12)
    v_mfma_f32_16x16x32_bf16 v[64:67], a[24:27], v[224:227], v[64:67]
    ds_read_b64_tr_b16 a[44:45], v13 offset:22528
    s_add_u32 s3, s76, 1835008
    s_mov_b64 exec, 0xffff
    buffer_load_dword v55, v20, s[16:19], s3 offen
    s_mov_b64 exec, -1
    v_mfma_f32_16x16x32_bf16 v[88:91], a[24:27], v[228:231], v[88:91]
    ds_read_b64_tr_b16 a[46:47], v13 offset:22784
    s_waitcnt lgkmcnt(11)
    v_mfma_f32_16x16x32_bf16 v[112:115], a[64:67], a[60:63], v[112:115]
    ds_read_b128 a[84:87], v19 offset:2048
    ds_read_b64_tr_b16 a[88:89], v14 offset:14336
    ds_read_b64_tr_b16 a[90:91], v14 offset:14592
    v_mfma_f32_16x16x32_bf16 v[68:71], a[28:31], v[224:227], v[68:71]
    ds_read_b64_tr_b16 a[0:1], v11 offset:24576
    v_mfma_f32_16x16x32_bf16 v[92:95], a[28:31], v[228:231], v[92:95]
    ds_read_b64_tr_b16 a[2:3], v11 offset:24832
    s_waitcnt lgkmcnt(12)
    v_mfma_f32_16x16x32_bf16 v[72:75], a[32:35], v[224:227], v[72:75]
    ds_read_b64_tr_b16 a[4:5], v13 offset:24576
    v_mfma_f32_16x16x32_bf16 v[96:99], a[32:35], v[228:231], v[96:99]
    ds_read_b64_tr_b16 a[6:7], v13 offset:24832
    s_waitcnt lgkmcnt(11)
    v_mfma_f32_16x16x32_bf16 v[112:115], a[76:79], a[72:75], v[112:115]
    ds_read_b128 a[48:51], v18 offset:4096
    ds_read_b64_tr_b16 a[52:53], v14 offset:24576
    ds_read_b64_tr_b16 a[54:55], v14 offset:24832
    v_mfma_f32_16x16x32_bf16 v[76:79], a[36:39], v[224:227], v[76:79]
    ds_read_b64_tr_b16 a[8:9], v11 offset:28672
    v_mfma_f32_16x16x32_bf16 v[100:103], a[36:39], v[228:231], v[100:103]
    ds_read_b64_tr_b16 a[10:11], v11 offset:28928
    s_waitcnt lgkmcnt(12)
    v_mfma_f32_16x16x32_bf16 v[80:83], a[40:43], v[224:227], v[80:83]
    ds_read_b64_tr_b16 a[12:13], v13 offset:28672
    v_mfma_f32_16x16x32_bf16 v[104:107], a[40:43], v[228:231], v[104:107]
    ds_read_b64_tr_b16 a[14:15], v13 offset:28928
    s_waitcnt lgkmcnt(11)
    v_mfma_f32_16x16x32_bf16 v[112:115], a[88:91], a[84:87], v[112:115]
    ds_read_b128 a[60:63], v19 offset:4096
    ds_read_b64_tr_b16 a[64:65], v14 offset:26624
    ds_read_b64_tr_b16 a[66:67], v14 offset:26880
    v_mfma_f32_16x16x32_bf16 v[84:87], a[44:47], v[224:227], v[84:87]
    ds_read_b64_tr_b16 a[16:17], v11 offset:32768
    v_mfma_f32_16x16x32_bf16 v[108:111], a[44:47], v[228:231], v[108:111]
    ds_read_b64_tr_b16 a[18:19], v11 offset:33024
    s_waitcnt vmcnt(15)
    s_waitcnt lgkmcnt(12)
    v_mfma_f32_16x16x32_bf16 v[64:67], a[0:3], v[136:139], v[64:67]
    ds_read_b64_tr_b16 a[20:21], v13 offset:32768
    s_add_u32 m0, s44, 98304
    s_add_u32 s63, s54, 0
    buffer_load_dwordx4 v7, s[12:15], s63 offen lds
    v_mfma_f32_16x16x32_bf16 v[88:91], a[0:3], v[140:143], v[88:91]
    ds_read_b64_tr_b16 a[22:23], v13 offset:33024
    s_waitcnt lgkmcnt(11)
    v_mfma_f32_16x16x32_bf16 v[112:115], a[52:55], a[48:51], v[112:115]
    ds_read_b128 a[72:75], v18 offset:6144
    ds_read_b64_tr_b16 a[76:77], v14 offset:36864
    ds_read_b64_tr_b16 a[78:79], v14 offset:37120
    v_mfma_f32_16x16x32_bf16 v[68:71], a[4:7], v[136:139], v[68:71]
    ds_read_b64_tr_b16 a[24:25], v11 offset:26624
    v_mfma_f32_16x16x32_bf16 v[92:95], a[4:7], v[140:143], v[92:95]
    ds_read_b64_tr_b16 a[26:27], v11 offset:26880
    s_add_u32 m0, s44, 102400
    s_add_u32 s63, s54, 32768
    buffer_load_dwordx4 v7, s[12:15], s63 offen lds
    s_waitcnt lgkmcnt(12)
    v_mfma_f32_16x16x32_bf16 v[72:75], a[8:11], v[136:139], v[72:75]
    ds_read_b64_tr_b16 a[28:29], v13 offset:26624
    v_mfma_f32_16x16x32_bf16 v[96:99], a[8:11], v[140:143], v[96:99]
    ds_read_b64_tr_b16 a[30:31], v13 offset:26880
    s_waitcnt lgkmcnt(11)
    v_mfma_f32_16x16x32_bf16 v[112:115], a[64:67], a[60:63], v[112:115]
    ds_read_b128 a[84:87], v19 offset:6144
    ds_read_b64_tr_b16 a[88:89], v14 offset:38912
    ds_read_b64_tr_b16 a[90:91], v14 offset:39168
    v_mfma_f32_16x16x32_bf16 v[76:79], a[12:15], v[136:139], v[76:79]
    ds_read_b64_tr_b16 a[32:33], v11 offset:30720
    v_lshlrev_b32 v62, 4, v3
    s_lshl_b32 s61, s45, 11
    s_sub_u32 s78, s61, 256
    s_max_i32 s78, s78, 0
    s_add_u32 s78, s78, 720896
    s_lshl_b32 s3, s41, 9
    s_add_u32 s61, s61, s3
    s_add_u32 s61, s61, 720896
    buffer_load_dwordx4 v[120:123], v62, s[36:39], s61 offen offset:0 sc1
    buffer_load_dwordx4 v[124:127], v62, s[36:39], s61 offen offset:256 sc1
    buffer_load_dwordx4 v[128:131], v62, s[36:39], s78 offen offset:0 sc1
    v_mfma_f32_16x16x32_bf16 v[100:103], a[12:15], v[140:143], v[100:103]
    ds_read_b64_tr_b16 a[34:35], v11 offset:30976
    s_waitcnt lgkmcnt(12)
    v_mfma_f32_16x16x32_bf16 v[80:83], a[16:19], v[136:139], v[80:83]
    ds_read_b64_tr_b16 a[36:37], v13 offset:30720
    v_mfma_f32_16x16x32_bf16 v[104:107], a[16:19], v[140:143], v[104:107]
    ds_read_b64_tr_b16 a[38:39], v13 offset:30976
    s_add_u32 s3, s76, 1376256
    s_mov_b64 exec, 0xffff
    buffer_load_dword v55, v20, s[16:19], s3 offen
    s_mov_b64 exec, -1
    s_waitcnt lgkmcnt(11)
    v_mfma_f32_16x16x32_bf16 v[112:115], a[76:79], a[72:75], v[112:115]
    ds_read_b128 a[48:51], v18 offset:8192
    ds_read_b64_tr_b16 a[52:53], v15 offset:0
    ds_read_b64_tr_b16 a[54:55], v15 offset:256
    v_mfma_f32_16x16x32_bf16 v[84:87], a[20:23], v[136:139], v[84:87]
    ds_read_b64_tr_b16 a[40:41], v11 offset:34816
    v_mfma_f32_16x16x32_bf16 v[108:111], a[20:23], v[140:143], v[108:111]
    ds_read_b64_tr_b16 a[42:43], v11 offset:35072
    s_waitcnt vmcnt(19)
    s_waitcnt lgkmcnt(12)
    v_mfma_f32_16x16x32_bf16 v[64:67], a[24:27], v[144:147], v[64:67]
    ds_read_b64_tr_b16 a[44:45], v13 offset:34816
    s_add_u32 m0, s44, 106496
    s_add_u32 s63, s54, 65536
    buffer_load_dwordx4 v7, s[12:15], s63 offen lds
    v_mfma_f32_16x16x32_bf16 v[88:91], a[24:27], v[148:151], v[88:91]
    ds_read_b64_tr_b16 a[46:47], v13 offset:35072
    s_waitcnt lgkmcnt(11)
    v_mfma_f32_16x16x32_bf16 v[112:115], a[88:91], a[84:87], v[112:115]
    ds_read_b128 a[60:63], v19 offset:8192
    ds_read_b64_tr_b16 a[64:65], v15 offset:2048
    ds_read_b64_tr_b16 a[66:67], v15 offset:2304
    v_mfma_f32_16x16x32_bf16 v[68:71], a[28:31], v[144:147], v[68:71]
    ds_read_b64_tr_b16 a[0:1], v11 offset:36864
    v_mfma_f32_16x16x32_bf16 v[92:95], a[28:31], v[148:151], v[92:95]
    ds_read_b64_tr_b16 a[2:3], v11 offset:37120
    s_add_u32 m0, s44, 110592
    s_add_u32 s63, s54, 98304
    buffer_load_dwordx4 v7, s[12:15], s63 offen lds
    s_waitcnt lgkmcnt(12)
    v_mfma_f32_16x16x32_bf16 v[72:75], a[32:35], v[144:147], v[72:75]
    ds_read_b64_tr_b16 a[4:5], v13 offset:36864
    v_mfma_f32_16x16x32_bf16 v[96:99], a[32:35], v[148:151], v[96:99]
    ds_read_b64_tr_b16 a[6:7], v13 offset:37120
    s_waitcnt lgkmcnt(11)
    v_mfma_f32_16x16x32_bf16 v[112:115], a[52:55], a[48:51], v[112:115]
    ds_read_b128 a[72:75], v18 offset:10240
    ds_read_b64_tr_b16 a[76:77], v15 offset:12288
    ds_read_b64_tr_b16 a[78:79], v15 offset:12544
    v_mfma_f32_16x16x32_bf16 v[76:79], a[36:39], v[144:147], v[76:79]
    ds_read_b64_tr_b16 a[8:9], v11 offset:40960
    s_add_u32 s3, s76, 917504
    s_mov_b64 exec, 0xffff
    buffer_load_dword v55, v20, s[16:19], s3 offen
    s_mov_b64 exec, -1
    v_mfma_f32_16x16x32_bf16 v[100:103], a[36:39], v[148:151], v[100:103]
    ds_read_b64_tr_b16 a[10:11], v11 offset:41216
    s_waitcnt lgkmcnt(12)
    v_mfma_f32_16x16x32_bf16 v[80:83], a[40:43], v[144:147], v[80:83]
    ds_read_b64_tr_b16 a[12:13], v13 offset:40960
    v_mfma_f32_16x16x32_bf16 v[104:107], a[40:43], v[148:151], v[104:107]
    ds_read_b64_tr_b16 a[14:15], v13 offset:41216
    s_waitcnt lgkmcnt(11)
    v_mfma_f32_16x16x32_bf16 v[112:115], a[64:67], a[60:63], v[112:115]
    ds_read_b128 a[84:87], v19 offset:10240
    ds_read_b64_tr_b16 a[88:89], v15 offset:14336
    ds_read_b64_tr_b16 a[90:91], v15 offset:14592
    v_mfma_f32_16x16x32_bf16 v[84:87], a[44:47], v[144:147], v[84:87]
    ds_read_b64_tr_b16 a[16:17], v11 offset:45056
    v_mfma_f32_16x16x32_bf16 v[108:111], a[44:47], v[148:151], v[108:111]
    ds_read_b64_tr_b16 a[18:19], v11 offset:45312
    s_waitcnt vmcnt(20)
    s_waitcnt lgkmcnt(12)
    v_mfma_f32_16x16x32_bf16 v[64:67], a[0:3], v[152:155], v[64:67]
    ds_read_b64_tr_b16 a[20:21], v13 offset:45056
    s_add_u32 m0, s44, 114688
    s_add_u32 s63, s54, 131072
    buffer_load_dwordx4 v7, s[12:15], s63 offen lds
    v_mfma_f32_16x16x32_bf16 v[88:91], a[0:3], v[156:159], v[88:91]
    ds_read_b64_tr_b16 a[22:23], v13 offset:45312
    s_waitcnt lgkmcnt(11)
    v_mfma_f32_16x16x32_bf16 v[112:115], a[76:79], a[72:75], v[112:115]
    ds_read_b128 a[48:51], v18 offset:12288
    ds_read_b64_tr_b16 a[52:53], v15 offset:24576
    ds_read_b64_tr_b16 a[54:55], v15 offset:24832
    v_mfma_f32_16x16x32_bf16 v[68:71], a[4:7], v[152:155], v[68:71]
    ds_read_b64_tr_b16 a[24:25], v11 offset:38912
    v_mfma_f32_16x16x32_bf16 v[92:95], a[4:7], v[156:159], v[92:95]
    ds_read_b64_tr_b16 a[26:27], v11 offset:39168
    s_add_u32 m0, s44, 118784
    s_add_u32 s63, s54, 163840
    buffer_load_dwordx4 v7, s[12:15], s63 offen lds
    s_waitcnt lgkmcnt(12)
    v_mfma_f32_16x16x32_bf16 v[72:75], a[8:11], v[152:155], v[72:75]
    ds_read_b64_tr_b16 a[28:29], v13 offset:38912
    v_mfma_f32_16x16x32_bf16 v[96:99], a[8:11], v[156:159], v[96:99]
    ds_read_b64_tr_b16 a[30:31], v13 offset:39168
    s_waitcnt lgkmcnt(11)
    v_mfma_f32_16x16x32_bf16 v[112:115], a[88:91], a[84:87], v[112:115]
    ds_read_b128 a[60:63], v19 offset:12288
    ds_read_b64_tr_b16 a[64:65], v15 offset:26624
    ds_read_b64_tr_b16 a[66:67], v15 offset:26880
    v_mfma_f32_16x16x32_bf16 v[76:79], a[12:15], v[152:155], v[76:79]
    ds_read_b64_tr_b16 a[32:33], v11 offset:43008
    s_add_u32 s3, s76, 458752
    s_mov_b64 exec, 0xffff
    buffer_load_dword v55, v20, s[16:19], s3 offen
    s_mov_b64 exec, -1
    v_mfma_f32_16x16x32_bf16 v[100:103], a[12:15], v[156:159], v[100:103]
    ds_read_b64_tr_b16 a[34:35], v11 offset:43264
    s_waitcnt lgkmcnt(12)
    v_mfma_f32_16x16x32_bf16 v[80:83], a[16:19], v[152:155], v[80:83]
    ds_read_b64_tr_b16 a[36:37], v13 offset:43008
    v_mfma_f32_16x16x32_bf16 v[104:107], a[16:19], v[156:159], v[104:107]
    ds_read_b64_tr_b16 a[38:39], v13 offset:43264
    s_waitcnt lgkmcnt(11)
    v_mfma_f32_16x16x32_bf16 v[112:115], a[52:55], a[48:51], v[112:115]
    ds_read_b128 a[72:75], v18 offset:14336
    ds_read_b64_tr_b16 a[76:77], v15 offset:36864
    ds_read_b64_tr_b16 a[78:79], v15 offset:37120
    v_mfma_f32_16x16x32_bf16 v[84:87], a[20:23], v[152:155], v[84:87]
    ds_read_b64_tr_b16 a[40:41], v11 offset:47104
    v_mfma_f32_16x16x32_bf16 v[108:111], a[20:23], v[156:159], v[108:111]
    ds_read_b64_tr_b16 a[42:43], v11 offset:47360
    s_waitcnt vmcnt(17)
    s_waitcnt lgkmcnt(12)
    v_mfma_f32_16x16x32_bf16 v[64:67], a[24:27], v[160:163], v[64:67]
    ds_read_b64_tr_b16 a[44:45], v13 offset:47104
    s_add_u32 m0, s44, 122880
    s_add_u32 s63, s54, 196608
    buffer_load_dwordx4 v7, s[12:15], s63 offen lds
    v_mfma_f32_16x16x32_bf16 v[88:91], a[24:27], v[164:167], v[88:91]
    ds_read_b64_tr_b16 a[46:47], v13 offset:47360
    s_waitcnt lgkmcnt(11)
    v_mfma_f32_16x16x32_bf16 v[112:115], a[64:67], a[60:63], v[112:115]
    ds_read_b128 a[84:87], v19 offset:14336
    ds_read_b64_tr_b16 a[88:89], v15 offset:38912
    ds_read_b64_tr_b16 a[90:91], v15 offset:39168
    v_mfma_f32_16x16x32_bf16 v[68:71], a[28:31], v[160:163], v[68:71]
    v_mfma_f32_16x16x32_bf16 v[92:95], a[28:31], v[164:167], v[92:95]
    s_add_u32 m0, s44, 126976
    s_add_u32 s63, s54, 229376
    buffer_load_dwordx4 v7, s[12:15], s63 offen lds
    s_waitcnt lgkmcnt(10)
    v_mfma_f32_16x16x32_bf16 v[72:75], a[32:35], v[160:163], v[72:75]
    v_mfma_f32_16x16x32_bf16 v[96:99], a[32:35], v[164:167], v[96:99]
    s_waitcnt lgkmcnt(7)
    v_mfma_f32_16x16x32_bf16 v[112:115], a[76:79], a[72:75], v[112:115]
    v_mfma_f32_16x16x32_bf16 v[76:79], a[36:39], v[160:163], v[76:79]
    s_add_u32 s3, s76, 0
    s_mov_b64 exec, 0xffff
    buffer_load_dword v55, v20, s[16:19], s3 offen
    s_mov_b64 exec, -1
    v_mfma_f32_16x16x32_bf16 v[100:103], a[36:39], v[164:167], v[100:103]
    s_waitcnt lgkmcnt(3)
    v_mfma_f32_16x16x32_bf16 v[80:83], a[40:43], v[160:163], v[80:83]
    v_mfma_f32_16x16x32_bf16 v[104:107], a[40:43], v[164:167], v[104:107]
    s_waitcnt lgkmcnt(0)
    v_mfma_f32_16x16x32_bf16 v[112:115], a[88:91], a[84:87], v[112:115]
    v_mfma_f32_16x16x32_bf16 v[84:87], a[44:47], v[160:163], v[84:87]
    v_mfma_f32_16x16x32_bf16 v[108:111], a[44:47], v[164:167], v[108:111]
    s_waitcnt vmcnt(10)
    s_mov_b32 s70, 30000
chk_29:
    v_xor_b32 v132, v121, v26
    v_xor_b32 v133, v123, v26
    v_xor_b32 v134, v125, v26
    v_xor_b32 v135, v127, v26
    v_or3_b32 v132, v132, v133, v134
    v_xor_b32 v133, v129, v26
    v_xor_b32 v134, v131, v26
    v_or3_b32 v132, v132, v135, v133
    v_or_b32 v132, v132, v134
    v_cmp_ne_u32 vcc, 0, v132
    s_nop 3
    s_cbranch_vccz chk_29_d
    buffer_load_dwordx4 v[120:123], v62, s[36:39], s61 offen offset:0 sc1
    buffer_load_dwordx4 v[124:127], v62, s[36:39], s61 offen offset:256 sc1
    buffer_load_dwordx4 v[128:131], v62, s[36:39], s78 offen offset:0 sc1
    s_waitcnt vmcnt(0)
    s_sub_u32 s70, s70, 1
    s_cmp_lg_u32 s70, 0
    s_cbranch_scc1 chk_29
chk_29_d:
    v_mov_b32_dpp v116, v112 row_newbcast:0 row_mask:0xf bank_mask:0xf
    v_mov_b32_dpp v117, v113 row_newbcast:0 row_mask:0xf bank_mask:0xf
    v_mov_b32_dpp v118, v114 row_newbcast:0 row_mask:0xf bank_mask:0xf
    v_mov_b32_dpp v119, v115 row_newbcast:0 row_mask:0xf bank_mask:0xf
    v_pk_mul_f32 v[112:113], v[112:113], v[128:129] op_sel_hi:[1,0]
    v_pk_mul_f32 v[114:115], v[114:115], v[128:129] op_sel_hi:[1,0]
    v_pk_fma_f32 v[112:113], v[116:117], v[130:131], v[112:113] op_sel_hi:[1,0,1]
    v_pk_fma_f32 v[114:115], v[118:119], v[130:131], v[114:115] op_sel_hi:[1,0,1]
    v_cvt_pk_bf16_f32 v216, v112, v113
    v_cvt_pk_bf16_f32 v217, v114, v115
    ds_write_b64 v50, v[216:217]
    v_pk_mul_f32 v[96:97], v[96:97], v[124:125] op_sel_hi:[1,0]
    v_pk_mul_f32 v[98:99], v[98:99], v[124:125] op_sel_hi:[1,0]
    v_pk_fma_f32 v[96:97], v[240:241], v[126:127], v[96:97] op_sel_hi:[1,0,1]
    v_pk_fma_f32 v[98:99], v[242:243], v[126:127], v[98:99] op_sel_hi:[1,0,1]
    v_cvt_pk_bf16_f32 v188, v96, v97
    v_cvt_pk_bf16_f32 v189, v98, v99
    ds_write_b64 v49, v[188:189] offset:1024
    v_pk_mul_f32 v[100:101], v[100:101], v[124:125] op_sel_hi:[1,0]
    v_pk_mul_f32 v[102:103], v[102:103], v[124:125] op_sel_hi:[1,0]
    v_pk_fma_f32 v[100:101], v[244:245], v[126:127], v[100:101] op_sel_hi:[1,0,1]
    v_pk_fma_f32 v[102:103], v[246:247], v[126:127], v[102:103] op_sel_hi:[1,0,1]
    v_cvt_pk_bf16_f32 v194, v100, v101
    v_cvt_pk_bf16_f32 v195, v102, v103
    ds_write_b64 v49, v[194:195] offset:1536
    v_pk_mul_f32 v[104:105], v[104:105], v[124:125] op_sel_hi:[1,0]
    v_pk_mul_f32 v[106:107], v[106:107], v[124:125] op_sel_hi:[1,0]
    v_pk_fma_f32 v[104:105], v[248:249], v[126:127], v[104:105] op_sel_hi:[1,0,1]
    v_pk_fma_f32 v[106:107], v[250:251], v[126:127], v[106:107] op_sel_hi:[1,0,1]
    v_cvt_pk_bf16_f32 v212, v104, v105
    v_cvt_pk_bf16_f32 v213, v106, v107
    ds_write_b64 v48, v[212:213] offset:2048
    v_pk_mul_f32 v[108:109], v[108:109], v[124:125] op_sel_hi:[1,0]
    v_pk_mul_f32 v[110:111], v[110:111], v[124:125] op_sel_hi:[1,0]
    v_pk_fma_f32 v[108:109], v[252:253], v[126:127], v[108:109] op_sel_hi:[1,0,1]
    v_pk_fma_f32 v[110:111], v[254:255], v[126:127], v[110:111] op_sel_hi:[1,0,1]
    v_cvt_pk_bf16_f32 v214, v108, v109
    v_cvt_pk_bf16_f32 v215, v110, v111
    ds_write_b64 v48, v[214:215] offset:2080
    v_pk_mul_f32 v[80:81], v[80:81], v[120:121] op_sel_hi:[1,0]
    v_pk_mul_f32 v[82:83], v[82:83], v[120:121] op_sel_hi:[1,0]
    v_pk_fma_f32 v[80:81], v[248:249], v[122:123], v[80:81] op_sel_hi:[1,0,1]
    v_pk_fma_f32 v[82:83], v[250:251], v[122:123], v[82:83] op_sel_hi:[1,0,1]
    v_cvt_pk_bf16_f32 v208, v80, v81
    v_cvt_pk_bf16_f32 v209, v82, v83
    ds_write_b64 v48, v[208:209] offset:1024
    v_pk_mul_f32 v[84:85], v[84:85], v[120:121] op_sel_hi:[1,0]
    v_pk_mul_f32 v[86:87], v[86:87], v[120:121] op_sel_hi:[1,0]
    v_pk_fma_f32 v[84:85], v[252:253], v[122:123], v[84:85] op_sel_hi:[1,0,1]
    v_pk_fma_f32 v[86:87], v[254:255], v[122:123], v[86:87] op_sel_hi:[1,0,1]
    v_cvt_pk_bf16_f32 v210, v84, v85
    v_cvt_pk_bf16_f32 v211, v86, v87
    ds_write_b64 v48, v[210:211] offset:1056
    v_pk_mul_f32 v[72:73], v[72:73], v[120:121] op_sel_hi:[1,0]
    v_pk_mul_f32 v[74:75], v[74:75], v[120:121] op_sel_hi:[1,0]
    v_pk_fma_f32 v[72:73], v[240:241], v[122:123], v[72:73] op_sel_hi:[1,0,1]
    v_pk_fma_f32 v[74:75], v[242:243], v[122:123], v[74:75] op_sel_hi:[1,0,1]
    v_cvt_pk_bf16_f32 v186, v72, v73
    v_cvt_pk_bf16_f32 v187, v74, v75
    v_pk_mul_f32 v[76:77], v[76:77], v[120:121] op_sel_hi:[1,0]
    v_pk_mul_f32 v[78:79], v[78:79], v[120:121] op_sel_hi:[1,0]
    v_pk_fma_f32 v[76:77], v[244:245], v[122:123], v[76:77] op_sel_hi:[1,0,1]
    v_pk_fma_f32 v[78:79], v[246:247], v[122:123], v[78:79] op_sel_hi:[1,0,1]
    v_cvt_pk_bf16_f32 v192, v76, v77
    v_cvt_pk_bf16_f32 v193, v78, v79
    s_waitcnt lgkmcnt(0)
    s_barrier
    ds_read_b64 v[184:185], v49 offset:0
    ds_read_b64 v[190:191], v49 offset:512
    ds_read_b64_tr_b16 v[196:197], v51 offset:0
    ds_read_b64_tr_b16 v[198:199], v51 offset:1024
    ds_read_b64_tr_b16 v[200:201], v51 offset:2048
    ds_read_b64_tr_b16 v[202:203], v51 offset:32
    ds_read_b64_tr_b16 v[204:205], v51 offset:1056
    ds_read_b64_tr_b16 v[206:207], v51 offset:2080
    v_pk_mul_f32 v[88:89], v[88:89], v[124:125] op_sel_hi:[1,0]
    v_pk_mul_f32 v[90:91], v[90:91], v[124:125] op_sel_hi:[1,0]
    v_pk_fma_f32 v[88:89], v[232:233], v[126:127], v[88:89] op_sel_hi:[1,0,1]
    s_add_u32 m0, s44, 0
    s_add_u32 s63, s54, 393216
    buffer_load_dwordx4 v7, s[12:15], s63 offen lds
    v_pk_fma_f32 v[90:91], v[234:235], v[126:127], v[90:91] op_sel_hi:[1,0,1]
    v_cvt_pk_bf16_f32 v180, v88, v89
    v_cvt_pk_bf16_f32 v181, v90, v91
    v_pk_mul_f32 v[92:93], v[92:93], v[124:125] op_sel_hi:[1,0]
    v_pk_mul_f32 v[94:95], v[94:95], v[124:125] op_sel_hi:[1,0]
    v_pk_fma_f32 v[92:93], v[236:237], v[126:127], v[92:93] op_sel_hi:[1,0,1]
    v_pk_fma_f32 v[94:95], v[238:239], v[126:127], v[94:95] op_sel_hi:[1,0,1]
    v_cvt_pk_bf16_f32 v182, v92, v93
    s_add_u32 m0, s44, 4096
    s_add_u32 s63, s54, 425984
    buffer_load_dwordx4 v7, s[12:15], s63 offen lds
    v_cvt_pk_bf16_f32 v183, v94, v95
    v_pk_mul_f32 v[64:65], v[64:65], v[120:121] op_sel_hi:[1,0]
    v_pk_mul_f32 v[66:67], v[66:67], v[120:121] op_sel_hi:[1,0]
    v_pk_fma_f32 v[64:65], v[232:233], v[122:123], v[64:65] op_sel_hi:[1,0,1]
    v_pk_fma_f32 v[66:67], v[234:235], v[122:123], v[66:67] op_sel_hi:[1,0,1]
    v_cvt_pk_bf16_f32 v176, v64, v65
    v_cvt_pk_bf16_f32 v177, v66, v67
    v_pk_mul_f32 v[68:69], v[68:69], v[120:121] op_sel_hi:[1,0]
    s_add_u32 m0, s44, 8192
    s_add_u32 s63, s54, 458752
    buffer_load_dwordx4 v7, s[12:15], s63 offen lds
    v_pk_mul_f32 v[70:71], v[70:71], v[120:121] op_sel_hi:[1,0]
    v_pk_fma_f32 v[68:69], v[236:237], v[122:123], v[68:69] op_sel_hi:[1,0,1]
    v_pk_fma_f32 v[70:71], v[238:239], v[122:123], v[70:71] op_sel_hi:[1,0,1]
    v_cvt_pk_bf16_f32 v178, v68, v69
    v_cvt_pk_bf16_f32 v179, v70, v71
    v_mfma_f32_16x16x16_bf16 v[80:83], v[188:189], v[180:181], 0
    v_mfma_f32_16x16x16_bf16 v[64:67], v[186:187], v[180:181], 0
    v_mfma_f32_16x16x16_bf16 v[84:87], v[194:195], v[182:183], 0
    v_mfma_f32_16x16x16_bf16 v[68:71], v[192:193], v[182:183], 0
    s_waitcnt lgkmcnt(6)
    v_mfma_f32_16x16x16_bf16 v[88:91], v[186:187], v[176:177], 0
    v_mfma_f32_16x16x16_bf16 v[72:75], v[184:185], v[176:177], v[44:47]
    v_mfma_f32_16x16x16_bf16 v[92:95], v[192:193], v[178:179], 0
    v_mfma_f32_16x16x16_bf16 v[76:79], v[190:191], v[178:179], v[44:47]
    v_cndmask_b32 v80, v80, v81, s[64:65]
    v_cndmask_b32 v64, v64, v65, s[64:65]
    v_cndmask_b32 v82, v82, v83, s[64:65]
    s_add_u32 m0, s44, 12288
    s_add_u32 s63, s54, 491520
    buffer_load_dwordx4 v7, s[12:15], s63 offen lds
    v_cndmask_b32 v66, v66, v67, s[64:65]
    v_cndmask_b32 v96, v64, v80, s[66:67]
    v_cndmask_b32 v97, v66, v82, s[68:69]
    v_max_f32 v104, v96, v97
    v_cndmask_b32 v84, v84, v85, s[64:65]
    v_cndmask_b32 v68, v68, v69, s[64:65]
    v_cndmask_b32 v86, v86, v87, s[64:65]
    v_cndmask_b32 v70, v70, v71, s[64:65]
    s_add_u32 m0, s44, 16384
    s_add_u32 s63, s55, 2064384
    buffer_load_dwordx4 v8, s[16:19], s63 offen lds
    v_cndmask_b32 v98, v68, v84, s[66:67]
    v_cndmask_b32 v99, v70, v86, s[68:69]
    v_max_f32 v106, v98, v99
    v_cndmask_b32 v88, v88, v89, s[64:65]
    v_cndmask_b32 v72, v72, v73, s[64:65]
    v_cndmask_b32 v90, v90, v91, s[64:65]
    v_cndmask_b32 v74, v74, v75, s[64:65]
    v_cndmask_b32 v100, v72, v88, s[66:67]
    s_add_u32 m0, s44, 20480
    s_add_u32 s63, s55, 5734400
    buffer_load_dwordx4 v8, s[16:19], s63 offen lds
    v_cndmask_b32 v101, v74, v90, s[68:69]
    v_max_f32 v108, v100, v101
    v_cndmask_b32 v92, v92, v93, s[64:65]
    v_cndmask_b32 v76, v76, v77, s[64:65]
    v_cndmask_b32 v94, v94, v95, s[64:65]
    v_cndmask_b32 v78, v78, v79, s[64:65]
    v_cndmask_b32 v102, v76, v92, s[66:67]
    v_cndmask_b32 v103, v78, v94, s[68:69]
    s_add_u32 m0, s44, 24576
    s_add_u32 s63, s55, 2179072
    buffer_load_dwordx4 v8, s[16:19], s63 offen lds
    v_max_f32 v110, v102, v103
    v_permlane32_swap_b32 v104, v106
    s_nop 0
    v_permlane32_swap_b32 v108, v110
    v_max_f32 v104, v104, v106
    v_max_f32 v108, v108, v110
    s_nop 1
    v_permlane16_swap_b32 v104, v108
    v_max_f32 v104, v104, v108
    s_mov_b32 s58, 0x3eb8aa3b
    v_mul_f32 v104, 0xbeb8aa3b, v104
    v_mov_b32 v108, v104
    s_nop 1
    v_permlane16_swap_b32 v104, v108
    v_mov_b32 v106, v104
    v_mov_b32 v110, v108
    s_nop 0
    v_permlane32_swap_b32 v104, v106
    v_permlane32_swap_b32 v108, v110
    v_pk_fma_f32 v[96:97], v[96:97], s[58:59], v[104:105] op_sel_hi:[1,0,0]
    v_pk_fma_f32 v[98:99], v[98:99], s[58:59], v[106:107] op_sel_hi:[1,0,0]
    v_pk_fma_f32 v[100:101], v[100:101], s[58:59], v[108:109] op_sel_hi:[1,0,0]
    v_pk_fma_f32 v[102:103], v[102:103], s[58:59], v[110:111] op_sel_hi:[1,0,0]
    v_exp_f32 v96, v96
    v_exp_f32 v97, v97
    v_exp_f32 v98, v98
    v_exp_f32 v99, v99
    v_exp_f32 v100, v100
    v_exp_f32 v101, v101
    v_exp_f32 v102, v102
    v_exp_f32 v103, v103
    v_cvt_pk_bf16_f32 v96, v96, v97
    v_cvt_pk_bf16_f32 v98, v98, v99
    v_cvt_pk_bf16_f32 v100, v100, v101
    v_cvt_pk_bf16_f32 v102, v102, v103
    s_waitcnt lgkmcnt(0)
    v_perm_b32 v64, v96, v96, v40
    v_perm_b32 v65, v96, v96, v41
    v_perm_b32 v66, v96, v96, v42
    v_perm_b32 v67, v96, v96, v43
    v_perm_b32 v68, v98, v98, v40
    v_perm_b32 v69, v98, v98, v41
    v_perm_b32 v70, v98, v98, v42
    v_perm_b32 v71, v98, v98, v43
    v_mfma_f32_16x16x32_bf16 v[136:139], v[28:31], v[64:67], 0
    v_mfma_f32_16x16x32_bf16 v[80:83], v[198:201], v[64:67], 0
    v_perm_b32 v72, v100, v100, v40
    v_perm_b32 v73, v100, v100, v41
    v_perm_b32 v74, v100, v100, v42
    v_perm_b32 v75, v100, v100, v43
    v_mfma_f32_16x16x32_bf16 v[140:143], v[28:31], v[68:71], 0
    v_mfma_f32_16x16x32_bf16 v[84:87], v[204:207], v[68:71], 0
    v_perm_b32 v76, v102, v102, v40
    v_perm_b32 v77, v102, v102, v41
    v_perm_b32 v78, v102, v102, v42
    v_perm_b32 v79, v102, v102, v43
    v_mfma_f32_16x16x32_bf16 v[144:147], v[28:31], v[72:75], 0
    v_mfma_f32_16x16x32_bf16 v[88:91], v[196:199], v[72:75], 0
    s_add_u32 s60, s77, 2097152
    s_add_u32 s61, s60, 16384
    v_mfma_f32_16x16x32_bf16 v[148:151], v[28:31], v[76:79], 0
    v_mfma_f32_16x16x32_bf16 v[92:95], v[202:205], v[76:79], 0
    v_rcp_f32 v136, v136
    s_nop 0
    v_pk_mul_f32 v[80:81], v[80:81], v[136:137] op_sel_hi:[1,0]
    v_pk_mul_f32 v[82:83], v[82:83], v[136:137] op_sel_hi:[1,0]
    v_cvt_pk_bf16_f32 v100, v80, v81
    v_cvt_pk_bf16_f32 v101, v82, v83
    v_rcp_f32 v140, v140
    s_nop 0
    v_pk_mul_f32 v[84:85], v[84:85], v[140:141] op_sel_hi:[1,0]
    v_pk_mul_f32 v[86:87], v[86:87], v[140:141] op_sel_hi:[1,0]
    v_cvt_pk_bf16_f32 v102, v84, v85
    v_cvt_pk_bf16_f32 v103, v86, v87
    s_cmp_lg_u32 s100, 0
    s_cbranch_scc1 hs_f_30
    buffer_store_dwordx4 v[100:103], v4, s[36:39], s61 offen sc1
    s_branch hs_j_31
hs_f_30:
    buffer_store_dwordx4 v[100:103], v4, s[36:39], s61 offen
hs_j_31:
    v_rcp_f32 v144, v144
    s_nop 0
    v_pk_mul_f32 v[88:89], v[88:89], v[144:145] op_sel_hi:[1,0]
    v_pk_mul_f32 v[90:91], v[90:91], v[144:145] op_sel_hi:[1,0]
    v_cvt_pk_bf16_f32 v96, v88, v89
    v_cvt_pk_bf16_f32 v97, v90, v91
    v_rcp_f32 v148, v148
    s_nop 0
    v_pk_mul_f32 v[92:93], v[92:93], v[148:149] op_sel_hi:[1,0]
    v_pk_mul_f32 v[94:95], v[94:95], v[148:149] op_sel_hi:[1,0]
    v_cvt_pk_bf16_f32 v98, v92, v93
    v_cvt_pk_bf16_f32 v99, v94, v95
    s_cmp_lg_u32 s100, 0
    s_cbranch_scc1 hs_f_32
    buffer_store_dwordx4 v[96:99], v4, s[36:39], s60 offen sc1
    s_branch hs_j_33
hs_f_32:
    buffer_store_dwordx4 v[96:99], v4, s[36:39], s60 offen
hs_j_33:
    s_add_u32 m0, s44, 28672
    s_add_u32 s63, s55, 5849088
    buffer_load_dwordx4 v8, s[16:19], s63 offen lds
    s_add_u32 m0, s44, 32768
    s_add_u32 s63, s55, 2293760
    buffer_load_dwordx4 v8, s[16:19], s63 offen lds
    s_add_u32 m0, s44, 36864
    s_add_u32 s63, s55, 5963776
    buffer_load_dwordx4 v8, s[16:19], s63 offen lds
    s_add_u32 m0, s44, 40960
    s_add_u32 s63, s55, 2408448
    buffer_load_dwordx4 v8, s[16:19], s63 offen lds
    s_add_u32 m0, s44, 45056
    s_add_u32 s63, s55, 6078464
    buffer_load_dwordx4 v8, s[16:19], s63 offen lds
    s_waitcnt vmcnt(5)
    s_waitcnt lgkmcnt(0)
    s_barrier
    s_cmp_lg_u32 s41, 0
    s_cbranch_scc1 pub_34
    s_lshl_b32 s60, s45, 4
    s_add_u32 s60, s60, s46
    s_mul_i32 s60, s60, 128
    s_add_u32 s60, s60, 65536
    v_lshlrev_b32 v62, 2, v1
    s_mov_b32 exec_hi, 0
    s_mov_b32 exec_lo, 0x00000001
    s_cmp_lg_u32 s100, 0
    s_cbranch_scc1 hs_f_35
    buffer_store_dword v26, v62, s[36:39], s60 offen sc1
    s_branch hs_j_36
hs_f_35:
    buffer_store_dword v26, v62, s[36:39], s60 offen
hs_j_36:
    s_mov_b64 exec, -1
pub_34:
    s_add_u32 m0, s44, 131072
    s_add_u32 s63, s54, 262144
    buffer_load_dwordx4 v7, s[12:15], s63 offen lds
    s_add_u32 m0, s44, 135168
    s_add_u32 s63, s54, 294912
    buffer_load_dwordx4 v7, s[12:15], s63 offen lds
    s_add_u32 m0, s44, 139264
    s_add_u32 s63, s54, 327680
    buffer_load_dwordx4 v7, s[12:15], s63 offen lds
    s_add_u32 m0, s44, 143360
    s_add_u32 s63, s54, 360448
    buffer_load_dwordx4 v7, s[12:15], s63 offen lds
    s_add_u32 m0, s44, 49152
    s_add_u32 s63, s55, 2523136
    buffer_load_dwordx4 v8, s[16:19], s63 offen lds
    s_add_u32 m0, s44, 53248
    s_add_u32 s63, s55, 6193152
    buffer_load_dwordx4 v8, s[16:19], s63 offen lds
    v_lshrrev_b32 v22, 2, v1
    v_lshrrev_b32 v23, 3, v1
    v_and_b32 v23, 3, v23
    v_lshlrev_b32 v22, 7, v22
    v_lshl_add_u32 v22, v23, 5, v22
    v_and_b32 v23, 3, v1
    v_lshl_add_u32 v22, v23, 3, v22
    v_xor_b32 v10, 0, v22
    v_add_u32 v14, 98304, v10
    v_xor_b32 v11, 32, v22
    v_add_u32 v15, 98304, v11
    v_xor_b32 v12, 64, v22
    v_add_u32 v16, 98304, v12
    v_xor_b32 v13, 96, v22
    v_add_u32 v17, 98304, v13
    ds_read_b64_tr_b16 a[0:1], v14 offset:0
    ds_read_b64_tr_b16 a[2:3], v14 offset:2048
    ds_read_b64_tr_b16 a[4:5], v15 offset:0
    ds_read_b64_tr_b16 a[6:7], v15 offset:2048
    ds_read_b64_tr_b16 a[8:9], v16 offset:0
    ds_read_b64_tr_b16 a[10:11], v16 offset:2048
    ds_read_b64_tr_b16 a[12:13], v17 offset:0
    ds_read_b64_tr_b16 a[14:15], v17 offset:2048
    ds_read_b64_tr_b16 a[16:17], v14 offset:4096
    ds_read_b64_tr_b16 a[18:19], v14 offset:6144
    ds_read_b64_tr_b16 a[20:21], v15 offset:4096
    ds_read_b64_tr_b16 a[22:23], v15 offset:6144
    ds_read_b64_tr_b16 a[24:25], v16 offset:4096
    ds_read_b64_tr_b16 a[26:27], v16 offset:6144
    ds_read_b64_tr_b16 a[28:29], v17 offset:4096
    ds_read_b64_tr_b16 a[30:31], v17 offset:6144
    ds_read_b64_tr_b16 a[32:33], v14 offset:8192
    ds_read_b64_tr_b16 a[34:35], v14 offset:10240
    ds_read_b64_tr_b16 a[36:37], v15 offset:8192
    ds_read_b64_tr_b16 a[38:39], v15 offset:10240
    ds_read_b64_tr_b16 a[40:41], v16 offset:8192
    ds_read_b64_tr_b16 a[42:43], v16 offset:10240
    ds_read_b64_tr_b16 a[44:45], v17 offset:8192
    ds_read_b64_tr_b16 a[46:47], v17 offset:10240
    ds_read_b64_tr_b16 a[48:49], v14 offset:12288
    ds_read_b64_tr_b16 a[50:51], v14 offset:14336
    ds_read_b64_tr_b16 a[52:53], v15 offset:12288
    ds_read_b64_tr_b16 a[54:55], v15 offset:14336
    ds_read_b64_tr_b16 a[56:57], v16 offset:12288
    ds_read_b64_tr_b16 a[58:59], v16 offset:14336
    ds_read_b64_tr_b16 a[60:61], v17 offset:12288
    ds_read_b64_tr_b16 a[62:63], v17 offset:14336
    ds_read_b64_tr_b16 a[64:65], v14 offset:16384
    ds_read_b64_tr_b16 a[66:67], v14 offset:18432
    ds_read_b64_tr_b16 a[68:69], v15 offset:16384
    ds_read_b64_tr_b16 a[70:71], v15 offset:18432
    ds_read_b64_tr_b16 a[72:73], v16 offset:16384
    ds_read_b64_tr_b16 a[74:75], v16 offset:18432
    ds_read_b64_tr_b16 a[76:77], v17 offset:16384
    ds_read_b64_tr_b16 a[78:79], v17 offset:18432
    ds_read_b64_tr_b16 a[80:81], v14 offset:20480
    ds_read_b64_tr_b16 a[82:83], v14 offset:22528
    ds_read_b64_tr_b16 a[84:85], v15 offset:20480
    ds_read_b64_tr_b16 a[86:87], v15 offset:22528
    ds_read_b64_tr_b16 a[88:89], v16 offset:20480
    ds_read_b64_tr_b16 a[90:91], v16 offset:22528
    ds_read_b64_tr_b16 a[92:93], v17 offset:20480
    ds_read_b64_tr_b16 a[94:95], v17 offset:22528
    ds_read_b64_tr_b16 a[96:97], v14 offset:24576
    ds_read_b64_tr_b16 a[98:99], v14 offset:26624
    ds_read_b64_tr_b16 a[100:101], v15 offset:24576
    ds_read_b64_tr_b16 a[102:103], v15 offset:26624
    ds_read_b64_tr_b16 a[104:105], v16 offset:24576
    ds_read_b64_tr_b16 a[106:107], v16 offset:26624
    ds_read_b64_tr_b16 a[108:109], v17 offset:24576
    ds_read_b64_tr_b16 a[110:111], v17 offset:26624
    ds_read_b64_tr_b16 a[112:113], v14 offset:28672
    ds_read_b64_tr_b16 a[114:115], v14 offset:30720
    ds_read_b64_tr_b16 a[116:117], v15 offset:28672
    ds_read_b64_tr_b16 a[118:119], v15 offset:30720
    ds_read_b64_tr_b16 a[120:121], v16 offset:28672
    ds_read_b64_tr_b16 a[122:123], v16 offset:30720
    ds_read_b64_tr_b16 a[124:125], v17 offset:28672
    ds_read_b64_tr_b16 a[126:127], v17 offset:30720
    ds_read_b64_tr_b16 a[192:193], v10 offset:0
    ds_read_b64_tr_b16 a[194:195], v10 offset:2048
    ds_read_b64_tr_b16 a[196:197], v11 offset:0
    ds_read_b64_tr_b16 a[198:199], v11 offset:2048
    ds_read_b64_tr_b16 a[200:201], v12 offset:0
    ds_read_b64_tr_b16 a[202:203], v12 offset:2048
    ds_read_b64_tr_b16 a[204:205], v13 offset:0
    ds_read_b64_tr_b16 a[206:207], v13 offset:2048
    ds_read_b64_tr_b16 a[208:209], v10 offset:4096
    ds_read_b64_tr_b16 a[210:211], v10 offset:6144
    ds_read_b64_tr_b16 a[212:213], v11 offset:4096
    ds_read_b64_tr_b16 a[214:215], v11 offset:6144
    ds_read_b64_tr_b16 a[216:217], v12 offset:4096
    ds_read_b64_tr_b16 a[218:219], v12 offset:6144
    ds_read_b64_tr_b16 a[220:221], v13 offset:4096
    ds_read_b64_tr_b16 a[222:223], v13 offset:6144
    ds_read_b64_tr_b16 a[224:225], v10 offset:8192
    ds_read_b64_tr_b16 a[226:227], v10 offset:10240
    ds_read_b64_tr_b16 a[228:229], v11 offset:8192
    ds_read_b64_tr_b16 a[230:231], v11 offset:10240
    ds_read_b64_tr_b16 a[232:233], v12 offset:8192
    ds_read_b64_tr_b16 a[234:235], v12 offset:10240
    ds_read_b64_tr_b16 a[236:237], v13 offset:8192
    ds_read_b64_tr_b16 a[238:239], v13 offset:10240
    ds_read_b64_tr_b16 a[240:241], v10 offset:12288
    ds_read_b64_tr_b16 a[242:243], v10 offset:14336
    ds_read_b64_tr_b16 a[244:245], v11 offset:12288
    ds_read_b64_tr_b16 a[246:247], v11 offset:14336
    ds_read_b64_tr_b16 a[248:249], v12 offset:12288
    ds_read_b64_tr_b16 a[250:251], v12 offset:14336
    ds_read_b64_tr_b16 a[252:253], v13 offset:12288
    ds_read_b64_tr_b16 a[254:255], v13 offset:14336
    v_lshlrev_b32 v64, 16, v32
    v_and_b32 v65, 0xffff0000, v32
    v_lshlrev_b32 v66, 16, v33
    v_and_b32 v67, 0xffff0000, v33
    v_lshlrev_b32 v68, 16, v34
    v_and_b32 v69, 0xffff0000, v34
    v_lshlrev_b32 v70, 16, v35
    v_and_b32 v71, 0xffff0000, v35
    v_lshlrev_b32 v72, 16, v36
    v_and_b32 v73, 0xffff0000, v36
    v_lshlrev_b32 v74, 16, v37
    v_and_b32 v75, 0xffff0000, v37
    v_lshlrev_b32 v76, 16, v38
    v_and_b32 v77, 0xffff0000, v38
    v_lshlrev_b32 v78, 16, v39
    v_and_b32 v79, 0xffff0000, v39
    s_lshl_b32 s72, s47, 2
    s_add_u32 s72, s72, s41
    s_lshl_b32 s73, s72, 11
    s_add_u32 s73, s73, 1048576
    s_lshl_b32 s74, s72, 10
    s_lshl_b32 s72, s72, 14
    s_add_u32 s72, s72, 2097152
    s_cmp_lg_u32 s41, 0
    s_cbranch_scc1 poll_37_d
    s_lshr_b32 s60, s47, 1
    s_lshl_b32 s60, s60, 4
    s_mul_i32 s60, s60, 128
    s_add_u32 s60, s60, 65536
    v_min_u32 v62, 15, v1
    v_mul_u32_u24 v62, 128, v62
    s_mov_b32 s70, 30000
poll_37:
    buffer_load_dword v63, v62, s[36:39], s60 offen sc1
    s_waitcnt vmcnt(0)
    v_cmp_ne_u32 vcc, v63, v26
    s_nop 3
    s_cbranch_vccz poll_37_d
    s_sub_u32 s70, s70, 1
    s_cmp_lg_u32 s70, 0
    s_cbranch_scc1 poll_37
poll_37_d:
    s_waitcnt vmcnt(0) lgkmcnt(0)
    s_barrier
    buffer_load_dwordx4 v[128:131], v4, s[36:39], s72 offen offset:0 sc1
    buffer_load_dwordx4 v[132:135], v4, s[36:39], s72 offen offset:1024 sc1
    ds_read_b64_tr_b16 a[128:129], v14 offset:32768
    ds_read_b64_tr_b16 a[130:131], v14 offset:34816
    ds_read_b64_tr_b16 a[132:133], v15 offset:32768
    ds_read_b64_tr_b16 a[134:135], v15 offset:34816
    ds_read_b64_tr_b16 a[136:137], v16 offset:32768
    ds_read_b64_tr_b16 a[138:139], v16 offset:34816
    ds_read_b64_tr_b16 a[140:141], v17 offset:32768
    ds_read_b64_tr_b16 a[142:143], v17 offset:34816
    buffer_load_dwordx4 v[136:139], v4, s[36:39], s72 offen offset:2048 sc1
    buffer_load_dwordx4 v[140:143], v4, s[36:39], s72 offen offset:3072 sc1
    ds_read_b64_tr_b16 a[144:145], v14 offset:36864
    ds_read_b64_tr_b16 a[146:147], v14 offset:38912
    ds_read_b64_tr_b16 a[148:149], v15 offset:36864
    ds_read_b64_tr_b16 a[150:151], v15 offset:38912
    ds_read_b64_tr_b16 a[152:153], v16 offset:36864
    ds_read_b64_tr_b16 a[154:155], v16 offset:38912
    ds_read_b64_tr_b16 a[156:157], v17 offset:36864
    ds_read_b64_tr_b16 a[158:159], v17 offset:38912
    s_add_u32 s72, s72, 4096
    buffer_load_dwordx4 v[144:147], v4, s[36:39], s72 offen offset:0 sc1
    buffer_load_dwordx4 v[148:151], v4, s[36:39], s72 offen offset:1024 sc1
    ds_read_b64_tr_b16 a[160:161], v14 offset:40960
    ds_read_b64_tr_b16 a[162:163], v14 offset:43008
    ds_read_b64_tr_b16 a[164:165], v15 offset:40960
    ds_read_b64_tr_b16 a[166:167], v15 offset:43008
    ds_read_b64_tr_b16 a[168:169], v16 offset:40960
    ds_read_b64_tr_b16 a[170:171], v16 offset:43008
    ds_read_b64_tr_b16 a[172:173], v17 offset:40960
    ds_read_b64_tr_b16 a[174:175], v17 offset:43008
    buffer_load_dwordx4 v[152:155], v4, s[36:39], s72 offen offset:2048 sc1
    buffer_load_dwordx4 v[156:159], v4, s[36:39], s72 offen offset:3072 sc1
    ds_read_b64_tr_b16 a[176:177], v14 offset:45056
    ds_read_b64_tr_b16 a[178:179], v14 offset:47104
    ds_read_b64_tr_b16 a[180:181], v15 offset:45056
    ds_read_b64_tr_b16 a[182:183], v15 offset:47104
    ds_read_b64_tr_b16 a[184:185], v16 offset:45056
    ds_read_b64_tr_b16 a[186:187], v16 offset:47104
    ds_read_b64_tr_b16 a[188:189], v17 offset:45056
    ds_read_b64_tr_b16 a[190:191], v17 offset:47104
    s_add_u32 s72, s72, 4096
    buffer_load_dwordx4 v[160:163], v4, s[36:39], s72 offen offset:0 sc1
    buffer_load_dwordx4 v[164:167], v4, s[36:39], s72 offen offset:1024 sc1
    buffer_load_dwordx4 v[168:171], v4, s[36:39], s72 offen offset:2048 sc1
    buffer_load_dwordx4 v[172:175], v4, s[36:39], s72 offen offset:3072 sc1
    s_add_u32 s72, s72, 4096
    buffer_load_dwordx4 v[176:179], v4, s[36:39], s72 offen offset:0 sc1
    buffer_load_dwordx4 v[180:183], v4, s[36:39], s72 offen offset:1024 sc1
    buffer_load_dwordx4 v[184:187], v4, s[36:39], s72 offen offset:2048 sc1
    buffer_load_dwordx4 v[188:191], v4, s[36:39], s72 offen offset:3072 sc1
    s_lshl_b32 s61, s48, 8
    s_add_u32 s61, s61, s73
    v_lshrrev_b32 v62, 1, v2
    v_lshlrev_b32 v62, 3, v62
    v_lshl_add_u32 v62, v3, 4, v62
    s_mul_i32 s60, s41, 2304
    s_add_u32 s60, s60, 147456
    v_mul_u32_u24 v23, 144, v3
    v_lshl_add_u32 v23, v2, 3, v23
    v_add_u32 v23, s60, v23
    s_mul_i32 s60, s41, 2176
    s_add_u32 s60, s60, 131072
    v_mul_u32_u24 v25, 136, v3
    v_lshl_add_u32 v25, v2, 3, v25
    v_add_u32 v25, s60, v25
    v_lshrrev_b32 v22, 5, v1
    v_lshlrev_b32 v22, 2, v22
    v_lshrrev_b32 v24, 2, v1
    v_and_b32 v24, 3, v24
    v_add_u32 v22, v22, v24
    v_mul_u32_u24 v22, 136, v22
    v_and_b32 v24, 1, v2
    v_lshl_add_u32 v22, v24, 5, v22
    v_and_b32 v24, 1, v1
    v_lshl_add_u32 v22, v24, 4, v22
    v_and_b32 v24, 2, v1
    v_lshl_add_u32 v22, v24, 2, v22
    v_add_u32 v22, s60, v22
    s_mul_i32 s62, s51, 4608
    s_lshl_b32 s60, s52, 6
    s_add_u32 s62, s62, s60
    s_add_u32 s62, s62, 147456
    v_and_b32 v24, 31, v1
    v_mul_u32_u24 v24, 144, v24
    v_lshrrev_b32 v63, 5, v1
    v_lshl_add_u32 v24, v63, 4, v24
    v_add_u32 v24, s62, v24
    s_mul_i32 s62, s48, 262144
    s_add_u32 s62, s62, s74
    s_lshr_b32 s74, s74, 16
    s_mul_i32 s74, s74, 0
    s_add_u32 s62, s62, s74
    s_add_u32 s62, s62, 8388608
    s_add_u32 s74, s62, 131072
    s_waitcnt vmcnt(15)
    v_mfma_f32_16x16x32_bf16 v[64:67], a[0:3], v[128:131], v[64:67]
    v_mfma_f32_16x16x32_bf16 v[68:71], a[4:7], v[128:131], v[68:71]
    v_mfma_f32_16x16x32_bf16 v[72:75], a[8:11], v[128:131], v[72:75]
    v_mfma_f32_16x16x32_bf16 v[76:79], a[12:15], v[128:131], v[76:79]
    s_waitcnt vmcnt(14)
    v_mfma_f32_16x16x32_bf16 v[64:67], a[16:19], v[132:135], v[64:67]
    v_mfma_f32_16x16x32_bf16 v[68:71], a[20:23], v[132:135], v[68:71]
    v_mfma_f32_16x16x32_bf16 v[72:75], a[24:27], v[132:135], v[72:75]
    v_mfma_f32_16x16x32_bf16 v[76:79], a[28:31], v[132:135], v[76:79]
    s_waitcnt vmcnt(13)
    v_mfma_f32_16x16x32_bf16 v[64:67], a[32:35], v[136:139], v[64:67]
    v_mfma_f32_16x16x32_bf16 v[68:71], a[36:39], v[136:139], v[68:71]
    s_add_u32 m0, s44, 57344
    s_add_u32 s63, s55, 2637824
    buffer_load_dwordx4 v8, s[16:19], s63 offen lds
    v_mfma_f32_16x16x32_bf16 v[72:75], a[40:43], v[136:139], v[72:75]
    v_mfma_f32_16x16x32_bf16 v[76:79], a[44:47], v[136:139], v[76:79]
    s_waitcnt vmcnt(13)
    v_mfma_f32_16x16x32_bf16 v[64:67], a[48:51], v[140:143], v[64:67]
    v_mfma_f32_16x16x32_bf16 v[68:71], a[52:55], v[140:143], v[68:71]
    s_add_u32 m0, s44, 61440
    s_add_u32 s63, s55, 6307840
    buffer_load_dwordx4 v8, s[16:19], s63 offen lds
    v_mfma_f32_16x16x32_bf16 v[72:75], a[56:59], v[140:143], v[72:75]
    v_mfma_f32_16x16x32_bf16 v[76:79], a[60:63], v[140:143], v[76:79]
    s_waitcnt vmcnt(13)
    v_mfma_f32_16x16x32_bf16 v[64:67], a[64:67], v[144:147], v[64:67]
    v_mfma_f32_16x16x32_bf16 v[68:71], a[68:71], v[144:147], v[68:71]
    s_add_u32 m0, s44, 65536
    s_add_u32 s63, s55, 2752512
    buffer_load_dwordx4 v8, s[16:19], s63 offen lds
    v_mfma_f32_16x16x32_bf16 v[72:75], a[72:75], v[144:147], v[72:75]
    v_mfma_f32_16x16x32_bf16 v[76:79], a[76:79], v[144:147], v[76:79]
    s_waitcnt vmcnt(13)
    v_mfma_f32_16x16x32_bf16 v[64:67], a[80:83], v[148:151], v[64:67]
    v_mfma_f32_16x16x32_bf16 v[68:71], a[84:87], v[148:151], v[68:71]
    s_add_u32 m0, s44, 69632
    s_add_u32 s63, s55, 6422528
    buffer_load_dwordx4 v8, s[16:19], s63 offen lds
    v_mfma_f32_16x16x32_bf16 v[72:75], a[88:91], v[148:151], v[72:75]
    v_mfma_f32_16x16x32_bf16 v[76:79], a[92:95], v[148:151], v[76:79]
    s_waitcnt vmcnt(13)
    v_mfma_f32_16x16x32_bf16 v[64:67], a[96:99], v[152:155], v[64:67]
    v_mfma_f32_16x16x32_bf16 v[68:71], a[100:103], v[152:155], v[68:71]
    s_add_u32 m0, s44, 73728
    s_add_u32 s63, s55, 2867200
    buffer_load_dwordx4 v8, s[16:19], s63 offen lds
    v_mfma_f32_16x16x32_bf16 v[72:75], a[104:107], v[152:155], v[72:75]
    v_mfma_f32_16x16x32_bf16 v[76:79], a[108:111], v[152:155], v[76:79]
    s_waitcnt vmcnt(13)
    v_mfma_f32_16x16x32_bf16 v[64:67], a[112:115], v[156:159], v[64:67]
    v_mfma_f32_16x16x32_bf16 v[68:71], a[116:119], v[156:159], v[68:71]
    s_add_u32 m0, s44, 77824
    s_add_u32 s63, s55, 6537216
    buffer_load_dwordx4 v8, s[16:19], s63 offen lds
    v_mfma_f32_16x16x32_bf16 v[72:75], a[120:123], v[156:159], v[72:75]
    v_mfma_f32_16x16x32_bf16 v[76:79], a[124:127], v[156:159], v[76:79]
    s_waitcnt vmcnt(13) lgkmcnt(15)
    v_mfma_f32_16x16x32_bf16 v[64:67], a[128:131], v[160:163], v[64:67]
    v_mfma_f32_16x16x32_bf16 v[68:71], a[132:135], v[160:163], v[68:71]
    s_add_u32 m0, s44, 81920
    s_add_u32 s63, s55, 2981888
    buffer_load_dwordx4 v8, s[16:19], s63 offen lds
    v_mfma_f32_16x16x32_bf16 v[72:75], a[136:139], v[160:163], v[72:75]
    v_mfma_f32_16x16x32_bf16 v[76:79], a[140:143], v[160:163], v[76:79]
    s_waitcnt vmcnt(13) lgkmcnt(15)
    v_mfma_f32_16x16x32_bf16 v[64:67], a[144:147], v[164:167], v[64:67]
    v_mfma_f32_16x16x32_bf16 v[68:71], a[148:151], v[164:167], v[68:71]
    s_add_u32 m0, s44, 86016
    s_add_u32 s63, s55, 6651904
    buffer_load_dwordx4 v8, s[16:19], s63 offen lds
    v_mfma_f32_16x16x32_bf16 v[72:75], a[152:155], v[164:167], v[72:75]
    v_mfma_f32_16x16x32_bf16 v[76:79], a[156:159], v[164:167], v[76:79]
    s_waitcnt vmcnt(13) lgkmcnt(8)
    v_mfma_f32_16x16x32_bf16 v[64:67], a[160:163], v[168:171], v[64:67]
    v_mfma_f32_16x16x32_bf16 v[68:71], a[164:167], v[168:171], v[68:71]
    s_add_u32 m0, s44, 90112
    s_add_u32 s63, s55, 3096576
    buffer_load_dwordx4 v8, s[16:19], s63 offen lds
    v_mfma_f32_16x16x32_bf16 v[72:75], a[168:171], v[168:171], v[72:75]
    v_mfma_f32_16x16x32_bf16 v[76:79], a[172:175], v[168:171], v[76:79]
    s_waitcnt vmcnt(13) lgkmcnt(0)
    v_mfma_f32_16x16x32_bf16 v[64:67], a[176:179], v[172:175], v[64:67]
    v_mfma_f32_16x16x32_bf16 v[68:71], a[180:183], v[172:175], v[68:71]
    s_add_u32 m0, s44, 94208
    s_add_u32 s63, s55, 6766592
    buffer_load_dwordx4 v8, s[16:19], s63 offen lds
    v_mfma_f32_16x16x32_bf16 v[72:75], a[184:187], v[172:175], v[72:75]
    v_mfma_f32_16x16x32_bf16 v[76:79], a[188:191], v[172:175], v[76:79]
    s_waitcnt vmcnt(13)
    v_mfma_f32_16x16x32_bf16 v[64:67], a[192:195], v[176:179], v[64:67]
    v_mfma_f32_16x16x32_bf16 v[68:71], a[196:199], v[176:179], v[68:71]
    s_add_u32 m0, s44, 98304
    s_add_u32 s63, s55, 3211264
    buffer_load_dwordx4 v8, s[16:19], s63 offen lds
    v_mfma_f32_16x16x32_bf16 v[72:75], a[200:203], v[176:179], v[72:75]
    v_mfma_f32_16x16x32_bf16 v[76:79], a[204:207], v[176:179], v[76:79]
    s_waitcnt vmcnt(13)
    v_mfma_f32_16x16x32_bf16 v[64:67], a[208:211], v[180:183], v[64:67]
    v_mfma_f32_16x16x32_bf16 v[68:71], a[212:215], v[180:183], v[68:71]
    s_add_u32 m0, s44, 102400
    s_add_u32 s63, s55, 6881280
    buffer_load_dwordx4 v8, s[16:19], s63 offen lds
    v_mfma_f32_16x16x32_bf16 v[72:75], a[216:219], v[180:183], v[72:75]
    v_mfma_f32_16x16x32_bf16 v[76:79], a[220:223], v[180:183], v[76:79]
    s_waitcnt vmcnt(13)
    v_mfma_f32_16x16x32_bf16 v[64:67], a[224:227], v[184:187], v[64:67]
    v_mfma_f32_16x16x32_bf16 v[68:71], a[228:231], v[184:187], v[68:71]
    s_add_u32 m0, s44, 106496
    s_add_u32 s63, s55, 3325952
    buffer_load_dwordx4 v8, s[16:19], s63 offen lds
    v_mfma_f32_16x16x32_bf16 v[72:75], a[232:235], v[184:187], v[72:75]
    v_mfma_f32_16x16x32_bf16 v[76:79], a[236:239], v[184:187], v[76:79]
    s_waitcnt vmcnt(13)
    v_mfma_f32_16x16x32_bf16 v[64:67], a[240:243], v[188:191], v[64:67]
    v_mfma_f32_16x16x32_bf16 v[68:71], a[244:247], v[188:191], v[68:71]
    s_add_u32 m0, s44, 110592
    s_add_u32 s63, s55, 6995968
    buffer_load_dwordx4 v8, s[16:19], s63 offen lds
    v_mfma_f32_16x16x32_bf16 v[72:75], a[248:251], v[188:191], v[72:75]
    v_mfma_f32_16x16x32_bf16 v[76:79], a[252:255], v[188:191], v[76:79]
    s_add_u32 m0, s44, 114688
    s_add_u32 s63, s55, 3440640
    buffer_load_dwordx4 v8, s[16:19], s63 offen lds
    s_add_u32 m0, s44, 118784
    s_add_u32 s63, s55, 7110656
    buffer_load_dwordx4 v8, s[16:19], s63 offen lds
    s_add_u32 m0, s44, 122880
    s_add_u32 s63, s55, 3555328
    buffer_load_dwordx4 v8, s[16:19], s63 offen lds
    s_add_u32 m0, s44, 126976
    s_add_u32 s63, s55, 7225344
    buffer_load_dwordx4 v8, s[16:19], s63 offen lds
    v_cvt_pk_bf16_f32 v100, v64, v65
    v_cvt_pk_bf16_f32 v101, v66, v67
    v_cvt_pk_bf16_f32 v102, v68, v69
    v_cvt_pk_bf16_f32 v103, v70, v71
    v_cvt_pk_bf16_f32 v104, v72, v73
    v_cvt_pk_bf16_f32 v105, v74, v75
    v_cvt_pk_bf16_f32 v106, v76, v77
    v_cvt_pk_bf16_f32 v107, v78, v79
    v_lshlrev_b32 v64, 16, v100
    v_and_b32 v65, 0xffff0000, v100
    v_lshlrev_b32 v66, 16, v101
    v_and_b32 v67, 0xffff0000, v101
    v_lshlrev_b32 v68, 16, v102
    v_and_b32 v69, 0xffff0000, v102
    v_lshlrev_b32 v70, 16, v103
    v_and_b32 v71, 0xffff0000, v103
    v_lshlrev_b32 v72, 16, v104
    v_and_b32 v73, 0xffff0000, v104
    v_lshlrev_b32 v74, 16, v105
    v_and_b32 v75, 0xffff0000, v105
    v_lshlrev_b32 v76, 16, v106
    v_and_b32 v77, 0xffff0000, v106
    v_lshlrev_b32 v78, 16, v107
    v_and_b32 v79, 0xffff0000, v107
    v_pk_add_f32 v[96:97], v[64:65], v[66:67]
    v_pk_mul_f32 v[98:99], v[64:65], v[64:65]
    v_pk_fma_f32 v[98:99], v[66:67], v[66:67], v[98:99]
    v_pk_fma_f32 v[98:99], v[68:69], v[68:69], v[98:99]
    v_pk_add_f32 v[96:97], v[96:97], v[68:69]
    v_pk_fma_f32 v[98:99], v[70:71], v[70:71], v[98:99]
    v_pk_add_f32 v[96:97], v[96:97], v[70:71]
    v_pk_fma_f32 v[98:99], v[72:73], v[72:73], v[98:99]
    v_pk_add_f32 v[96:97], v[96:97], v[72:73]
    v_pk_fma_f32 v[98:99], v[74:75], v[74:75], v[98:99]
    v_pk_add_f32 v[96:97], v[96:97], v[74:75]
    v_pk_fma_f32 v[98:99], v[76:77], v[76:77], v[98:99]
    v_pk_add_f32 v[96:97], v[96:97], v[76:77]
    v_pk_fma_f32 v[98:99], v[78:79], v[78:79], v[98:99]
    v_pk_add_f32 v[96:97], v[96:97], v[78:79]
    v_add_f32 v96, v96, v97
    v_add_f32 v98, v98, v99
    s_nop 1
    v_permlane32_swap_b32 v96, v98
    v_add_f32 v96, v96, v98
    v_mov_b32 v98, v96
    v_mov_b32 v97, v26
    s_nop 0
    v_permlane16_swap_b32 v96, v98
    v_add_f32 v96, v96, v98
    s_cmp_lg_u32 s100, 0
    s_cbranch_scc1 hs_f_38
    buffer_store_dwordx2 v[96:97], v62, s[36:39], s61 offen sc1
    s_branch hs_j_39
hs_f_38:
    buffer_store_dwordx2 v[96:97], v62, s[36:39], s61 offen
hs_j_39:
    ds_write_b64 v23, v[100:101] offset:0
    ds_write_b64 v23, v[102:103] offset:32
    ds_write_b64 v23, v[104:105] offset:64
    ds_write_b64 v23, v[106:107] offset:96
    s_waitcnt vmcnt(1) lgkmcnt(0)
    s_barrier
    ds_read_b128 v[32:35], v24 offset:0
    ds_read_b128 v[36:39], v24 offset:32
    ds_read_b64_tr_b16 a[48:49], v56 offset:16384
    ds_read_b64_tr_b16 a[50:51], v56 offset:17408
    ds_read_b64_tr_b16 a[52:53], v57 offset:16384
    ds_read_b64_tr_b16 a[54:55], v57 offset:17408
    ds_read_b64_tr_b16 a[56:57], v56 offset:18432
    ds_read_b64_tr_b16 a[58:59], v56 offset:19456
    ds_read_b64_tr_b16 a[60:61], v57 offset:18432
    ds_read_b64_tr_b16 a[62:63], v57 offset:19456
    buffer_load_dwordx4 v[108:111], v4, s[36:39], s73 offen sc1
    buffer_load_dwordx4 v[112:115], v4, s[36:39], s73 offen offset:1024 sc1
    ds_read_b64_tr_b16 a[64:65], v56 offset:24576
    ds_read_b64_tr_b16 a[66:67], v56 offset:25600
    ds_read_b64_tr_b16 a[68:69], v57 offset:24576
    ds_read_b64_tr_b16 a[70:71], v57 offset:25600
    ds_read_b64_tr_b16 a[72:73], v56 offset:26624
    ds_read_b64_tr_b16 a[74:75], v56 offset:27648
    ds_read_b64_tr_b16 a[76:77], v57 offset:26624
    ds_read_b64_tr_b16 a[78:79], v57 offset:27648
    ds_read_b64_tr_b16 a[80:81], v56 offset:32768
    ds_read_b64_tr_b16 a[82:83], v56 offset:33792
    ds_read_b64_tr_b16 a[84:85], v57 offset:32768
    ds_read_b64_tr_b16 a[86:87], v57 offset:33792
    ds_read_b64_tr_b16 a[88:89], v56 offset:34816
    ds_read_b64_tr_b16 a[90:91], v56 offset:35840
    ds_read_b64_tr_b16 a[92:93], v57 offset:34816
    ds_read_b64_tr_b16 a[94:95], v57 offset:35840
    ds_read_b64_tr_b16 a[96:97], v56 offset:40960
    ds_read_b64_tr_b16 a[98:99], v56 offset:41984
    ds_read_b64_tr_b16 a[100:101], v57 offset:40960
    ds_read_b64_tr_b16 a[102:103], v57 offset:41984
    ds_read_b64_tr_b16 a[104:105], v56 offset:43008
    ds_read_b64_tr_b16 a[106:107], v56 offset:44032
    ds_read_b64_tr_b16 a[108:109], v57 offset:43008
    ds_read_b64_tr_b16 a[110:111], v57 offset:44032
    ds_read_b64_tr_b16 a[112:113], v58 offset:0
    ds_read_b64_tr_b16 a[114:115], v58 offset:1024
    ds_read_b64_tr_b16 a[116:117], v59 offset:0
    ds_read_b64_tr_b16 a[118:119], v59 offset:1024
    ds_read_b64_tr_b16 a[120:121], v58 offset:2048
    ds_read_b64_tr_b16 a[122:123], v58 offset:3072
    ds_read_b64_tr_b16 a[124:125], v59 offset:2048
    ds_read_b64_tr_b16 a[126:127], v59 offset:3072
    s_waitcnt vmcnt(0)
    s_mov_b32 s70, 30000
chk_40:
    v_xor_b32 v109, v109, v26
    v_xor_b32 v111, v111, v26
    v_xor_b32 v113, v113, v26
    v_xor_b32 v115, v115, v26
    v_or_b32 v109, v109, v111
    v_or3_b32 v109, v109, v113, v115
    v_cmp_ne_u32 vcc, 0, v109
    s_nop 3
    s_cbranch_vccz chk_40_d
    buffer_load_dwordx4 v[108:111], v4, s[36:39], s73 offen sc1
    buffer_load_dwordx4 v[112:115], v4, s[36:39], s73 offen offset:1024 sc1
    s_waitcnt vmcnt(0)
    s_sub_u32 s70, s70, 1
    s_cmp_lg_u32 s70, 0
    s_cbranch_scc1 chk_40
chk_40_d:
    v_add_f32 v96, v108, v112
    v_add_f32 v98, v110, v114
    s_nop 1
    v_permlane32_swap_b32 v96, v98
    v_add_f32 v96, v96, v98
    v_mov_b32 v98, v96
    s_nop 1
    v_permlane16_swap_b32 v96, v98
    v_add_f32 v96, v96, v98
    v_mul_f32 v96, 0x3b000000, v96
    v_mov_b32 v98, v96
    s_nop 1
    v_permlane32_swap_b32 v96, v98
    v_fma_f32 v98, -v96, v96, v98
    v_max_f32 v98, 0, v98
    v_mov_b32 v99, 0x2edbe6ff
    v_fmac_f32 v99, 0x3f800054, v98
    v_rsq_f32 v97, v99
    s_nop 0
    v_mul_f32 v99, v96, v97
    v_pk_fma_f32 v[64:65], v[64:65], v[96:97], v[98:99] op_sel:[0,1,1] op_sel_hi:[1,1,1] neg_lo:[0,0,1] neg_hi:[0,0,1]
    v_pk_fma_f32 v[66:67], v[66:67], v[96:97], v[98:99] op_sel:[0,1,1] op_sel_hi:[1,1,1] neg_lo:[0,0,1] neg_hi:[0,0,1]
    v_cvt_pk_bf16_f32 v100, v64, v65
    v_cvt_pk_bf16_f32 v101, v66, v67
    ds_write_b64 v25, v[100:101] offset:0
    v_pk_fma_f32 v[68:69], v[68:69], v[96:97], v[98:99] op_sel:[0,1,1] op_sel_hi:[1,1,1] neg_lo:[0,0,1] neg_hi:[0,0,1]
    v_pk_fma_f32 v[70:71], v[70:71], v[96:97], v[98:99] op_sel:[0,1,1] op_sel_hi:[1,1,1] neg_lo:[0,0,1] neg_hi:[0,0,1]
    v_cvt_pk_bf16_f32 v102, v68, v69
    v_cvt_pk_bf16_f32 v103, v70, v71
    ds_write_b64 v25, v[102:103] offset:32
    ds_read_b64_tr_b16 v[80:81], v22 offset:0
    ds_read_b64_tr_b16 v[82:83], v22 offset:1088
    v_pk_fma_f32 v[72:73], v[72:73], v[96:97], v[98:99] op_sel:[0,1,1] op_sel_hi:[1,1,1] neg_lo:[0,0,1] neg_hi:[0,0,1]
    v_pk_fma_f32 v[74:75], v[74:75], v[96:97], v[98:99] op_sel:[0,1,1] op_sel_hi:[1,1,1] neg_lo:[0,0,1] neg_hi:[0,0,1]
    v_cvt_pk_bf16_f32 v104, v72, v73
    v_cvt_pk_bf16_f32 v105, v74, v75
    ds_write_b64 v25, v[104:105] offset:64
    v_pk_fma_f32 v[76:77], v[76:77], v[96:97], v[98:99] op_sel:[0,1,1] op_sel_hi:[1,1,1] neg_lo:[0,0,1] neg_hi:[0,0,1]
    v_pk_fma_f32 v[78:79], v[78:79], v[96:97], v[98:99] op_sel:[0,1,1] op_sel_hi:[1,1,1] neg_lo:[0,0,1] neg_hi:[0,0,1]
    v_cvt_pk_bf16_f32 v106, v76, v77
    v_cvt_pk_bf16_f32 v107, v78, v79
    ds_write_b64 v25, v[106:107] offset:96
    ds_read_b64_tr_b16 v[84:85], v22 offset:64
    ds_read_b64_tr_b16 v[86:87], v22 offset:1152
    s_waitcnt lgkmcnt(4)
    buffer_store_dwordx4 v[80:83], v4, s[36:39], s62 offen sc1
    s_waitcnt lgkmcnt(0)
    buffer_store_dwordx4 v[84:87], v4, s[36:39], s74 offen sc1
    s_add_u32 m0, s44, 0
    s_add_u32 s63, s55, 229376
    buffer_load_dwordx4 v8, s[16:19], s63 offen lds
    ds_read_b64_tr_b16 a[128:129], v58 offset:8192
    ds_read_b64_tr_b16 a[130:131], v58 offset:9216
    ds_read_b64_tr_b16 a[132:133], v59 offset:8192
    ds_read_b64_tr_b16 a[134:135], v59 offset:9216
    ds_read_b64_tr_b16 a[136:137], v58 offset:10240
    ds_read_b64_tr_b16 a[138:139], v58 offset:11264
    ds_read_b64_tr_b16 a[140:141], v59 offset:10240
    ds_read_b64_tr_b16 a[142:143], v59 offset:11264
    ds_read_b64_tr_b16 a[144:145], v58 offset:16384
    ds_read_b64_tr_b16 a[146:147], v58 offset:17408
    ds_read_b64_tr_b16 a[148:149], v59 offset:16384
    ds_read_b64_tr_b16 a[150:151], v59 offset:17408
    s_add_u32 m0, s44, 4096
    s_add_u32 s63, s55, 3899392
    buffer_load_dwordx4 v8, s[16:19], s63 offen lds
    ds_read_b64_tr_b16 a[152:153], v58 offset:18432
    ds_read_b64_tr_b16 a[154:155], v58 offset:19456
    ds_read_b64_tr_b16 a[156:157], v59 offset:18432
    ds_read_b64_tr_b16 a[158:159], v59 offset:19456
    ds_read_b64_tr_b16 a[160:161], v58 offset:24576
    ds_read_b64_tr_b16 a[162:163], v58 offset:25600
    ds_read_b64_tr_b16 a[164:165], v59 offset:24576
    ds_read_b64_tr_b16 a[166:167], v59 offset:25600
    ds_read_b64_tr_b16 a[168:169], v58 offset:26624
    ds_read_b64_tr_b16 a[170:171], v58 offset:27648
    ds_read_b64_tr_b16 a[172:173], v59 offset:26624
    ds_read_b64_tr_b16 a[174:175], v59 offset:27648
    s_add_u32 m0, s44, 8192
    s_add_u32 s63, s55, 344064
    buffer_load_dwordx4 v8, s[16:19], s63 offen lds
    ds_read_b64_tr_b16 a[176:177], v58 offset:32768
    ds_read_b64_tr_b16 a[178:179], v58 offset:33792
    ds_read_b64_tr_b16 a[180:181], v59 offset:32768
    ds_read_b64_tr_b16 a[182:183], v59 offset:33792
    ds_read_b64_tr_b16 a[184:185], v58 offset:34816
    ds_read_b64_tr_b16 a[186:187], v58 offset:35840
    ds_read_b64_tr_b16 a[188:189], v59 offset:34816
    ds_read_b64_tr_b16 a[190:191], v59 offset:35840
    ds_read_b64_tr_b16 a[192:193], v58 offset:40960
    ds_read_b64_tr_b16 a[194:195], v58 offset:41984
    ds_read_b64_tr_b16 a[196:197], v59 offset:40960
    ds_read_b64_tr_b16 a[198:199], v59 offset:41984
    s_add_u32 m0, s44, 12288
    s_add_u32 s63, s55, 4014080
    buffer_load_dwordx4 v8, s[16:19], s63 offen lds
    ds_read_b64_tr_b16 a[200:201], v58 offset:43008
    ds_read_b64_tr_b16 a[202:203], v58 offset:44032
    ds_read_b64_tr_b16 a[204:205], v59 offset:43008
    ds_read_b64_tr_b16 a[206:207], v59 offset:44032
    ds_read_b64_tr_b16 a[208:209], v60 offset:0
    ds_read_b64_tr_b16 a[210:211], v60 offset:1024
    ds_read_b64_tr_b16 a[212:213], v61 offset:0
    ds_read_b64_tr_b16 a[214:215], v61 offset:1024
    ds_read_b64_tr_b16 a[216:217], v60 offset:2048
    ds_read_b64_tr_b16 a[218:219], v60 offset:3072
    ds_read_b64_tr_b16 a[220:221], v61 offset:2048
    ds_read_b64_tr_b16 a[222:223], v61 offset:3072
    ds_read_b64_tr_b16 a[224:225], v60 offset:8192
    ds_read_b64_tr_b16 a[226:227], v60 offset:9216
    ds_read_b64_tr_b16 a[228:229], v61 offset:8192
    ds_read_b64_tr_b16 a[230:231], v61 offset:9216
    ds_read_b64_tr_b16 a[232:233], v60 offset:10240
    ds_read_b64_tr_b16 a[234:235], v60 offset:11264
    ds_read_b64_tr_b16 a[236:237], v61 offset:10240
    ds_read_b64_tr_b16 a[238:239], v61 offset:11264
    ds_read_b64_tr_b16 a[240:241], v60 offset:16384
    ds_read_b64_tr_b16 a[242:243], v60 offset:17408
    ds_read_b64_tr_b16 a[244:245], v61 offset:16384
    ds_read_b64_tr_b16 a[246:247], v61 offset:17408
    ds_read_b64_tr_b16 a[248:249], v60 offset:18432
    ds_read_b64_tr_b16 a[250:251], v60 offset:19456
    ds_read_b64_tr_b16 a[252:253], v61 offset:18432
    ds_read_b64_tr_b16 a[254:255], v61 offset:19456
    ds_read_b64_tr_b16 a[0:1], v60 offset:24576
    ds_read_b64_tr_b16 a[2:3], v60 offset:25600
    ds_read_b64_tr_b16 a[4:5], v61 offset:24576
    ds_read_b64_tr_b16 a[6:7], v61 offset:25600
    ds_read_b64_tr_b16 a[8:9], v60 offset:26624
    ds_read_b64_tr_b16 a[10:11], v60 offset:27648
    ds_read_b64_tr_b16 a[12:13], v61 offset:26624
    ds_read_b64_tr_b16 a[14:15], v61 offset:27648
    s_waitcnt vmcnt(4)
    s_waitcnt lgkmcnt(0)
    s_barrier
    s_cmp_lg_u32 s41, 0
    s_cbranch_scc1 pub_41
    s_lshl_b32 s60, s48, 5
    s_add_u32 s60, s60, s47
    s_mul_i32 s60, s60, 128
    s_add_u32 s60, s60, 131072
    v_lshlrev_b32 v62, 2, v1
    s_mov_b32 exec_hi, 0
    s_mov_b32 exec_lo, 0x00000001
    buffer_store_dword v26, v62, s[36:39], s60 offen sc1
    s_mov_b64 exec, -1
pub_41:
    s_cmp_ge_u32 s43, 28
    s_cbranch_scc1 p3skip_42
    s_lshl_b32 s60, s51, 6
    s_add_u32 s60, s60, s55
    v_lshrrev_b32 v22, 5, v1
    v_lshlrev_b32 v22, 3, v22
    buffer_load_dwordx2 v[48:49], v22, s[24:27], s60 offen offset:0
    buffer_load_dwordx2 v[50:51], v22, s[24:27], s60 offen offset:16
    buffer_load_dwordx2 v[52:53], v22, s[24:27], s60 offen offset:32
    buffer_load_dwordx2 v[54:55], v22, s[24:27], s60 offen offset:48
    s_lshl_b32 s72, s49, 1
    s_add_u32 s72, s72, s52
    s_mul_i32 s72, s72, 131072
    s_mul_i32 s3, s51, 65536
    s_add_u32 s72, s72, s3
    s_add_u32 s72, s72, 8388608
    s_add_u32 m0, s44, 131072
    s_add_u32 s63, s55, 0
    buffer_load_dwordx4 v8, s[16:19], s63 offen lds
    s_add_u32 m0, s44, 135168
    s_add_u32 s63, s55, 3670016
    buffer_load_dwordx4 v8, s[16:19], s63 offen lds
    s_add_u32 m0, s44, 139264
    s_add_u32 s63, s55, 114688
    buffer_load_dwordx4 v8, s[16:19], s63 offen lds
    s_add_u32 m0, s44, 143360
    s_add_u32 s63, s55, 3784704
    buffer_load_dwordx4 v8, s[16:19], s63 offen lds
    s_add_u32 m0, s44, 16384
    s_add_u32 s63, s55, 458752
    buffer_load_dwordx4 v8, s[16:19], s63 offen lds
    s_add_u32 m0, s44, 20480
    s_add_u32 s63, s55, 4128768
    buffer_load_dwordx4 v8, s[16:19], s63 offen lds
    s_add_u32 m0, s44, 24576
    s_add_u32 s63, s55, 573440
    buffer_load_dwordx4 v8, s[16:19], s63 offen lds
    s_add_u32 m0, s44, 28672
    s_add_u32 s63, s55, 4243456
    buffer_load_dwordx4 v8, s[16:19], s63 offen lds
    s_add_u32 m0, s44, 32768
    s_add_u32 s63, s55, 688128
    buffer_load_dwordx4 v8, s[16:19], s63 offen lds
    s_add_u32 m0, s44, 36864
    s_add_u32 s63, s55, 4358144
    buffer_load_dwordx4 v8, s[16:19], s63 offen lds
    s_add_u32 m0, s44, 40960
    s_add_u32 s63, s55, 802816
    buffer_load_dwordx4 v8, s[16:19], s63 offen lds
    s_add_u32 m0, s44, 45056
    s_add_u32 s63, s55, 4472832
    buffer_load_dwordx4 v8, s[16:19], s63 offen lds
    s_add_u32 m0, s44, 49152
    s_add_u32 s63, s55, 917504
    buffer_load_dwordx4 v8, s[16:19], s63 offen lds
    s_add_u32 m0, s44, 53248
    s_add_u32 s63, s55, 4587520
    buffer_load_dwordx4 v8, s[16:19], s63 offen lds
    s_add_u32 m0, s44, 57344
    s_add_u32 s63, s55, 1032192
    buffer_load_dwordx4 v8, s[16:19], s63 offen lds
    s_add_u32 m0, s44, 61440
    s_add_u32 s63, s55, 4702208
    buffer_load_dwordx4 v8, s[16:19], s63 offen lds
    s_add_u32 m0, s44, 65536
    s_add_u32 s63, s55, 1146880
    buffer_load_dwordx4 v8, s[16:19], s63 offen lds
    s_add_u32 m0, s44, 69632
    s_add_u32 s63, s55, 4816896
    buffer_load_dwordx4 v8, s[16:19], s63 offen lds
    s_lshl_b32 s74, s49, 1
    s_add_u32 s74, s74, s51
    s_lshl_b32 s74, s74, 4
    s_mul_i32 s74, s74, 128
    s_add_u32 s74, s74, 131072
    v_min_u32 v23, 15, v3
    v_mul_u32_u24 v62, 128, v23
    buffer_load_dword v63, v62, s[36:39], s74 offen sc1
    s_add_u32 m0, s44, 73728
    s_add_u32 s63, s55, 1261568
    buffer_load_dwordx4 v8, s[16:19], s63 offen lds
    s_add_u32 m0, s44, 77824
    s_add_u32 s63, s55, 4931584
    buffer_load_dwordx4 v8, s[16:19], s63 offen lds
    s_add_u32 m0, s44, 81920
    s_add_u32 s63, s55, 1376256
    buffer_load_dwordx4 v8, s[16:19], s63 offen lds
    s_add_u32 m0, s44, 86016
    s_add_u32 s63, s55, 5046272
    buffer_load_dwordx4 v8, s[16:19], s63 offen lds
    s_add_u32 m0, s44, 90112
    s_add_u32 s63, s55, 1490944
    buffer_load_dwordx4 v8, s[16:19], s63 offen lds
    s_add_u32 m0, s44, 94208
    s_add_u32 s63, s55, 5160960
    buffer_load_dwordx4 v8, s[16:19], s63 offen lds
    s_add_u32 m0, s44, 98304
    s_add_u32 s63, s55, 1605632
    buffer_load_dwordx4 v8, s[16:19], s63 offen lds
    s_add_u32 m0, s44, 102400
    s_add_u32 s63, s55, 5275648
    buffer_load_dwordx4 v8, s[16:19], s63 offen lds
    s_add_u32 m0, s44, 106496
    s_add_u32 s63, s55, 1720320
    buffer_load_dwordx4 v8, s[16:19], s63 offen lds
    s_add_u32 m0, s44, 110592
    s_add_u32 s63, s55, 5390336
    buffer_load_dwordx4 v8, s[16:19], s63 offen lds
    s_add_u32 m0, s44, 114688
    s_add_u32 s63, s55, 1835008
    buffer_load_dwordx4 v8, s[16:19], s63 offen lds
    s_add_u32 m0, s44, 118784
    s_add_u32 s63, s55, 5505024
    buffer_load_dwordx4 v8, s[16:19], s63 offen lds
    s_add_u32 m0, s44, 122880
    s_add_u32 s63, s55, 1949696
    buffer_load_dwordx4 v8, s[16:19], s63 offen lds
    s_add_u32 m0, s44, 126976
    s_add_u32 s63, s55, 5619712
    buffer_load_dwordx4 v8, s[16:19], s63 offen lds
    s_waitcnt vmcnt(14)
    s_mov_b32 s70, 30000
chk_44:
    v_cmp_ne_u32 vcc, v63, v26
    s_nop 3
    s_and_b64 vcc, vcc, 0x0000ffff
    s_cbranch_scc0 chk_44_d
    buffer_load_dword v63, v62, s[36:39], s74 offen sc1
    s_waitcnt vmcnt(0)
    s_sub_u32 s70, s70, 1
    s_cmp_lg_u32 s70, 0
    s_cbranch_scc1 chk_44
chk_44_d:
    s_add_u32 s82, s72, 57344
    buffer_load_dwordx4 v[128:131], v4, s[36:39], s82 offen offset:0 sc1
    buffer_load_dwordx4 v[132:135], v4, s[36:39], s82 offen offset:1024 sc1
    buffer_load_dwordx4 v[136:139], v4, s[36:39], s82 offen offset:2048 sc1
    buffer_load_dwordx4 v[140:143], v4, s[36:39], s82 offen offset:3072 sc1
    s_add_u32 s82, s72, 61440
    buffer_load_dwordx4 v[144:147], v4, s[36:39], s82 offen offset:0 sc1
    buffer_load_dwordx4 v[148:151], v4, s[36:39], s82 offen offset:1024 sc1
    buffer_load_dwordx4 v[152:155], v4, s[36:39], s82 offen offset:2048 sc1
    buffer_load_dwordx4 v[156:159], v4, s[36:39], s82 offen offset:3072 sc1
    s_add_u32 s82, s72, 0
    buffer_load_dwordx4 v[160:163], v4, s[36:39], s82 offen offset:0 sc1
    buffer_load_dwordx4 v[164:167], v4, s[36:39], s82 offen offset:1024 sc1
    buffer_load_dwordx4 v[168:171], v4, s[36:39], s82 offen offset:2048 sc1
    buffer_load_dwordx4 v[172:175], v4, s[36:39], s82 offen offset:3072 sc1
    s_add_u32 s82, s72, 4096
    buffer_load_dwordx4 v[176:179], v4, s[36:39], s82 offen offset:0 sc1
    buffer_load_dwordx4 v[180:183], v4, s[36:39], s82 offen offset:1024 sc1
    v_lshlrev_b32 v64, 16, v48
    v_and_b32 v65, 0xffff0000, v48
    v_lshlrev_b32 v66, 16, v49
    v_and_b32 v67, 0xffff0000, v49
    v_lshlrev_b32 v68, 16, v50
    v_and_b32 v69, 0xffff0000, v50
    v_lshlrev_b32 v70, 16, v51
    v_and_b32 v71, 0xffff0000, v51
    v_lshlrev_b32 v72, 16, v52
    v_and_b32 v73, 0xffff0000, v52
    v_lshlrev_b32 v74, 16, v53
    v_and_b32 v75, 0xffff0000, v53
    v_lshlrev_b32 v76, 16, v54
    v_and_b32 v77, 0xffff0000, v54
    v_lshlrev_b32 v78, 16, v55
    v_and_b32 v79, 0xffff0000, v55
    v_mov_b32 v48, 0xbdd2d3e8
    v_mov_b32 v50, 0xc0135761
    s_lshl_b32 s60, s49, 1
    s_add_u32 s60, s60, s52
    s_mul_i32 s60, s60, 56
    s_lshl_b32 s61, s50, 1
    s_add_u32 s60, s60, s61
    s_add_u32 s60, s60, s51
    s_lshl_b32 s60, s60, 11
    s_add_u32 s60, s60, 12582912
    s_lshl_b32 s62, s41, 12
    s_add_u32 s62, s62, 147456
    v_add_u32 v22, s62, v4
    v_xor_b32 v23, 8192, v22
    s_waitcnt vmcnt(13)
    v_mfma_f32_32x32x16_bf16 v[64:79], a[208:211], v[128:131], v[64:79]
    buffer_load_dwordx4 v[184:187], v4, s[36:39], s82 offen offset:2048 sc1
    v_mfma_f32_32x32x16_bf16 v[80:95], a[212:215], v[128:131], 0
    s_waitcnt vmcnt(13)
    v_mfma_f32_32x32x16_bf16 v[64:79], a[216:219], v[132:135], v[64:79]
    buffer_load_dwordx4 v[188:191], v4, s[36:39], s82 offen offset:3072 sc1
    v_mfma_f32_32x32x16_bf16 v[80:95], a[220:223], v[132:135], v[80:95]
    s_waitcnt vmcnt(13)
    v_mfma_f32_32x32x16_bf16 v[64:79], a[224:227], v[136:139], v[64:79]
    s_add_u32 s82, s72, 8192
    buffer_load_dwordx4 v[192:195], v4, s[36:39], s82 offen offset:0 sc1
    v_mfma_f32_32x32x16_bf16 v[80:95], a[228:231], v[136:139], v[80:95]
    s_waitcnt vmcnt(13)
    v_mfma_f32_32x32x16_bf16 v[64:79], a[232:235], v[140:143], v[64:79]
    buffer_load_dwordx4 v[196:199], v4, s[36:39], s82 offen offset:1024 sc1
    v_mfma_f32_32x32x16_bf16 v[80:95], a[236:239], v[140:143], v[80:95]
    s_waitcnt vmcnt(13)
    v_mfma_f32_32x32x16_bf16 v[64:79], a[240:243], v[144:147], v[64:79]
    buffer_load_dwordx4 v[200:203], v4, s[36:39], s82 offen offset:2048 sc1
    v_mfma_f32_32x32x16_bf16 v[80:95], a[244:247], v[144:147], v[80:95]
    s_waitcnt vmcnt(13)
    v_mfma_f32_32x32x16_bf16 v[64:79], a[248:251], v[148:151], v[64:79]
    s_barrier
    ds_read_b64_tr_b16 v[96:97], v60 offset:32768
    ds_read_b64_tr_b16 v[98:99], v60 offset:33792
    buffer_load_dwordx4 v[204:207], v4, s[36:39], s82 offen offset:3072 sc1
    v_mfma_f32_32x32x16_bf16 v[80:95], a[252:255], v[148:151], v[80:95]
    ds_read_b64_tr_b16 v[100:101], v61 offset:32768
    ds_read_b64_tr_b16 v[102:103], v61 offset:33792
    s_waitcnt vmcnt(13)
    v_mfma_f32_32x32x16_bf16 v[64:79], a[0:3], v[152:155], v[64:79]
    ds_read_b64_tr_b16 v[104:105], v60 offset:34816
    ds_read_b64_tr_b16 v[106:107], v60 offset:35840
    s_add_u32 s82, s72, 12288
    buffer_load_dwordx4 v[208:211], v4, s[36:39], s82 offen offset:0 sc1
    v_mfma_f32_32x32x16_bf16 v[80:95], a[4:7], v[152:155], v[80:95]
    ds_read_b64_tr_b16 v[108:109], v61 offset:34816
    ds_read_b64_tr_b16 v[110:111], v61 offset:35840
    s_waitcnt vmcnt(13)
    v_mfma_f32_32x32x16_bf16 v[64:79], a[8:11], v[156:159], v[64:79]
    ds_read_b64_tr_b16 v[112:113], v60 offset:40960
    ds_read_b64_tr_b16 v[114:115], v60 offset:41984
    buffer_load_dwordx4 v[212:215], v4, s[36:39], s82 offen offset:1024 sc1
    v_mfma_f32_32x32x16_bf16 v[80:95], a[12:15], v[156:159], v[80:95]
    ds_read_b64_tr_b16 v[116:117], v61 offset:40960
    ds_read_b64_tr_b16 v[118:119], v61 offset:41984
    s_waitcnt vmcnt(13) lgkmcnt(10)
    v_mfma_f32_32x32x16_bf16 v[64:79], v[96:99], v[160:163], v[64:79]
    ds_read_b64_tr_b16 v[120:121], v60 offset:43008
    ds_read_b64_tr_b16 v[122:123], v60 offset:44032
    buffer_load_dwordx4 v[216:219], v4, s[36:39], s82 offen offset:2048 sc1
    s_waitcnt lgkmcnt(10)
    v_mfma_f32_32x32x16_bf16 v[80:95], v[100:103], v[160:163], v[80:95]
    ds_read_b64_tr_b16 v[124:125], v61 offset:43008
    ds_read_b64_tr_b16 v[126:127], v61 offset:44032
    s_waitcnt vmcnt(13) lgkmcnt(10)
    v_mfma_f32_32x32x16_bf16 v[64:79], v[104:107], v[164:167], v[64:79]
    ds_read_b64_tr_b16 v[96:97], v56 offset:0
    ds_read_b64_tr_b16 v[98:99], v56 offset:1024
    buffer_load_dwordx4 v[220:223], v4, s[36:39], s82 offen offset:3072 sc1
    s_waitcnt lgkmcnt(10)
    v_mfma_f32_32x32x16_bf16 v[80:95], v[108:111], v[164:167], v[80:95]
    ds_read_b64_tr_b16 v[100:101], v57 offset:0
    ds_read_b64_tr_b16 v[102:103], v57 offset:1024
    s_waitcnt vmcnt(13) lgkmcnt(10)
    v_mfma_f32_32x32x16_bf16 v[64:79], v[112:115], v[168:171], v[64:79]
    ds_read_b64_tr_b16 v[104:105], v56 offset:2048
    ds_read_b64_tr_b16 v[106:107], v56 offset:3072
    s_add_u32 s82, s72, 16384
    buffer_load_dwordx4 v[224:227], v4, s[36:39], s82 offen offset:0 sc1
    s_waitcnt lgkmcnt(10)
    v_mfma_f32_32x32x16_bf16 v[80:95], v[116:119], v[168:171], v[80:95]
    ds_read_b64_tr_b16 v[108:109], v57 offset:2048
    ds_read_b64_tr_b16 v[110:111], v57 offset:3072
    s_waitcnt vmcnt(13) lgkmcnt(10)
    v_mfma_f32_32x32x16_bf16 v[64:79], v[120:123], v[172:175], v[64:79]
    ds_read_b64_tr_b16 v[112:113], v56 offset:8192
    ds_read_b64_tr_b16 v[114:115], v56 offset:9216
    buffer_load_dwordx4 v[228:231], v4, s[36:39], s82 offen offset:1024 sc1
    s_waitcnt lgkmcnt(10)
    v_mfma_f32_32x32x16_bf16 v[80:95], v[124:127], v[172:175], v[80:95]
    ds_read_b64_tr_b16 v[116:117], v57 offset:8192
    ds_read_b64_tr_b16 v[118:119], v57 offset:9216
    s_waitcnt vmcnt(13) lgkmcnt(10)
    v_mfma_f32_32x32x16_bf16 v[64:79], v[96:99], v[176:179], v[64:79]
    ds_read_b64_tr_b16 v[120:121], v56 offset:10240
    ds_read_b64_tr_b16 v[122:123], v56 offset:11264
    buffer_load_dwordx4 v[128:131], v4, s[36:39], s82 offen offset:2048 sc1
    s_waitcnt lgkmcnt(10)
    v_mfma_f32_32x32x16_bf16 v[80:95], v[100:103], v[176:179], v[80:95]
    ds_read_b64_tr_b16 v[124:125], v57 offset:10240
    ds_read_b64_tr_b16 v[126:127], v57 offset:11264
    s_waitcnt vmcnt(13) lgkmcnt(10)
    v_mfma_f32_32x32x16_bf16 v[64:79], v[104:107], v[180:183], v[64:79]
    ds_read_b64_tr_b16 v[96:97], v56 offset:16384
    ds_read_b64_tr_b16 v[98:99], v56 offset:17408
    buffer_load_dwordx4 v[132:135], v4, s[36:39], s82 offen offset:3072 sc1
    s_waitcnt lgkmcnt(10)
    v_mfma_f32_32x32x16_bf16 v[80:95], v[108:111], v[180:183], v[80:95]
    ds_read_b64_tr_b16 v[100:101], v57 offset:16384
    ds_read_b64_tr_b16 v[102:103], v57 offset:17408
    s_waitcnt vmcnt(13) lgkmcnt(10)
    v_mfma_f32_32x32x16_bf16 v[64:79], v[112:115], v[184:187], v[64:79]
    ds_read_b64_tr_b16 v[104:105], v56 offset:18432
    ds_read_b64_tr_b16 v[106:107], v56 offset:19456
    s_add_u32 s82, s72, 20480
    buffer_load_dwordx4 v[136:139], v4, s[36:39], s82 offen offset:0 sc1
    s_waitcnt lgkmcnt(10)
    v_mfma_f32_32x32x16_bf16 v[80:95], v[116:119], v[184:187], v[80:95]
    ds_read_b64_tr_b16 v[108:109], v57 offset:18432
    ds_read_b64_tr_b16 v[110:111], v57 offset:19456
    s_waitcnt vmcnt(13) lgkmcnt(10)
    v_mfma_f32_32x32x16_bf16 v[64:79], v[120:123], v[188:191], v[64:79]
    ds_read_b64_tr_b16 v[112:113], v56 offset:24576
    ds_read_b64_tr_b16 v[114:115], v56 offset:25600
    buffer_load_dwordx4 v[140:143], v4, s[36:39], s82 offen offset:1024 sc1
    s_waitcnt lgkmcnt(10)
    v_mfma_f32_32x32x16_bf16 v[80:95], v[124:127], v[188:191], v[80:95]
    ds_read_b64_tr_b16 v[116:117], v57 offset:24576
    ds_read_b64_tr_b16 v[118:119], v57 offset:25600
    s_waitcnt vmcnt(13) lgkmcnt(10)
    v_mfma_f32_32x32x16_bf16 v[64:79], v[96:99], v[192:195], v[64:79]
    ds_read_b64_tr_b16 v[120:121], v56 offset:26624
    ds_read_b64_tr_b16 v[122:123], v56 offset:27648
    buffer_load_dwordx4 v[144:147], v4, s[36:39], s82 offen offset:2048 sc1
    s_waitcnt lgkmcnt(10)
    v_mfma_f32_32x32x16_bf16 v[80:95], v[100:103], v[192:195], v[80:95]
    ds_read_b64_tr_b16 v[124:125], v57 offset:26624
    ds_read_b64_tr_b16 v[126:127], v57 offset:27648
    s_waitcnt vmcnt(13) lgkmcnt(10)
    v_mfma_f32_32x32x16_bf16 v[64:79], v[104:107], v[196:199], v[64:79]
    ds_read_b64_tr_b16 v[96:97], v56 offset:32768
    ds_read_b64_tr_b16 v[98:99], v56 offset:33792
    buffer_load_dwordx4 v[148:151], v4, s[36:39], s82 offen offset:3072 sc1
    s_waitcnt lgkmcnt(10)
    v_mfma_f32_32x32x16_bf16 v[80:95], v[108:111], v[196:199], v[80:95]
    ds_read_b64_tr_b16 v[100:101], v57 offset:32768
    ds_read_b64_tr_b16 v[102:103], v57 offset:33792
    s_waitcnt vmcnt(13) lgkmcnt(10)
    v_mfma_f32_32x32x16_bf16 v[64:79], v[112:115], v[200:203], v[64:79]
    ds_read_b64_tr_b16 v[104:105], v56 offset:34816
    ds_read_b64_tr_b16 v[106:107], v56 offset:35840
    s_add_u32 s82, s72, 24576
    buffer_load_dwordx4 v[152:155], v4, s[36:39], s82 offen offset:0 sc1
    s_waitcnt lgkmcnt(10)
    v_mfma_f32_32x32x16_bf16 v[80:95], v[116:119], v[200:203], v[80:95]
    ds_read_b64_tr_b16 v[108:109], v57 offset:34816
    ds_read_b64_tr_b16 v[110:111], v57 offset:35840
    s_waitcnt vmcnt(13) lgkmcnt(10)
    v_mfma_f32_32x32x16_bf16 v[64:79], v[120:123], v[204:207], v[64:79]
    ds_read_b64_tr_b16 v[112:113], v56 offset:40960
    ds_read_b64_tr_b16 v[114:115], v56 offset:41984
    buffer_load_dwordx4 v[156:159], v4, s[36:39], s82 offen offset:1024 sc1
    s_waitcnt lgkmcnt(10)
    v_mfma_f32_32x32x16_bf16 v[80:95], v[124:127], v[204:207], v[80:95]
    ds_read_b64_tr_b16 v[116:117], v57 offset:40960
    ds_read_b64_tr_b16 v[118:119], v57 offset:41984
    s_waitcnt vmcnt(13) lgkmcnt(10)
    v_mfma_f32_32x32x16_bf16 v[64:79], v[96:99], v[208:211], v[64:79]
    ds_read_b64_tr_b16 v[120:121], v56 offset:43008
    ds_read_b64_tr_b16 v[122:123], v56 offset:44032
    buffer_load_dwordx4 v[160:163], v4, s[36:39], s82 offen offset:2048 sc1
    s_waitcnt lgkmcnt(10)
    v_mfma_f32_32x32x16_bf16 v[80:95], v[100:103], v[208:211], v[80:95]
    ds_read_b64_tr_b16 v[124:125], v57 offset:43008
    ds_read_b64_tr_b16 v[126:127], v57 offset:44032
    s_waitcnt vmcnt(13) lgkmcnt(10)
    v_mfma_f32_32x32x16_bf16 v[64:79], v[104:107], v[212:215], v[64:79]
    ds_read_b64_tr_b16 v[96:97], v58 offset:0
    ds_read_b64_tr_b16 v[98:99], v58 offset:1024
    buffer_load_dwordx4 v[164:167], v4, s[36:39], s82 offen offset:3072 sc1
    s_waitcnt lgkmcnt(10)
    v_mfma_f32_32x32x16_bf16 v[80:95], v[108:111], v[212:215], v[80:95]
    ds_read_b64_tr_b16 v[100:101], v59 offset:0
    ds_read_b64_tr_b16 v[102:103], v59 offset:1024
    s_waitcnt vmcnt(13) lgkmcnt(10)
    v_mfma_f32_32x32x16_bf16 v[64:79], v[112:115], v[216:219], v[64:79]
    ds_read_b64_tr_b16 v[104:105], v58 offset:2048
    ds_read_b64_tr_b16 v[106:107], v58 offset:3072
    s_add_u32 s82, s72, 28672
    buffer_load_dwordx4 v[168:171], v4, s[36:39], s82 offen offset:0 sc1
    s_waitcnt lgkmcnt(10)
    v_mfma_f32_32x32x16_bf16 v[80:95], v[116:119], v[216:219], v[80:95]
    ds_read_b64_tr_b16 v[108:109], v59 offset:2048
    ds_read_b64_tr_b16 v[110:111], v59 offset:3072
    s_waitcnt vmcnt(13) lgkmcnt(10)
    v_mfma_f32_32x32x16_bf16 v[64:79], v[120:123], v[220:223], v[64:79]
    ds_read_b64_tr_b16 v[112:113], v58 offset:8192
    ds_read_b64_tr_b16 v[114:115], v58 offset:9216
    buffer_load_dwordx4 v[172:175], v4, s[36:39], s82 offen offset:1024 sc1
    s_waitcnt lgkmcnt(10)
    v_mfma_f32_32x32x16_bf16 v[80:95], v[124:127], v[220:223], v[80:95]
    ds_read_b64_tr_b16 v[116:117], v59 offset:8192
    ds_read_b64_tr_b16 v[118:119], v59 offset:9216
    s_waitcnt vmcnt(13) lgkmcnt(10)
    v_mfma_f32_32x32x16_bf16 v[64:79], v[96:99], v[224:227], v[64:79]
    ds_read_b64_tr_b16 v[120:121], v58 offset:10240
    ds_read_b64_tr_b16 v[122:123], v58 offset:11264
    buffer_load_dwordx4 v[176:179], v4, s[36:39], s82 offen offset:2048 sc1
    s_waitcnt lgkmcnt(10)
    v_mfma_f32_32x32x16_bf16 v[80:95], v[100:103], v[224:227], v[80:95]
    ds_read_b64_tr_b16 v[124:125], v59 offset:10240
    ds_read_b64_tr_b16 v[126:127], v59 offset:11264
    s_waitcnt vmcnt(13) lgkmcnt(10)
    v_mfma_f32_32x32x16_bf16 v[64:79], v[104:107], v[228:231], v[64:79]
    ds_read_b64_tr_b16 v[96:97], v58 offset:16384
    ds_read_b64_tr_b16 v[98:99], v58 offset:17408
    buffer_load_dwordx4 v[180:183], v4, s[36:39], s82 offen offset:3072 sc1
    s_waitcnt lgkmcnt(10)
    v_mfma_f32_32x32x16_bf16 v[80:95], v[108:111], v[228:231], v[80:95]
    ds_read_b64_tr_b16 v[100:101], v59 offset:16384
    ds_read_b64_tr_b16 v[102:103], v59 offset:17408
    s_waitcnt vmcnt(13) lgkmcnt(10)
    v_mfma_f32_32x32x16_bf16 v[64:79], v[112:115], v[128:131], v[64:79]
    ds_read_b64_tr_b16 v[104:105], v58 offset:18432
    ds_read_b64_tr_b16 v[106:107], v58 offset:19456
    s_add_u32 s82, s72, 32768
    buffer_load_dwordx4 v[184:187], v4, s[36:39], s82 offen offset:0 sc1
    s_waitcnt lgkmcnt(10)
    v_mfma_f32_32x32x16_bf16 v[80:95], v[116:119], v[128:131], v[80:95]
    ds_read_b64_tr_b16 v[108:109], v59 offset:18432
    ds_read_b64_tr_b16 v[110:111], v59 offset:19456
    s_waitcnt vmcnt(13) lgkmcnt(10)
    v_mfma_f32_32x32x16_bf16 v[64:79], v[120:123], v[132:135], v[64:79]
    ds_read_b64_tr_b16 v[112:113], v58 offset:24576
    ds_read_b64_tr_b16 v[114:115], v58 offset:25600
    buffer_load_dwordx4 v[188:191], v4, s[36:39], s82 offen offset:1024 sc1
    s_waitcnt lgkmcnt(10)
    v_mfma_f32_32x32x16_bf16 v[80:95], v[124:127], v[132:135], v[80:95]
    ds_read_b64_tr_b16 v[116:117], v59 offset:24576
    ds_read_b64_tr_b16 v[118:119], v59 offset:25600
    s_waitcnt vmcnt(13) lgkmcnt(10)
    v_mfma_f32_32x32x16_bf16 v[64:79], v[96:99], v[136:139], v[64:79]
    ds_read_b64_tr_b16 v[120:121], v58 offset:26624
    ds_read_b64_tr_b16 v[122:123], v58 offset:27648
    buffer_load_dwordx4 v[192:195], v4, s[36:39], s82 offen offset:2048 sc1
    s_waitcnt lgkmcnt(10)
    v_mfma_f32_32x32x16_bf16 v[80:95], v[100:103], v[136:139], v[80:95]
    ds_read_b64_tr_b16 v[124:125], v59 offset:26624
    ds_read_b64_tr_b16 v[126:127], v59 offset:27648
    s_waitcnt vmcnt(13) lgkmcnt(10)
    v_mfma_f32_32x32x16_bf16 v[64:79], v[104:107], v[140:143], v[64:79]
    ds_read_b64_tr_b16 v[96:97], v58 offset:32768
    ds_read_b64_tr_b16 v[98:99], v58 offset:33792
    buffer_load_dwordx4 v[196:199], v4, s[36:39], s82 offen offset:3072 sc1
    s_waitcnt lgkmcnt(10)
    v_mfma_f32_32x32x16_bf16 v[80:95], v[108:111], v[140:143], v[80:95]
    ds_read_b64_tr_b16 v[100:101], v59 offset:32768
    ds_read_b64_tr_b16 v[102:103], v59 offset:33792
    s_waitcnt vmcnt(13) lgkmcnt(10)
    v_mfma_f32_32x32x16_bf16 v[64:79], v[112:115], v[144:147], v[64:79]
    ds_read_b64_tr_b16 v[104:105], v58 offset:34816
    ds_read_b64_tr_b16 v[106:107], v58 offset:35840
    s_add_u32 s82, s72, 36864
    buffer_load_dwordx4 v[200:203], v4, s[36:39], s82 offen offset:0 sc1
    s_waitcnt lgkmcnt(10)
    v_mfma_f32_32x32x16_bf16 v[80:95], v[116:119], v[144:147], v[80:95]
    ds_read_b64_tr_b16 v[108:109], v59 offset:34816
    ds_read_b64_tr_b16 v[110:111], v59 offset:35840
    s_waitcnt vmcnt(13) lgkmcnt(10)
    v_mfma_f32_32x32x16_bf16 v[64:79], v[120:123], v[148:151], v[64:79]
    ds_read_b64_tr_b16 v[112:113], v58 offset:40960
    ds_read_b64_tr_b16 v[114:115], v58 offset:41984
    buffer_load_dwordx4 v[204:207], v4, s[36:39], s82 offen offset:1024 sc1
    s_waitcnt lgkmcnt(10)
    v_mfma_f32_32x32x16_bf16 v[80:95], v[124:127], v[148:151], v[80:95]
    ds_read_b64_tr_b16 v[116:117], v59 offset:40960
    ds_read_b64_tr_b16 v[118:119], v59 offset:41984
    s_waitcnt vmcnt(13) lgkmcnt(10)
    v_mfma_f32_32x32x16_bf16 v[64:79], v[96:99], v[152:155], v[64:79]
    ds_read_b64_tr_b16 v[120:121], v58 offset:43008
    ds_read_b64_tr_b16 v[122:123], v58 offset:44032
    buffer_load_dwordx4 v[208:211], v4, s[36:39], s82 offen offset:2048 sc1
    s_waitcnt lgkmcnt(10)
    v_mfma_f32_32x32x16_bf16 v[80:95], v[100:103], v[152:155], v[80:95]
    ds_read_b64_tr_b16 v[124:125], v59 offset:43008
    ds_read_b64_tr_b16 v[126:127], v59 offset:44032
    s_waitcnt vmcnt(13) lgkmcnt(10)
    v_mfma_f32_32x32x16_bf16 v[64:79], v[104:107], v[156:159], v[64:79]
    ds_read_b64_tr_b16 v[96:97], v60 offset:0
    ds_read_b64_tr_b16 v[98:99], v60 offset:1024
    buffer_load_dwordx4 v[212:215], v4, s[36:39], s82 offen offset:3072 sc1
    s_waitcnt lgkmcnt(10)
    v_mfma_f32_32x32x16_bf16 v[80:95], v[108:111], v[156:159], v[80:95]
    ds_read_b64_tr_b16 v[100:101], v61 offset:0
    ds_read_b64_tr_b16 v[102:103], v61 offset:1024
    s_waitcnt vmcnt(13) lgkmcnt(10)
    v_mfma_f32_32x32x16_bf16 v[64:79], v[112:115], v[160:163], v[64:79]
    ds_read_b64_tr_b16 v[104:105], v60 offset:2048
    ds_read_b64_tr_b16 v[106:107], v60 offset:3072
    s_add_u32 s82, s72, 40960
    buffer_load_dwordx4 v[216:219], v4, s[36:39], s82 offen offset:0 sc1
    s_waitcnt lgkmcnt(10)
    v_mfma_f32_32x32x16_bf16 v[80:95], v[116:119], v[160:163], v[80:95]
    ds_read_b64_tr_b16 v[108:109], v61 offset:2048
    ds_read_b64_tr_b16 v[110:111], v61 offset:3072
    s_waitcnt vmcnt(13) lgkmcnt(10)
    v_mfma_f32_32x32x16_bf16 v[64:79], v[120:123], v[164:167], v[64:79]
    ds_read_b64_tr_b16 v[112:113], v60 offset:8192
    ds_read_b64_tr_b16 v[114:115], v60 offset:9216
    buffer_load_dwordx4 v[220:223], v4, s[36:39], s82 offen offset:1024 sc1
    s_waitcnt lgkmcnt(10)
    v_mfma_f32_32x32x16_bf16 v[80:95], v[124:127], v[164:167], v[80:95]
    ds_read_b64_tr_b16 v[116:117], v61 offset:8192
    ds_read_b64_tr_b16 v[118:119], v61 offset:9216
    s_waitcnt vmcnt(13) lgkmcnt(10)
    v_mfma_f32_32x32x16_bf16 v[64:79], v[96:99], v[168:171], v[64:79]
    ds_read_b64_tr_b16 v[120:121], v60 offset:10240
    ds_read_b64_tr_b16 v[122:123], v60 offset:11264
    buffer_load_dwordx4 v[224:227], v4, s[36:39], s82 offen offset:2048 sc1
    s_waitcnt lgkmcnt(10)
    v_mfma_f32_32x32x16_bf16 v[80:95], v[100:103], v[168:171], v[80:95]
    ds_read_b64_tr_b16 v[124:125], v61 offset:10240
    ds_read_b64_tr_b16 v[126:127], v61 offset:11264
    s_waitcnt vmcnt(13) lgkmcnt(10)
    v_mfma_f32_32x32x16_bf16 v[64:79], v[104:107], v[172:175], v[64:79]
    ds_read_b64_tr_b16 v[96:97], v60 offset:16384
    ds_read_b64_tr_b16 v[98:99], v60 offset:17408
    buffer_load_dwordx4 v[228:231], v4, s[36:39], s82 offen offset:3072 sc1
    s_waitcnt lgkmcnt(10)
    v_mfma_f32_32x32x16_bf16 v[80:95], v[108:111], v[172:175], v[80:95]
    ds_read_b64_tr_b16 v[100:101], v61 offset:16384
    ds_read_b64_tr_b16 v[102:103], v61 offset:17408
    s_waitcnt vmcnt(13) lgkmcnt(10)
    v_mfma_f32_32x32x16_bf16 v[64:79], v[112:115], v[176:179], v[64:79]
    ds_read_b64_tr_b16 v[104:105], v60 offset:18432
    ds_read_b64_tr_b16 v[106:107], v60 offset:19456
    s_add_u32 s82, s72, 45056
    buffer_load_dwordx4 v[128:131], v4, s[36:39], s82 offen offset:0 sc1
    s_waitcnt lgkmcnt(10)
    v_mfma_f32_32x32x16_bf16 v[80:95], v[116:119], v[176:179], v[80:95]
    ds_read_b64_tr_b16 v[108:109], v61 offset:18432
    ds_read_b64_tr_b16 v[110:111], v61 offset:19456
    s_waitcnt vmcnt(13) lgkmcnt(10)
    v_mfma_f32_32x32x16_bf16 v[64:79], v[120:123], v[180:183], v[64:79]
    ds_read_b64_tr_b16 v[112:113], v60 offset:24576
    ds_read_b64_tr_b16 v[114:115], v60 offset:25600
    buffer_load_dwordx4 v[132:135], v4, s[36:39], s82 offen offset:1024 sc1
    s_waitcnt lgkmcnt(10)
    v_mfma_f32_32x32x16_bf16 v[80:95], v[124:127], v[180:183], v[80:95]
    ds_read_b64_tr_b16 v[116:117], v61 offset:24576
    ds_read_b64_tr_b16 v[118:119], v61 offset:25600
    s_waitcnt vmcnt(13) lgkmcnt(10)
    v_mfma_f32_32x32x16_bf16 v[64:79], v[96:99], v[184:187], v[64:79]
    ds_read_b64_tr_b16 v[120:121], v60 offset:26624
    ds_read_b64_tr_b16 v[122:123], v60 offset:27648
    buffer_load_dwordx4 v[136:139], v4, s[36:39], s82 offen offset:2048 sc1
    s_waitcnt lgkmcnt(10)
    v_mfma_f32_32x32x16_bf16 v[80:95], v[100:103], v[184:187], v[80:95]
    ds_read_b64_tr_b16 v[124:125], v61 offset:26624
    ds_read_b64_tr_b16 v[126:127], v61 offset:27648
    s_waitcnt vmcnt(13) lgkmcnt(10)
    v_mfma_f32_32x32x16_bf16 v[64:79], v[104:107], v[188:191], v[64:79]
    buffer_load_dwordx4 v[140:143], v4, s[36:39], s82 offen offset:3072 sc1
    s_waitcnt lgkmcnt(8)
    v_mfma_f32_32x32x16_bf16 v[80:95], v[108:111], v[188:191], v[80:95]
    s_waitcnt vmcnt(13) lgkmcnt(6)
    v_mfma_f32_32x32x16_bf16 v[64:79], v[112:115], v[192:195], v[64:79]
    s_add_u32 s82, s72, 49152
    buffer_load_dwordx4 v[144:147], v4, s[36:39], s82 offen offset:0 sc1
    s_waitcnt lgkmcnt(4)
    v_mfma_f32_32x32x16_bf16 v[80:95], v[116:119], v[192:195], v[80:95]
    s_waitcnt vmcnt(13) lgkmcnt(2)
    v_mfma_f32_32x32x16_bf16 v[64:79], v[120:123], v[196:199], v[64:79]
    buffer_load_dwordx4 v[148:151], v4, s[36:39], s82 offen offset:1024 sc1
    s_waitcnt lgkmcnt(0)
    v_mfma_f32_32x32x16_bf16 v[80:95], v[124:127], v[196:199], v[80:95]
    s_barrier
    s_waitcnt vmcnt(13)
    v_mfma_f32_32x32x16_bf16 v[64:79], a[48:51], v[200:203], v[64:79]
    buffer_load_dwordx4 v[152:155], v4, s[36:39], s82 offen offset:2048 sc1
    v_mfma_f32_32x32x16_bf16 v[80:95], a[52:55], v[200:203], v[80:95]
    s_waitcnt vmcnt(13)
    v_mfma_f32_32x32x16_bf16 v[64:79], a[56:59], v[204:207], v[64:79]
    buffer_load_dwordx4 v[156:159], v4, s[36:39], s82 offen offset:3072 sc1
    v_mfma_f32_32x32x16_bf16 v[80:95], a[60:63], v[204:207], v[80:95]
    s_waitcnt vmcnt(13)
    v_mfma_f32_32x32x16_bf16 v[64:79], a[64:67], v[208:211], v[64:79]
    s_add_u32 s82, s72, 53248
    buffer_load_dwordx4 v[160:163], v4, s[36:39], s82 offen offset:0 sc1
    v_mfma_f32_32x32x16_bf16 v[80:95], a[68:71], v[208:211], v[80:95]
    s_waitcnt vmcnt(13)
    v_mfma_f32_32x32x16_bf16 v[64:79], a[72:75], v[212:215], v[64:79]
    buffer_load_dwordx4 v[164:167], v4, s[36:39], s82 offen offset:1024 sc1
    v_mfma_f32_32x32x16_bf16 v[80:95], a[76:79], v[212:215], v[80:95]
    s_waitcnt vmcnt(13)
    v_mfma_f32_32x32x16_bf16 v[64:79], a[80:83], v[216:219], v[64:79]
    buffer_load_dwordx4 v[168:171], v4, s[36:39], s82 offen offset:2048 sc1
    v_mfma_f32_32x32x16_bf16 v[80:95], a[84:87], v[216:219], v[80:95]
    s_waitcnt vmcnt(13)
    v_mfma_f32_32x32x16_bf16 v[64:79], a[88:91], v[220:223], v[64:79]
    buffer_load_dwordx4 v[172:175], v4, s[36:39], s82 offen offset:3072 sc1
    v_mfma_f32_32x32x16_bf16 v[80:95], a[92:95], v[220:223], v[80:95]
    s_waitcnt vmcnt(13)
    v_mfma_f32_32x32x16_bf16 v[64:79], a[96:99], v[224:227], v[64:79]
    s_add_u32 m0, s44, 65536
    s_add_u32 s63, s56, 2359296
    buffer_load_dwordx4 v9, s[20:23], s63 offen lds
    v_mfma_f32_32x32x16_bf16 v[80:95], a[100:103], v[224:227], v[80:95]
    s_waitcnt vmcnt(13)
    v_mfma_f32_32x32x16_bf16 v[64:79], a[104:107], v[228:231], v[64:79]
    s_add_u32 m0, s44, 69632
    s_add_u32 s63, s56, 6029312
    buffer_load_dwordx4 v9, s[20:23], s63 offen lds
    v_mfma_f32_32x32x16_bf16 v[80:95], a[108:111], v[228:231], v[80:95]
    s_waitcnt vmcnt(13)
    v_mfma_f32_32x32x16_bf16 v[64:79], a[112:115], v[128:131], v[64:79]
    s_add_u32 m0, s44, 73728
    s_add_u32 s63, s56, 2490368
    buffer_load_dwordx4 v9, s[20:23], s63 offen lds
    v_mfma_f32_32x32x16_bf16 v[80:95], a[116:119], v[128:131], v[80:95]
    s_waitcnt vmcnt(13)
    v_mfma_f32_32x32x16_bf16 v[64:79], a[120:123], v[132:135], v[64:79]
    s_add_u32 m0, s44, 77824
    s_add_u32 s63, s56, 6160384
    buffer_load_dwordx4 v9, s[20:23], s63 offen lds
    v_mfma_f32_32x32x16_bf16 v[80:95], a[124:127], v[132:135], v[80:95]
    s_waitcnt vmcnt(13)
    v_mfma_f32_32x32x16_bf16 v[64:79], a[128:131], v[136:139], v[64:79]
    s_add_u32 m0, s44, 81920
    s_add_u32 s63, s56, 2621440
    buffer_load_dwordx4 v9, s[20:23], s63 offen lds
    v_mfma_f32_32x32x16_bf16 v[80:95], a[132:135], v[136:139], v[80:95]
    s_waitcnt vmcnt(13)
    v_mfma_f32_32x32x16_bf16 v[64:79], a[136:139], v[140:143], v[64:79]
    s_add_u32 m0, s44, 86016
    s_add_u32 s63, s56, 6291456
    buffer_load_dwordx4 v9, s[20:23], s63 offen lds
    v_mfma_f32_32x32x16_bf16 v[80:95], a[140:143], v[140:143], v[80:95]
    s_waitcnt vmcnt(13)
    v_mfma_f32_32x32x16_bf16 v[64:79], a[144:147], v[144:147], v[64:79]
    s_add_u32 m0, s44, 90112
    s_add_u32 s63, s56, 2752512
    buffer_load_dwordx4 v9, s[20:23], s63 offen lds
    v_mfma_f32_32x32x16_bf16 v[80:95], a[148:151], v[144:147], v[80:95]
    s_waitcnt vmcnt(13)
    v_mfma_f32_32x32x16_bf16 v[64:79], a[152:155], v[148:151], v[64:79]
    s_add_u32 m0, s44, 94208
    s_add_u32 s63, s56, 6422528
    buffer_load_dwordx4 v9, s[20:23], s63 offen lds
    v_mfma_f32_32x32x16_bf16 v[80:95], a[156:159], v[148:151], v[80:95]
    s_waitcnt vmcnt(13)
    v_mfma_f32_32x32x16_bf16 v[64:79], a[160:163], v[152:155], v[64:79]
    s_add_u32 m0, s44, 98304
    s_add_u32 s63, s56, 2883584
    buffer_load_dwordx4 v9, s[20:23], s63 offen lds
    v_mfma_f32_32x32x16_bf16 v[80:95], a[164:167], v[152:155], v[80:95]
    s_waitcnt vmcnt(13)
    v_mfma_f32_32x32x16_bf16 v[64:79], a[168:171], v[156:159], v[64:79]
    s_add_u32 m0, s44, 102400
    s_add_u32 s63, s56, 6553600
    buffer_load_dwordx4 v9, s[20:23], s63 offen lds
    v_mfma_f32_32x32x16_bf16 v[80:95], a[172:175], v[156:159], v[80:95]
    s_waitcnt vmcnt(13)
    v_mfma_f32_32x32x16_bf16 v[64:79], a[176:179], v[160:163], v[64:79]
    s_add_u32 m0, s44, 106496
    s_add_u32 s63, s56, 3014656
    buffer_load_dwordx4 v9, s[20:23], s63 offen lds
    v_mfma_f32_32x32x16_bf16 v[80:95], a[180:183], v[160:163], v[80:95]
    s_waitcnt vmcnt(13)
    v_mfma_f32_32x32x16_bf16 v[64:79], a[184:187], v[164:167], v[64:79]
    s_add_u32 m0, s44, 110592
    s_add_u32 s63, s56, 6684672
    buffer_load_dwordx4 v9, s[20:23], s63 offen lds
    v_mfma_f32_32x32x16_bf16 v[80:95], a[188:191], v[164:167], v[80:95]
    s_waitcnt vmcnt(13)
    v_mfma_f32_32x32x16_bf16 v[80:95], a[196:199], v[168:171], v[80:95]
    s_waitcnt vmcnt(12)
    v_mfma_f32_32x32x16_bf16 v[80:95], a[204:207], v[172:175], v[80:95]
    v_mfma_f32_32x32x16_bf16 v[64:79], a[192:195], v[168:171], v[64:79]
    s_add_u32 m0, s44, 114688
    s_add_u32 s63, s56, 3145728
    buffer_load_dwordx4 v9, s[20:23], s63 offen lds
    v_mfma_f32_32x32x16_bf16 v[64:79], a[200:203], v[172:175], v[64:79]
    s_add_u32 m0, s44, 118784
    s_add_u32 s63, s56, 6815744
    buffer_load_dwordx4 v9, s[20:23], s63 offen lds
    s_nop 3
    ds_write_b128 v22, v[80:83] offset:0
    ds_write_b128 v22, v[84:87] offset:1024
    ds_write_b128 v22, v[88:91] offset:2048
    ds_write_b128 v22, v[92:95] offset:3072
    s_waitcnt lgkmcnt(0)
    s_barrier
    ds_read_b128 v[96:99], v23 offset:0
    ds_read_b128 v[100:103], v23 offset:1024
    ds_read_b128 v[104:107], v23 offset:2048
    ds_read_b128 v[108:111], v23 offset:3072
    s_add_u32 m0, s44, 122880
    s_add_u32 s63, s56, 3276800
    buffer_load_dwordx4 v9, s[20:23], s63 offen lds
    s_add_u32 m0, s44, 126976
    s_add_u32 s63, s56, 6946816
    buffer_load_dwordx4 v9, s[20:23], s63 offen lds
    s_waitcnt lgkmcnt(3)
    v_pk_add_f32 v[64:65], v[64:65], v[96:97]
    v_pk_add_f32 v[66:67], v[66:67], v[98:99]
    s_waitcnt lgkmcnt(2)
    v_pk_add_f32 v[68:69], v[68:69], v[100:101]
    v_pk_add_f32 v[70:71], v[70:71], v[102:103]
    v_pk_mul_f32 v[80:81], v[64:65], v[64:65]
    v_pk_mul_f32 v[82:83], v[66:67], v[66:67]
    v_pk_mul_f32 v[84:85], v[68:69], v[68:69]
    s_add_u32 m0, s44, 131072
    s_add_u32 s63, s56, 3407872
    buffer_load_dwordx4 v9, s[20:23], s63 offen lds
    v_pk_mul_f32 v[86:87], v[70:71], v[70:71]
    v_pk_fma_f32 v[80:81], v[80:81], v[48:49], v[50:51] op_sel_hi:[1,0,0]
    v_pk_fma_f32 v[82:83], v[82:83], v[48:49], v[50:51] op_sel_hi:[1,0,0]
    v_pk_fma_f32 v[84:85], v[84:85], v[48:49], v[50:51] op_sel_hi:[1,0,0]
    v_pk_fma_f32 v[86:87], v[86:87], v[48:49], v[50:51] op_sel_hi:[1,0,0]
    v_pk_mul_f32 v[80:81], v[80:81], v[64:65]
    v_pk_mul_f32 v[82:83], v[82:83], v[66:67]
    v_pk_mul_f32 v[84:85], v[84:85], v[68:69]
    s_add_u32 m0, s44, 135168
    s_add_u32 s63, s56, 7077888
    buffer_load_dwordx4 v9, s[20:23], s63 offen lds
    v_pk_mul_f32 v[86:87], v[86:87], v[70:71]
    v_exp_f32 v80, v80
    v_exp_f32 v81, v81
    v_exp_f32 v82, v82
    v_exp_f32 v83, v83
    v_exp_f32 v84, v84
    v_exp_f32 v85, v85
    v_exp_f32 v86, v86
    s_add_u32 m0, s44, 139264
    s_add_u32 s63, s56, 3538944
    buffer_load_dwordx4 v9, s[20:23], s63 offen lds
    v_exp_f32 v87, v87
    v_pk_add_f32 v[80:81], v[80:81], 1.0 op_sel_hi:[1,0]
    v_pk_add_f32 v[82:83], v[82:83], 1.0 op_sel_hi:[1,0]
    v_pk_add_f32 v[84:85], v[84:85], 1.0 op_sel_hi:[1,0]
    v_pk_add_f32 v[86:87], v[86:87], 1.0 op_sel_hi:[1,0]
    v_rcp_f32 v80, v80
    v_rcp_f32 v81, v81
    v_rcp_f32 v82, v82
    s_add_u32 m0, s44, 143360
    s_add_u32 s63, s56, 7208960
    buffer_load_dwordx4 v9, s[20:23], s63 offen lds
    v_rcp_f32 v83, v83
    v_rcp_f32 v84, v84
    v_rcp_f32 v85, v85
    v_rcp_f32 v86, v86
    v_rcp_f32 v87, v87
    v_pk_mul_f32 v[64:65], v[64:65], v[80:81]
    v_pk_mul_f32 v[66:67], v[66:67], v[82:83]
    v_pk_mul_f32 v[68:69], v[68:69], v[84:85]
    s_add_u32 m0, s44, 0
    s_add_u32 s63, s56, 0
    buffer_load_dwordx4 v9, s[20:23], s63 offen lds
    v_pk_mul_f32 v[70:71], v[70:71], v[86:87]
    v_cvt_pk_bf16_f32 v116, v64, v65
    v_cvt_pk_bf16_f32 v117, v66, v67
    v_cvt_pk_bf16_f32 v118, v68, v69
    v_cvt_pk_bf16_f32 v119, v70, v71
    buffer_store_dwordx4 v[116:119], v4, s[36:39], s60 offen offset:0 sc1
    s_waitcnt lgkmcnt(1)
    v_pk_add_f32 v[72:73], v[72:73], v[104:105]
    v_pk_add_f32 v[74:75], v[74:75], v[106:107]
    s_waitcnt lgkmcnt(0)
    v_pk_add_f32 v[76:77], v[76:77], v[108:109]
    s_add_u32 m0, s44, 4096
    s_add_u32 s63, s56, 3670016
    buffer_load_dwordx4 v9, s[20:23], s63 offen lds
    v_pk_add_f32 v[78:79], v[78:79], v[110:111]
    v_pk_mul_f32 v[88:89], v[72:73], v[72:73]
    v_pk_mul_f32 v[90:91], v[74:75], v[74:75]
    v_pk_mul_f32 v[92:93], v[76:77], v[76:77]
    v_pk_mul_f32 v[94:95], v[78:79], v[78:79]
    v_pk_fma_f32 v[88:89], v[88:89], v[48:49], v[50:51] op_sel_hi:[1,0,0]
    v_pk_fma_f32 v[90:91], v[90:91], v[48:49], v[50:51] op_sel_hi:[1,0,0]
    v_pk_fma_f32 v[92:93], v[92:93], v[48:49], v[50:51] op_sel_hi:[1,0,0]
    s_add_u32 m0, s44, 8192
    s_add_u32 s63, s56, 131072
    buffer_load_dwordx4 v9, s[20:23], s63 offen lds
    v_pk_fma_f32 v[94:95], v[94:95], v[48:49], v[50:51] op_sel_hi:[1,0,0]
    v_pk_mul_f32 v[88:89], v[88:89], v[72:73]
    v_pk_mul_f32 v[90:91], v[90:91], v[74:75]
    v_pk_mul_f32 v[92:93], v[92:93], v[76:77]
    v_pk_mul_f32 v[94:95], v[94:95], v[78:79]
    v_exp_f32 v88, v88
    v_exp_f32 v89, v89
    v_exp_f32 v90, v90
    s_add_u32 m0, s44, 12288
    s_add_u32 s63, s56, 3801088
    buffer_load_dwordx4 v9, s[20:23], s63 offen lds
    v_exp_f32 v91, v91
    v_exp_f32 v92, v92
    v_exp_f32 v93, v93
    v_exp_f32 v94, v94
    v_exp_f32 v95, v95
    v_pk_add_f32 v[88:89], v[88:89], 1.0 op_sel_hi:[1,0]
    v_pk_add_f32 v[90:91], v[90:91], 1.0 op_sel_hi:[1,0]
    v_pk_add_f32 v[92:93], v[92:93], 1.0 op_sel_hi:[1,0]
    s_add_u32 m0, s44, 16384
    s_add_u32 s63, s56, 262144
    buffer_load_dwordx4 v9, s[20:23], s63 offen lds
    v_pk_add_f32 v[94:95], v[94:95], 1.0 op_sel_hi:[1,0]
    v_rcp_f32 v88, v88
    v_rcp_f32 v89, v89
    v_rcp_f32 v90, v90
    v_rcp_f32 v91, v91
    v_rcp_f32 v92, v92
    v_rcp_f32 v93, v93
    v_rcp_f32 v94, v94
    s_add_u32 m0, s44, 20480
    s_add_u32 s63, s56, 3932160
    buffer_load_dwordx4 v9, s[20:23], s63 offen lds
    v_rcp_f32 v95, v95
    v_pk_mul_f32 v[72:73], v[72:73], v[88:89]
    v_pk_mul_f32 v[74:75], v[74:75], v[90:91]
    v_pk_mul_f32 v[76:77], v[76:77], v[92:93]
    v_pk_mul_f32 v[78:79], v[78:79], v[94:95]
    v_cvt_pk_bf16_f32 v120, v72, v73
    v_cvt_pk_bf16_f32 v121, v74, v75
    v_cvt_pk_bf16_f32 v122, v76, v77
    s_add_u32 m0, s44, 24576
    s_add_u32 s63, s56, 393216
    buffer_load_dwordx4 v9, s[20:23], s63 offen lds
    v_cvt_pk_bf16_f32 v123, v78, v79
    buffer_store_dwordx4 v[120:123], v4, s[36:39], s60 offen offset:1024 sc1
    s_waitcnt vmcnt(9)
    s_barrier
    s_add_u32 m0, s44, 28672
    s_add_u32 s63, s56, 4063232
    buffer_load_dwordx4 v9, s[20:23], s63 offen lds
    ds_read_b64_tr_b16 a[0:1], v58 offset:16384
    ds_read_b64_tr_b16 a[2:3], v58 offset:17408
    ds_read_b64_tr_b16 a[4:5], v59 offset:16384
    ds_read_b64_tr_b16 a[6:7], v59 offset:17408
    ds_read_b64_tr_b16 a[8:9], v58 offset:18432
    ds_read_b64_tr_b16 a[10:11], v58 offset:19456
    s_add_u32 m0, s44, 32768
    s_add_u32 s63, s56, 524288
    buffer_load_dwordx4 v9, s[20:23], s63 offen lds
    ds_read_b64_tr_b16 a[12:13], v59 offset:18432
    ds_read_b64_tr_b16 a[14:15], v59 offset:19456
    ds_read_b64_tr_b16 a[16:17], v58 offset:24576
    ds_read_b64_tr_b16 a[18:19], v58 offset:25600
    ds_read_b64_tr_b16 a[20:21], v59 offset:24576
    ds_read_b64_tr_b16 a[22:23], v59 offset:25600
    s_add_u32 m0, s44, 36864
    s_add_u32 s63, s56, 4194304
    buffer_load_dwordx4 v9, s[20:23], s63 offen lds
    ds_read_b64_tr_b16 a[24:25], v58 offset:26624
    ds_read_b64_tr_b16 a[26:27], v58 offset:27648
    ds_read_b64_tr_b16 a[28:29], v59 offset:26624
    ds_read_b64_tr_b16 a[30:31], v59 offset:27648
    ds_read_b64_tr_b16 a[32:33], v58 offset:32768
    ds_read_b64_tr_b16 a[34:35], v58 offset:33792
    s_add_u32 m0, s44, 40960
    s_add_u32 s63, s56, 655360
    buffer_load_dwordx4 v9, s[20:23], s63 offen lds
    ds_read_b64_tr_b16 a[36:37], v59 offset:32768
    ds_read_b64_tr_b16 a[38:39], v59 offset:33792
    ds_read_b64_tr_b16 a[40:41], v58 offset:34816
    ds_read_b64_tr_b16 a[42:43], v58 offset:35840
    ds_read_b64_tr_b16 a[44:45], v59 offset:34816
    ds_read_b64_tr_b16 a[46:47], v59 offset:35840
    s_add_u32 m0, s44, 45056
    s_add_u32 s63, s56, 4325376
    buffer_load_dwordx4 v9, s[20:23], s63 offen lds
    ds_read_b64_tr_b16 a[48:49], v58 offset:40960
    ds_read_b64_tr_b16 a[50:51], v58 offset:41984
    ds_read_b64_tr_b16 a[52:53], v59 offset:40960
    ds_read_b64_tr_b16 a[54:55], v59 offset:41984
    ds_read_b64_tr_b16 a[56:57], v58 offset:43008
    ds_read_b64_tr_b16 a[58:59], v58 offset:44032
    s_add_u32 m0, s44, 49152
    s_add_u32 s63, s56, 786432
    buffer_load_dwordx4 v9, s[20:23], s63 offen lds
    ds_read_b64_tr_b16 a[60:61], v59 offset:43008
    ds_read_b64_tr_b16 a[62:63], v59 offset:44032
    ds_read_b64_tr_b16 a[64:65], v60 offset:0
    ds_read_b64_tr_b16 a[66:67], v60 offset:1024
    ds_read_b64_tr_b16 a[68:69], v61 offset:0
    ds_read_b64_tr_b16 a[70:71], v61 offset:1024
    s_add_u32 m0, s44, 53248
    s_add_u32 s63, s56, 4456448
    buffer_load_dwordx4 v9, s[20:23], s63 offen lds
    ds_read_b64_tr_b16 a[72:73], v60 offset:2048
    ds_read_b64_tr_b16 a[74:75], v60 offset:3072
    ds_read_b64_tr_b16 a[76:77], v61 offset:2048
    ds_read_b64_tr_b16 a[78:79], v61 offset:3072
    ds_read_b64_tr_b16 a[80:81], v60 offset:8192
    ds_read_b64_tr_b16 a[82:83], v60 offset:9216
    s_add_u32 m0, s44, 57344
    s_add_u32 s63, s56, 917504
    buffer_load_dwordx4 v9, s[20:23], s63 offen lds
    ds_read_b64_tr_b16 a[84:85], v61 offset:8192
    ds_read_b64_tr_b16 a[86:87], v61 offset:9216
    ds_read_b64_tr_b16 a[88:89], v60 offset:10240
    ds_read_b64_tr_b16 a[90:91], v60 offset:11264
    ds_read_b64_tr_b16 a[92:93], v61 offset:10240
    ds_read_b64_tr_b16 a[94:95], v61 offset:11264
    s_add_u32 m0, s44, 61440
    s_add_u32 s63, s56, 4587520
    buffer_load_dwordx4 v9, s[20:23], s63 offen lds
    ds_read_b64_tr_b16 a[96:97], v60 offset:16384
    ds_read_b64_tr_b16 a[98:99], v60 offset:17408
    ds_read_b64_tr_b16 a[100:101], v61 offset:16384
    ds_read_b64_tr_b16 a[102:103], v61 offset:17408
    ds_read_b64_tr_b16 a[104:105], v60 offset:18432
    ds_read_b64_tr_b16 a[106:107], v60 offset:19456
    ds_read_b64_tr_b16 a[108:109], v61 offset:18432
    ds_read_b64_tr_b16 a[110:111], v61 offset:19456
    ds_read_b64_tr_b16 a[112:113], v60 offset:24576
    ds_read_b64_tr_b16 a[114:115], v60 offset:25600
    ds_read_b64_tr_b16 a[116:117], v61 offset:24576
    ds_read_b64_tr_b16 a[118:119], v61 offset:25600
    ds_read_b64_tr_b16 a[120:121], v60 offset:26624
    ds_read_b64_tr_b16 a[122:123], v60 offset:27648
    ds_read_b64_tr_b16 a[124:125], v61 offset:26624
    ds_read_b64_tr_b16 a[126:127], v61 offset:27648
    ds_read_b64_tr_b16 a[128:129], v60 offset:32768
    ds_read_b64_tr_b16 a[130:131], v60 offset:33792
    ds_read_b64_tr_b16 a[132:133], v61 offset:32768
    ds_read_b64_tr_b16 a[134:135], v61 offset:33792
    ds_read_b64_tr_b16 a[136:137], v60 offset:34816
    ds_read_b64_tr_b16 a[138:139], v60 offset:35840
    ds_read_b64_tr_b16 a[140:141], v61 offset:34816
    ds_read_b64_tr_b16 a[142:143], v61 offset:35840
    ds_read_b64_tr_b16 a[144:145], v60 offset:40960
    ds_read_b64_tr_b16 a[146:147], v60 offset:41984
    ds_read_b64_tr_b16 a[148:149], v61 offset:40960
    ds_read_b64_tr_b16 a[150:151], v61 offset:41984
    ds_read_b64_tr_b16 a[152:153], v60 offset:43008
    ds_read_b64_tr_b16 a[154:155], v60 offset:44032
    ds_read_b64_tr_b16 a[156:157], v61 offset:43008
    ds_read_b64_tr_b16 a[158:159], v61 offset:44032
    s_waitcnt vmcnt(9)
    s_waitcnt lgkmcnt(0)
    s_barrier
    s_cmp_lg_u32 s41, 0
    s_cbranch_scc1 pub_45
    s_lshl_b32 s60, s49, 5
    s_add_u32 s60, s60, s50
    s_mul_i32 s60, s60, 128
    s_add_u32 s60, s60, 131076
    v_lshlrev_b32 v62, 2, v1
    s_mov_b32 exec_hi, 0
    s_mov_b32 exec_lo, 0x00000001
    buffer_store_dword v26, v62, s[36:39], s60 offen sc1
    s_mov_b64 exec, -1
pub_45:
    s_branch p3end_43
p3skip_42:
    v_lshlrev_b32 v22, 12, v1
    s_and_b32 s60, s43, 3
    s_lshl_b32 s61, s42, 2
    s_add_u32 s60, s60, s61
    s_lshl_b32 s60, s60, 7
    s_mul_i32 s61, s51, 3670016
    s_add_u32 s60, s60, s61
    s_lshl_b32 s61, s52, 18
    s_add_u32 s60, s60, s61
    s_add_u32 s61, s60, 2097152
    buffer_load_dword v68, v22, s[20:23], s61 offen
    s_add_u32 s61, s60, 2621440
    buffer_load_dword v69, v22, s[20:23], s61 offen
    s_add_u32 s61, s60, 3145728
    buffer_load_dword v70, v22, s[20:23], s61 offen
    s_add_u32 m0, s44, 65536
    s_add_u32 s63, s56, 2359296
    buffer_load_dwordx4 v9, s[20:23], s63 offen lds
    s_add_u32 m0, s44, 69632
    s_add_u32 s63, s56, 6029312
    buffer_load_dwordx4 v9, s[20:23], s63 offen lds
    s_add_u32 m0, s44, 73728
    s_add_u32 s63, s56, 2490368
    buffer_load_dwordx4 v9, s[20:23], s63 offen lds
    s_add_u32 m0, s44, 77824
    s_add_u32 s63, s56, 6160384
    buffer_load_dwordx4 v9, s[20:23], s63 offen lds
    s_add_u32 m0, s44, 81920
    s_add_u32 s63, s56, 2621440
    buffer_load_dwordx4 v9, s[20:23], s63 offen lds
    s_add_u32 m0, s44, 86016
    s_add_u32 s63, s56, 6291456
    buffer_load_dwordx4 v9, s[20:23], s63 offen lds
    s_add_u32 m0, s44, 90112
    s_add_u32 s63, s56, 2752512
    buffer_load_dwordx4 v9, s[20:23], s63 offen lds
    s_add_u32 m0, s44, 94208
    s_add_u32 s63, s56, 6422528
    buffer_load_dwordx4 v9, s[20:23], s63 offen lds
    s_add_u32 m0, s44, 98304
    s_add_u32 s63, s56, 2883584
    buffer_load_dwordx4 v9, s[20:23], s63 offen lds
    s_add_u32 m0, s44, 102400
    s_add_u32 s63, s56, 6553600
    buffer_load_dwordx4 v9, s[20:23], s63 offen lds
    s_add_u32 m0, s44, 106496
    s_add_u32 s63, s56, 3014656
    buffer_load_dwordx4 v9, s[20:23], s63 offen lds
    s_add_u32 m0, s44, 110592
    s_add_u32 s63, s56, 6684672
    buffer_load_dwordx4 v9, s[20:23], s63 offen lds
    s_add_u32 m0, s44, 114688
    s_add_u32 s63, s56, 3145728
    buffer_load_dwordx4 v9, s[20:23], s63 offen lds
    s_add_u32 m0, s44, 118784
    s_add_u32 s63, s56, 6815744
    buffer_load_dwordx4 v9, s[20:23], s63 offen lds
    s_add_u32 m0, s44, 122880
    s_add_u32 s63, s56, 3276800
    buffer_load_dwordx4 v9, s[20:23], s63 offen lds
    s_add_u32 m0, s44, 126976
    s_add_u32 s63, s56, 6946816
    buffer_load_dwordx4 v9, s[20:23], s63 offen lds
    s_add_u32 m0, s44, 131072
    s_add_u32 s63, s56, 3407872
    buffer_load_dwordx4 v9, s[20:23], s63 offen lds
    s_add_u32 m0, s44, 135168
    s_add_u32 s63, s56, 7077888
    buffer_load_dwordx4 v9, s[20:23], s63 offen lds
    s_add_u32 m0, s44, 139264
    s_add_u32 s63, s56, 3538944
    buffer_load_dwordx4 v9, s[20:23], s63 offen lds
    s_add_u32 m0, s44, 143360
    s_add_u32 s63, s56, 7208960
    buffer_load_dwordx4 v9, s[20:23], s63 offen lds
    s_add_u32 s61, s60, 0
    buffer_load_dword v64, v22, s[20:23], s61 offen
    s_add_u32 s61, s60, 524288
    buffer_load_dword v65, v22, s[20:23], s61 offen
    s_waitcnt vmcnt(2)
    s_barrier
    ds_read_b64_tr_b16 a[0:1], v58 offset:16384
    ds_read_b64_tr_b16 a[2:3], v58 offset:17408
    ds_read_b64_tr_b16 a[4:5], v59 offset:16384
    ds_read_b64_tr_b16 a[6:7], v59 offset:17408
    ds_read_b64_tr_b16 a[8:9], v58 offset:18432
    ds_read_b64_tr_b16 a[10:11], v58 offset:19456
    ds_read_b64_tr_b16 a[12:13], v59 offset:18432
    ds_read_b64_tr_b16 a[14:15], v59 offset:19456
    ds_read_b64_tr_b16 a[16:17], v58 offset:24576
    ds_read_b64_tr_b16 a[18:19], v58 offset:25600
    ds_read_b64_tr_b16 a[20:21], v59 offset:24576
    ds_read_b64_tr_b16 a[22:23], v59 offset:25600
    ds_read_b64_tr_b16 a[24:25], v58 offset:26624
    ds_read_b64_tr_b16 a[26:27], v58 offset:27648
    ds_read_b64_tr_b16 a[28:29], v59 offset:26624
    ds_read_b64_tr_b16 a[30:31], v59 offset:27648
    ds_read_b64_tr_b16 a[32:33], v58 offset:32768
    ds_read_b64_tr_b16 a[34:35], v58 offset:33792
    ds_read_b64_tr_b16 a[36:37], v59 offset:32768
    ds_read_b64_tr_b16 a[38:39], v59 offset:33792
    ds_read_b64_tr_b16 a[40:41], v58 offset:34816
    ds_read_b64_tr_b16 a[42:43], v58 offset:35840
    ds_read_b64_tr_b16 a[44:45], v59 offset:34816
    ds_read_b64_tr_b16 a[46:47], v59 offset:35840
    ds_read_b64_tr_b16 a[48:49], v58 offset:40960
    ds_read_b64_tr_b16 a[50:51], v58 offset:41984
    ds_read_b64_tr_b16 a[52:53], v59 offset:40960
    ds_read_b64_tr_b16 a[54:55], v59 offset:41984
    ds_read_b64_tr_b16 a[56:57], v58 offset:43008
    ds_read_b64_tr_b16 a[58:59], v58 offset:44032
    ds_read_b64_tr_b16 a[60:61], v59 offset:43008
    ds_read_b64_tr_b16 a[62:63], v59 offset:44032
    ds_read_b64_tr_b16 a[64:65], v60 offset:0
    ds_read_b64_tr_b16 a[66:67], v60 offset:1024
    ds_read_b64_tr_b16 a[68:69], v61 offset:0
    ds_read_b64_tr_b16 a[70:71], v61 offset:1024
    ds_read_b64_tr_b16 a[72:73], v60 offset:2048
    ds_read_b64_tr_b16 a[74:75], v60 offset:3072
    ds_read_b64_tr_b16 a[76:77], v61 offset:2048
    ds_read_b64_tr_b16 a[78:79], v61 offset:3072
    ds_read_b64_tr_b16 a[80:81], v60 offset:8192
    ds_read_b64_tr_b16 a[82:83], v60 offset:9216
    ds_read_b64_tr_b16 a[84:85], v61 offset:8192
    ds_read_b64_tr_b16 a[86:87], v61 offset:9216
    ds_read_b64_tr_b16 a[88:89], v60 offset:10240
    ds_read_b64_tr_b16 a[90:91], v60 offset:11264
    ds_read_b64_tr_b16 a[92:93], v61 offset:10240
    ds_read_b64_tr_b16 a[94:95], v61 offset:11264
    ds_read_b64_tr_b16 a[96:97], v60 offset:16384
    ds_read_b64_tr_b16 a[98:99], v60 offset:17408
    ds_read_b64_tr_b16 a[100:101], v61 offset:16384
    ds_read_b64_tr_b16 a[102:103], v61 offset:17408
    ds_read_b64_tr_b16 a[104:105], v60 offset:18432
    ds_read_b64_tr_b16 a[106:107], v60 offset:19456
    ds_read_b64_tr_b16 a[108:109], v61 offset:18432
    ds_read_b64_tr_b16 a[110:111], v61 offset:19456
    ds_read_b64_tr_b16 a[112:113], v60 offset:24576
    ds_read_b64_tr_b16 a[114:115], v60 offset:25600
    ds_read_b64_tr_b16 a[116:117], v61 offset:24576
    ds_read_b64_tr_b16 a[118:119], v61 offset:25600
    ds_read_b64_tr_b16 a[120:121], v60 offset:26624
    ds_read_b64_tr_b16 a[122:123], v60 offset:27648
    ds_read_b64_tr_b16 a[124:125], v61 offset:26624
    ds_read_b64_tr_b16 a[126:127], v61 offset:27648
    ds_read_b64_tr_b16 a[128:129], v60 offset:32768
    ds_read_b64_tr_b16 a[130:131], v60 offset:33792
    ds_read_b64_tr_b16 a[132:133], v61 offset:32768
    ds_read_b64_tr_b16 a[134:135], v61 offset:33792
    ds_read_b64_tr_b16 a[136:137], v60 offset:34816
    ds_read_b64_tr_b16 a[138:139], v60 offset:35840
    ds_read_b64_tr_b16 a[140:141], v61 offset:34816
    ds_read_b64_tr_b16 a[142:143], v61 offset:35840
    ds_read_b64_tr_b16 a[144:145], v60 offset:40960
    ds_read_b64_tr_b16 a[146:147], v60 offset:41984
    ds_read_b64_tr_b16 a[148:149], v61 offset:40960
    ds_read_b64_tr_b16 a[150:151], v61 offset:41984
    ds_read_b64_tr_b16 a[152:153], v60 offset:43008
    ds_read_b64_tr_b16 a[154:155], v60 offset:44032
    ds_read_b64_tr_b16 a[156:157], v61 offset:43008
    ds_read_b64_tr_b16 a[158:159], v61 offset:44032
    s_add_u32 s61, s60, 1048576
    buffer_load_dword v66, v22, s[20:23], s61 offen
    s_add_u32 s61, s60, 1572864
    buffer_load_dword v67, v22, s[20:23], s61 offen
    s_add_u32 m0, s44, 0
    s_add_u32 s63, s56, 0
    buffer_load_dwordx4 v9, s[20:23], s63 offen lds
    s_add_u32 m0, s44, 4096
    s_add_u32 s63, s56, 3670016
    buffer_load_dwordx4 v9, s[20:23], s63 offen lds
    s_add_u32 m0, s44, 8192
    s_add_u32 s63, s56, 131072
    buffer_load_dwordx4 v9, s[20:23], s63 offen lds
    s_add_u32 m0, s44, 12288
    s_add_u32 s63, s56, 3801088
    buffer_load_dwordx4 v9, s[20:23], s63 offen lds
    s_add_u32 m0, s44, 16384
    s_add_u32 s63, s56, 262144
    buffer_load_dwordx4 v9, s[20:23], s63 offen lds
    s_add_u32 m0, s44, 20480
    s_add_u32 s63, s56, 3932160
    buffer_load_dwordx4 v9, s[20:23], s63 offen lds
    s_add_u32 m0, s44, 24576
    s_add_u32 s63, s56, 393216
    buffer_load_dwordx4 v9, s[20:23], s63 offen lds
    s_add_u32 m0, s44, 28672
    s_add_u32 s63, s56, 4063232
    buffer_load_dwordx4 v9, s[20:23], s63 offen lds
    s_add_u32 m0, s44, 32768
    s_add_u32 s63, s56, 524288
    buffer_load_dwordx4 v9, s[20:23], s63 offen lds
    s_add_u32 m0, s44, 36864
    s_add_u32 s63, s56, 4194304
    buffer_load_dwordx4 v9, s[20:23], s63 offen lds
    s_add_u32 m0, s44, 40960
    s_add_u32 s63, s56, 655360
    buffer_load_dwordx4 v9, s[20:23], s63 offen lds
    s_add_u32 m0, s44, 45056
    s_add_u32 s63, s56, 4325376
    buffer_load_dwordx4 v9, s[20:23], s63 offen lds
    s_add_u32 m0, s44, 49152
    s_add_u32 s63, s56, 786432
    buffer_load_dwordx4 v9, s[20:23], s63 offen lds
    s_add_u32 m0, s44, 53248
    s_add_u32 s63, s56, 4456448
    buffer_load_dwordx4 v9, s[20:23], s63 offen lds
    s_add_u32 m0, s44, 57344
    s_add_u32 s63, s56, 917504
    buffer_load_dwordx4 v9, s[20:23], s63 offen lds
    s_add_u32 m0, s44, 61440
    s_add_u32 s63, s56, 4587520
    buffer_load_dwordx4 v9, s[20:23], s63 offen lds
    s_waitcnt lgkmcnt(0)
    s_barrier
p3end_43:
    s_lshl_b32 s60, s51, 6
    s_add_u32 s60, s60, s56
    v_and_b32 v22, 31, v1
    v_lshlrev_b32 v22, 1, v22
    buffer_load_ushort v48, v22, s[28:31], s60 offen
    s_lshl_b32 s72, s48, 1
    s_add_u32 s72, s72, s52
    s_lshl_b32 s72, s72, 1
    s_add_u32 s72, s72, s51
    s_mul_i32 s72, s72, 57344
    s_add_u32 s72, s72, 12582912
    s_add_u32 m0, s44, 65536
    s_add_u32 s63, s56, 1048576
    buffer_load_dwordx4 v9, s[20:23], s63 offen lds
    s_add_u32 m0, s44, 69632
    s_add_u32 s63, s56, 4718592
    buffer_load_dwordx4 v9, s[20:23], s63 offen lds
    s_add_u32 m0, s44, 73728
    s_add_u32 s63, s56, 1179648
    buffer_load_dwordx4 v9, s[20:23], s63 offen lds
    s_add_u32 m0, s44, 77824
    s_add_u32 s63, s56, 4849664
    buffer_load_dwordx4 v9, s[20:23], s63 offen lds
    s_add_u32 m0, s44, 81920
    s_add_u32 s63, s56, 1310720
    buffer_load_dwordx4 v9, s[20:23], s63 offen lds
    s_add_u32 m0, s44, 86016
    s_add_u32 s63, s56, 4980736
    buffer_load_dwordx4 v9, s[20:23], s63 offen lds
    s_add_u32 m0, s44, 90112
    s_add_u32 s63, s56, 1441792
    buffer_load_dwordx4 v9, s[20:23], s63 offen lds
    s_add_u32 m0, s44, 94208
    s_add_u32 s63, s56, 5111808
    buffer_load_dwordx4 v9, s[20:23], s63 offen lds
    s_add_u32 m0, s44, 98304
    s_add_u32 s63, s56, 1572864
    buffer_load_dwordx4 v9, s[20:23], s63 offen lds
    s_add_u32 m0, s44, 102400
    s_add_u32 s63, s56, 5242880
    buffer_load_dwordx4 v9, s[20:23], s63 offen lds
    s_lshl_b32 s74, s48, 5
    s_mul_i32 s3, s51, 14
    s_add_u32 s74, s74, s3
    s_mul_i32 s74, s74, 128
    s_add_u32 s74, s74, 131076
    v_min_u32 v23, 13, v3
    v_mul_u32_u24 v62, 128, v23
    buffer_load_dword v63, v62, s[36:39], s74 offen sc1
    s_add_u32 m0, s44, 106496
    s_add_u32 s63, s56, 1703936
    buffer_load_dwordx4 v9, s[20:23], s63 offen lds
    s_add_u32 m0, s44, 110592
    s_add_u32 s63, s56, 5373952
    buffer_load_dwordx4 v9, s[20:23], s63 offen lds
    s_add_u32 m0, s44, 114688
    s_add_u32 s63, s56, 1835008
    buffer_load_dwordx4 v9, s[20:23], s63 offen lds
    s_add_u32 m0, s44, 118784
    s_add_u32 s63, s56, 5505024
    buffer_load_dwordx4 v9, s[20:23], s63 offen lds
    s_add_u32 m0, s44, 122880
    s_add_u32 s63, s56, 1966080
    buffer_load_dwordx4 v9, s[20:23], s63 offen lds
    s_add_u32 m0, s44, 126976
    s_add_u32 s63, s56, 5636096
    buffer_load_dwordx4 v9, s[20:23], s63 offen lds
    s_add_u32 m0, s44, 131072
    s_add_u32 s63, s56, 2097152
    buffer_load_dwordx4 v9, s[20:23], s63 offen lds
    s_add_u32 m0, s44, 135168
    s_add_u32 s63, s56, 5767168
    buffer_load_dwordx4 v9, s[20:23], s63 offen lds
    s_add_u32 m0, s44, 139264
    s_add_u32 s63, s56, 2228224
    buffer_load_dwordx4 v9, s[20:23], s63 offen lds
    s_add_u32 m0, s44, 143360
    s_add_u32 s63, s56, 5898240
    buffer_load_dwordx4 v9, s[20:23], s63 offen lds
    s_waitcnt vmcnt(10)
    s_mov_b32 s70, 30000
chk_46:
    v_cmp_ne_u32 vcc, v63, v26
    s_nop 3
    s_and_b64 vcc, vcc, 0x0000ffff
    s_cbranch_scc0 chk_46_d
    buffer_load_dword v63, v62, s[36:39], s74 offen sc1
    s_waitcnt vmcnt(0)
    s_sub_u32 s70, s70, 1
    s_cmp_lg_u32 s70, 0
    s_cbranch_scc1 chk_46
chk_46_d:
    s_add_u32 s82, s72, 49152
    buffer_load_dwordx4 v[128:131], v4, s[36:39], s82 offen offset:0 sc1
    buffer_load_dwordx4 v[132:135], v4, s[36:39], s82 offen offset:1024 sc1
    buffer_load_dwordx4 v[136:139], v4, s[36:39], s82 offen offset:2048 sc1
    buffer_load_dwordx4 v[140:143], v4, s[36:39], s82 offen offset:3072 sc1
    s_add_u32 s82, s72, 53248
    buffer_load_dwordx4 v[144:147], v4, s[36:39], s82 offen offset:0 sc1
    buffer_load_dwordx4 v[148:151], v4, s[36:39], s82 offen offset:1024 sc1
    buffer_load_dwordx4 v[152:155], v4, s[36:39], s82 offen offset:2048 sc1
    buffer_load_dwordx4 v[156:159], v4, s[36:39], s82 offen offset:3072 sc1
    s_add_u32 s82, s72, 0
    buffer_load_dwordx4 v[160:163], v4, s[36:39], s82 offen offset:0 sc1
    buffer_load_dwordx4 v[164:167], v4, s[36:39], s82 offen offset:1024 sc1
    buffer_load_dwordx4 v[168:171], v4, s[36:39], s82 offen offset:2048 sc1
    buffer_load_dwordx4 v[172:175], v4, s[36:39], s82 offen offset:3072 sc1
    s_add_u32 s82, s72, 4096
    buffer_load_dwordx4 v[176:179], v4, s[36:39], s82 offen offset:0 sc1
    buffer_load_dwordx4 v[180:183], v4, s[36:39], s82 offen offset:1024 sc1
    v_lshlrev_b32 v48, 16, v48
    v_lshlrev_b32 v64, 16, v32
    v_and_b32 v65, 0xffff0000, v32
    v_lshlrev_b32 v66, 16, v33
    v_and_b32 v67, 0xffff0000, v33
    v_lshlrev_b32 v68, 16, v34
    v_and_b32 v69, 0xffff0000, v34
    v_lshlrev_b32 v70, 16, v35
    v_and_b32 v71, 0xffff0000, v35
    v_lshlrev_b32 v72, 16, v36
    v_and_b32 v73, 0xffff0000, v36
    v_lshlrev_b32 v74, 16, v37
    v_and_b32 v75, 0xffff0000, v37
    v_lshlrev_b32 v76, 16, v38
    v_and_b32 v77, 0xffff0000, v38
    v_lshlrev_b32 v78, 16, v39
    v_and_b32 v79, 0xffff0000, v39
    v_pk_add_f32 v[64:65], v[64:65], v[48:49] op_sel_hi:[1,0]
    v_pk_add_f32 v[66:67], v[66:67], v[48:49] op_sel_hi:[1,0]
    v_pk_add_f32 v[68:69], v[68:69], v[48:49] op_sel_hi:[1,0]
    v_pk_add_f32 v[70:71], v[70:71], v[48:49] op_sel_hi:[1,0]
    v_pk_add_f32 v[72:73], v[72:73], v[48:49] op_sel_hi:[1,0]
    v_pk_add_f32 v[74:75], v[74:75], v[48:49] op_sel_hi:[1,0]
    v_pk_add_f32 v[76:77], v[76:77], v[48:49] op_sel_hi:[1,0]
    v_pk_add_f32 v[78:79], v[78:79], v[48:49] op_sel_hi:[1,0]
    s_lshl_b32 s60, s47, 1
    s_add_u32 s60, s60, s51
    v_lshrrev_b32 v25, 5, v1
    s_lshl_b32 s60, s60, 15
    s_add_u32 s60, s60, s54
    s_lshl_b32 s61, s52, 6
    s_add_u32 s60, s60, s61
    v_and_b32 v24, 31, v1
    v_lshlrev_b32 v24, 10, v24
    v_lshl_add_u32 v24, v25, 4, v24
    s_lshl_b32 s62, s41, 12
    s_add_u32 s62, s62, 147456
    v_add_u32 v22, s62, v4
    v_xor_b32 v23, 8192, v22
    s_waitcnt vmcnt(13)
    v_mfma_f32_32x32x16_bf16 v[64:79], v[128:131], a[96:99], v[64:79]
    buffer_load_dwordx4 v[184:187], v4, s[36:39], s82 offen offset:2048 sc1
    v_mfma_f32_32x32x16_bf16 v[80:95], v[128:131], a[100:103], 0
    s_waitcnt vmcnt(13)
    v_mfma_f32_32x32x16_bf16 v[64:79], v[132:135], a[104:107], v[64:79]
    buffer_load_dwordx4 v[188:191], v4, s[36:39], s82 offen offset:3072 sc1
    v_mfma_f32_32x32x16_bf16 v[80:95], v[132:135], a[108:111], v[80:95]
    s_waitcnt vmcnt(13)
    v_mfma_f32_32x32x16_bf16 v[64:79], v[136:139], a[112:115], v[64:79]
    s_add_u32 s82, s72, 8192
    buffer_load_dwordx4 v[192:195], v4, s[36:39], s82 offen offset:0 sc1
    v_mfma_f32_32x32x16_bf16 v[80:95], v[136:139], a[116:119], v[80:95]
    s_waitcnt vmcnt(13)
    v_mfma_f32_32x32x16_bf16 v[64:79], v[140:143], a[120:123], v[64:79]
    buffer_load_dwordx4 v[196:199], v4, s[36:39], s82 offen offset:1024 sc1
    v_mfma_f32_32x32x16_bf16 v[80:95], v[140:143], a[124:127], v[80:95]
    s_waitcnt vmcnt(13)
    v_mfma_f32_32x32x16_bf16 v[64:79], v[144:147], a[128:131], v[64:79]
    buffer_load_dwordx4 v[200:203], v4, s[36:39], s82 offen offset:2048 sc1
    v_mfma_f32_32x32x16_bf16 v[80:95], v[144:147], a[132:135], v[80:95]
    s_waitcnt vmcnt(13)
    v_mfma_f32_32x32x16_bf16 v[64:79], v[148:151], a[136:139], v[64:79]
    s_barrier
    ds_read_b64_tr_b16 v[96:97], v56 offset:0
    ds_read_b64_tr_b16 v[98:99], v56 offset:1024
    buffer_load_dwordx4 v[204:207], v4, s[36:39], s82 offen offset:3072 sc1
    v_mfma_f32_32x32x16_bf16 v[80:95], v[148:151], a[140:143], v[80:95]
    ds_read_b64_tr_b16 v[100:101], v57 offset:0
    ds_read_b64_tr_b16 v[102:103], v57 offset:1024
    s_waitcnt vmcnt(13)
    v_mfma_f32_32x32x16_bf16 v[64:79], v[152:155], a[144:147], v[64:79]
    ds_read_b64_tr_b16 v[104:105], v56 offset:2048
    ds_read_b64_tr_b16 v[106:107], v56 offset:3072
    s_add_u32 s82, s72, 12288
    buffer_load_dwordx4 v[208:211], v4, s[36:39], s82 offen offset:0 sc1
    v_mfma_f32_32x32x16_bf16 v[80:95], v[152:155], a[148:151], v[80:95]
    ds_read_b64_tr_b16 v[108:109], v57 offset:2048
    ds_read_b64_tr_b16 v[110:111], v57 offset:3072
    s_waitcnt vmcnt(13)
    v_mfma_f32_32x32x16_bf16 v[64:79], v[156:159], a[152:155], v[64:79]
    ds_read_b64_tr_b16 v[112:113], v56 offset:8192
    ds_read_b64_tr_b16 v[114:115], v56 offset:9216
    buffer_load_dwordx4 v[212:215], v4, s[36:39], s82 offen offset:1024 sc1
    v_mfma_f32_32x32x16_bf16 v[80:95], v[156:159], a[156:159], v[80:95]
    ds_read_b64_tr_b16 v[116:117], v57 offset:8192
    ds_read_b64_tr_b16 v[118:119], v57 offset:9216
    s_waitcnt vmcnt(13) lgkmcnt(10)
    v_mfma_f32_32x32x16_bf16 v[64:79], v[160:163], v[96:99], v[64:79]
    ds_read_b64_tr_b16 v[120:121], v56 offset:10240
    ds_read_b64_tr_b16 v[122:123], v56 offset:11264
    buffer_load_dwordx4 v[216:219], v4, s[36:39], s82 offen offset:2048 sc1
    s_waitcnt lgkmcnt(10)
    v_mfma_f32_32x32x16_bf16 v[80:95], v[160:163], v[100:103], v[80:95]
    ds_read_b64_tr_b16 v[124:125], v57 offset:10240
    ds_read_b64_tr_b16 v[126:127], v57 offset:11264
    s_waitcnt vmcnt(13) lgkmcnt(10)
    v_mfma_f32_32x32x16_bf16 v[64:79], v[164:167], v[104:107], v[64:79]
    ds_read_b64_tr_b16 v[96:97], v56 offset:16384
    ds_read_b64_tr_b16 v[98:99], v56 offset:17408
    buffer_load_dwordx4 v[220:223], v4, s[36:39], s82 offen offset:3072 sc1
    s_waitcnt lgkmcnt(10)
    v_mfma_f32_32x32x16_bf16 v[80:95], v[164:167], v[108:111], v[80:95]
    ds_read_b64_tr_b16 v[100:101], v57 offset:16384
    ds_read_b64_tr_b16 v[102:103], v57 offset:17408
    s_waitcnt vmcnt(13) lgkmcnt(10)
    v_mfma_f32_32x32x16_bf16 v[64:79], v[168:171], v[112:115], v[64:79]
    ds_read_b64_tr_b16 v[104:105], v56 offset:18432
    ds_read_b64_tr_b16 v[106:107], v56 offset:19456
    s_add_u32 s82, s72, 16384
    buffer_load_dwordx4 v[224:227], v4, s[36:39], s82 offen offset:0 sc1
    s_waitcnt lgkmcnt(10)
    v_mfma_f32_32x32x16_bf16 v[80:95], v[168:171], v[116:119], v[80:95]
    ds_read_b64_tr_b16 v[108:109], v57 offset:18432
    ds_read_b64_tr_b16 v[110:111], v57 offset:19456
    s_waitcnt vmcnt(13) lgkmcnt(10)
    v_mfma_f32_32x32x16_bf16 v[64:79], v[172:175], v[120:123], v[64:79]
    ds_read_b64_tr_b16 v[112:113], v56 offset:24576
    ds_read_b64_tr_b16 v[114:115], v56 offset:25600
    buffer_load_dwordx4 v[228:231], v4, s[36:39], s82 offen offset:1024 sc1
    s_waitcnt lgkmcnt(10)
    v_mfma_f32_32x32x16_bf16 v[80:95], v[172:175], v[124:127], v[80:95]
    ds_read_b64_tr_b16 v[116:117], v57 offset:24576
    ds_read_b64_tr_b16 v[118:119], v57 offset:25600
    s_waitcnt vmcnt(13) lgkmcnt(10)
    v_mfma_f32_32x32x16_bf16 v[64:79], v[176:179], v[96:99], v[64:79]
    ds_read_b64_tr_b16 v[120:121], v56 offset:26624
    ds_read_b64_tr_b16 v[122:123], v56 offset:27648
    buffer_load_dwordx4 v[128:131], v4, s[36:39], s82 offen offset:2048 sc1
    s_waitcnt lgkmcnt(10)
    v_mfma_f32_32x32x16_bf16 v[80:95], v[176:179], v[100:103], v[80:95]
    ds_read_b64_tr_b16 v[124:125], v57 offset:26624
    ds_read_b64_tr_b16 v[126:127], v57 offset:27648
    s_waitcnt vmcnt(13) lgkmcnt(10)
    v_mfma_f32_32x32x16_bf16 v[64:79], v[180:183], v[104:107], v[64:79]
    ds_read_b64_tr_b16 v[96:97], v56 offset:32768
    ds_read_b64_tr_b16 v[98:99], v56 offset:33792
    buffer_load_dwordx4 v[132:135], v4, s[36:39], s82 offen offset:3072 sc1
    s_waitcnt lgkmcnt(10)
    v_mfma_f32_32x32x16_bf16 v[80:95], v[180:183], v[108:111], v[80:95]
    ds_read_b64_tr_b16 v[100:101], v57 offset:32768
    ds_read_b64_tr_b16 v[102:103], v57 offset:33792
    s_waitcnt vmcnt(13) lgkmcnt(10)
    v_mfma_f32_32x32x16_bf16 v[64:79], v[184:187], v[112:115], v[64:79]
    ds_read_b64_tr_b16 v[104:105], v56 offset:34816
    ds_read_b64_tr_b16 v[106:107], v56 offset:35840
    s_add_u32 s82, s72, 20480
    buffer_load_dwordx4 v[136:139], v4, s[36:39], s82 offen offset:0 sc1
    s_waitcnt lgkmcnt(10)
    v_mfma_f32_32x32x16_bf16 v[80:95], v[184:187], v[116:119], v[80:95]
    ds_read_b64_tr_b16 v[108:109], v57 offset:34816
    ds_read_b64_tr_b16 v[110:111], v57 offset:35840
    s_waitcnt vmcnt(13) lgkmcnt(10)
    v_mfma_f32_32x32x16_bf16 v[64:79], v[188:191], v[120:123], v[64:79]
    ds_read_b64_tr_b16 v[112:113], v56 offset:40960
    ds_read_b64_tr_b16 v[114:115], v56 offset:41984
    buffer_load_dwordx4 v[140:143], v4, s[36:39], s82 offen offset:1024 sc1
    s_waitcnt lgkmcnt(10)
    v_mfma_f32_32x32x16_bf16 v[80:95], v[188:191], v[124:127], v[80:95]
    ds_read_b64_tr_b16 v[116:117], v57 offset:40960
    ds_read_b64_tr_b16 v[118:119], v57 offset:41984
    s_waitcnt vmcnt(13) lgkmcnt(10)
    v_mfma_f32_32x32x16_bf16 v[64:79], v[192:195], v[96:99], v[64:79]
    ds_read_b64_tr_b16 v[120:121], v56 offset:43008
    ds_read_b64_tr_b16 v[122:123], v56 offset:44032
    buffer_load_dwordx4 v[144:147], v4, s[36:39], s82 offen offset:2048 sc1
    s_waitcnt lgkmcnt(10)
    v_mfma_f32_32x32x16_bf16 v[80:95], v[192:195], v[100:103], v[80:95]
    ds_read_b64_tr_b16 v[124:125], v57 offset:43008
    ds_read_b64_tr_b16 v[126:127], v57 offset:44032
    s_waitcnt vmcnt(13) lgkmcnt(10)
    v_mfma_f32_32x32x16_bf16 v[64:79], v[196:199], v[104:107], v[64:79]
    ds_read_b64_tr_b16 v[96:97], v58 offset:0
    ds_read_b64_tr_b16 v[98:99], v58 offset:1024
    buffer_load_dwordx4 v[148:151], v4, s[36:39], s82 offen offset:3072 sc1
    s_waitcnt lgkmcnt(10)
    v_mfma_f32_32x32x16_bf16 v[80:95], v[196:199], v[108:111], v[80:95]
    ds_read_b64_tr_b16 v[100:101], v59 offset:0
    ds_read_b64_tr_b16 v[102:103], v59 offset:1024
    s_waitcnt vmcnt(13) lgkmcnt(10)
    v_mfma_f32_32x32x16_bf16 v[64:79], v[200:203], v[112:115], v[64:79]
    ds_read_b64_tr_b16 v[104:105], v58 offset:2048
    ds_read_b64_tr_b16 v[106:107], v58 offset:3072
    s_add_u32 s82, s72, 24576
    buffer_load_dwordx4 v[152:155], v4, s[36:39], s82 offen offset:0 sc1
    s_waitcnt lgkmcnt(10)
    v_mfma_f32_32x32x16_bf16 v[80:95], v[200:203], v[116:119], v[80:95]
    ds_read_b64_tr_b16 v[108:109], v59 offset:2048
    ds_read_b64_tr_b16 v[110:111], v59 offset:3072
    s_waitcnt vmcnt(13) lgkmcnt(10)
    v_mfma_f32_32x32x16_bf16 v[64:79], v[204:207], v[120:123], v[64:79]
    ds_read_b64_tr_b16 v[112:113], v58 offset:8192
    ds_read_b64_tr_b16 v[114:115], v58 offset:9216
    buffer_load_dwordx4 v[156:159], v4, s[36:39], s82 offen offset:1024 sc1
    s_waitcnt lgkmcnt(10)
    v_mfma_f32_32x32x16_bf16 v[80:95], v[204:207], v[124:127], v[80:95]
    ds_read_b64_tr_b16 v[116:117], v59 offset:8192
    ds_read_b64_tr_b16 v[118:119], v59 offset:9216
    s_waitcnt vmcnt(13) lgkmcnt(10)
    v_mfma_f32_32x32x16_bf16 v[64:79], v[208:211], v[96:99], v[64:79]
    ds_read_b64_tr_b16 v[120:121], v58 offset:10240
    ds_read_b64_tr_b16 v[122:123], v58 offset:11264
    buffer_load_dwordx4 v[160:163], v4, s[36:39], s82 offen offset:2048 sc1
    s_waitcnt lgkmcnt(10)
    v_mfma_f32_32x32x16_bf16 v[80:95], v[208:211], v[100:103], v[80:95]
    ds_read_b64_tr_b16 v[124:125], v59 offset:10240
    ds_read_b64_tr_b16 v[126:127], v59 offset:11264
    s_waitcnt vmcnt(13) lgkmcnt(10)
    v_mfma_f32_32x32x16_bf16 v[64:79], v[212:215], v[104:107], v[64:79]
    ds_read_b64_tr_b16 v[96:97], v58 offset:16384
    ds_read_b64_tr_b16 v[98:99], v58 offset:17408
    buffer_load_dwordx4 v[164:167], v4, s[36:39], s82 offen offset:3072 sc1
    s_waitcnt lgkmcnt(10)
    v_mfma_f32_32x32x16_bf16 v[80:95], v[212:215], v[108:111], v[80:95]
    ds_read_b64_tr_b16 v[100:101], v59 offset:16384
    ds_read_b64_tr_b16 v[102:103], v59 offset:17408
    s_waitcnt vmcnt(13) lgkmcnt(10)
    v_mfma_f32_32x32x16_bf16 v[64:79], v[216:219], v[112:115], v[64:79]
    ds_read_b64_tr_b16 v[104:105], v58 offset:18432
    ds_read_b64_tr_b16 v[106:107], v58 offset:19456
    s_add_u32 s82, s72, 28672
    buffer_load_dwordx4 v[168:171], v4, s[36:39], s82 offen offset:0 sc1
    s_waitcnt lgkmcnt(10)
    v_mfma_f32_32x32x16_bf16 v[80:95], v[216:219], v[116:119], v[80:95]
    ds_read_b64_tr_b16 v[108:109], v59 offset:18432
    ds_read_b64_tr_b16 v[110:111], v59 offset:19456
    s_waitcnt vmcnt(13) lgkmcnt(10)
    v_mfma_f32_32x32x16_bf16 v[64:79], v[220:223], v[120:123], v[64:79]
    ds_read_b64_tr_b16 v[112:113], v58 offset:24576
    ds_read_b64_tr_b16 v[114:115], v58 offset:25600
    buffer_load_dwordx4 v[172:175], v4, s[36:39], s82 offen offset:1024 sc1
    s_waitcnt lgkmcnt(10)
    v_mfma_f32_32x32x16_bf16 v[80:95], v[220:223], v[124:127], v[80:95]
    ds_read_b64_tr_b16 v[116:117], v59 offset:24576
    ds_read_b64_tr_b16 v[118:119], v59 offset:25600
    s_waitcnt vmcnt(13) lgkmcnt(10)
    v_mfma_f32_32x32x16_bf16 v[64:79], v[224:227], v[96:99], v[64:79]
    ds_read_b64_tr_b16 v[120:121], v58 offset:26624
    ds_read_b64_tr_b16 v[122:123], v58 offset:27648
    buffer_load_dwordx4 v[176:179], v4, s[36:39], s82 offen offset:2048 sc1
    s_waitcnt lgkmcnt(10)
    v_mfma_f32_32x32x16_bf16 v[80:95], v[224:227], v[100:103], v[80:95]
    ds_read_b64_tr_b16 v[124:125], v59 offset:26624
    ds_read_b64_tr_b16 v[126:127], v59 offset:27648
    s_waitcnt vmcnt(13) lgkmcnt(10)
    v_mfma_f32_32x32x16_bf16 v[64:79], v[228:231], v[104:107], v[64:79]
    ds_read_b64_tr_b16 v[96:97], v58 offset:32768
    ds_read_b64_tr_b16 v[98:99], v58 offset:33792
    buffer_load_dwordx4 v[180:183], v4, s[36:39], s82 offen offset:3072 sc1
    s_waitcnt lgkmcnt(10)
    v_mfma_f32_32x32x16_bf16 v[80:95], v[228:231], v[108:111], v[80:95]
    ds_read_b64_tr_b16 v[100:101], v59 offset:32768
    ds_read_b64_tr_b16 v[102:103], v59 offset:33792
    s_waitcnt vmcnt(13) lgkmcnt(10)
    v_mfma_f32_32x32x16_bf16 v[64:79], v[128:131], v[112:115], v[64:79]
    ds_read_b64_tr_b16 v[104:105], v58 offset:34816
    ds_read_b64_tr_b16 v[106:107], v58 offset:35840
    s_add_u32 s82, s72, 32768
    buffer_load_dwordx4 v[184:187], v4, s[36:39], s82 offen offset:0 sc1
    s_waitcnt lgkmcnt(10)
    v_mfma_f32_32x32x16_bf16 v[80:95], v[128:131], v[116:119], v[80:95]
    ds_read_b64_tr_b16 v[108:109], v59 offset:34816
    ds_read_b64_tr_b16 v[110:111], v59 offset:35840
    s_waitcnt vmcnt(13) lgkmcnt(10)
    v_mfma_f32_32x32x16_bf16 v[64:79], v[132:135], v[120:123], v[64:79]
    ds_read_b64_tr_b16 v[112:113], v58 offset:40960
    ds_read_b64_tr_b16 v[114:115], v58 offset:41984
    buffer_load_dwordx4 v[188:191], v4, s[36:39], s82 offen offset:1024 sc1
    s_waitcnt lgkmcnt(10)
    v_mfma_f32_32x32x16_bf16 v[80:95], v[132:135], v[124:127], v[80:95]
    ds_read_b64_tr_b16 v[116:117], v59 offset:40960
    ds_read_b64_tr_b16 v[118:119], v59 offset:41984
    s_waitcnt vmcnt(13) lgkmcnt(10)
    v_mfma_f32_32x32x16_bf16 v[64:79], v[136:139], v[96:99], v[64:79]
    ds_read_b64_tr_b16 v[120:121], v58 offset:43008
    ds_read_b64_tr_b16 v[122:123], v58 offset:44032
    buffer_load_dwordx4 v[192:195], v4, s[36:39], s82 offen offset:2048 sc1
    s_waitcnt lgkmcnt(10)
    v_mfma_f32_32x32x16_bf16 v[80:95], v[136:139], v[100:103], v[80:95]
    ds_read_b64_tr_b16 v[124:125], v59 offset:43008
    ds_read_b64_tr_b16 v[126:127], v59 offset:44032
    s_waitcnt vmcnt(13) lgkmcnt(10)
    v_mfma_f32_32x32x16_bf16 v[64:79], v[140:143], v[104:107], v[64:79]
    ds_read_b64_tr_b16 v[96:97], v60 offset:0
    ds_read_b64_tr_b16 v[98:99], v60 offset:1024
    buffer_load_dwordx4 v[196:199], v4, s[36:39], s82 offen offset:3072 sc1
    s_waitcnt lgkmcnt(10)
    v_mfma_f32_32x32x16_bf16 v[80:95], v[140:143], v[108:111], v[80:95]
    ds_read_b64_tr_b16 v[100:101], v61 offset:0
    ds_read_b64_tr_b16 v[102:103], v61 offset:1024
    s_waitcnt vmcnt(13) lgkmcnt(10)
    v_mfma_f32_32x32x16_bf16 v[64:79], v[144:147], v[112:115], v[64:79]
    ds_read_b64_tr_b16 v[104:105], v60 offset:2048
    ds_read_b64_tr_b16 v[106:107], v60 offset:3072
    s_add_u32 s82, s72, 36864
    buffer_load_dwordx4 v[200:203], v4, s[36:39], s82 offen offset:0 sc1
    s_waitcnt lgkmcnt(10)
    v_mfma_f32_32x32x16_bf16 v[80:95], v[144:147], v[116:119], v[80:95]
    ds_read_b64_tr_b16 v[108:109], v61 offset:2048
    ds_read_b64_tr_b16 v[110:111], v61 offset:3072
    s_waitcnt vmcnt(13) lgkmcnt(10)
    v_mfma_f32_32x32x16_bf16 v[64:79], v[148:151], v[120:123], v[64:79]
    ds_read_b64_tr_b16 v[112:113], v60 offset:8192
    ds_read_b64_tr_b16 v[114:115], v60 offset:9216
    buffer_load_dwordx4 v[204:207], v4, s[36:39], s82 offen offset:1024 sc1
    s_waitcnt lgkmcnt(10)
    v_mfma_f32_32x32x16_bf16 v[80:95], v[148:151], v[124:127], v[80:95]
    ds_read_b64_tr_b16 v[116:117], v61 offset:8192
    ds_read_b64_tr_b16 v[118:119], v61 offset:9216
    s_waitcnt vmcnt(13) lgkmcnt(10)
    v_mfma_f32_32x32x16_bf16 v[64:79], v[152:155], v[96:99], v[64:79]
    ds_read_b64_tr_b16 v[120:121], v60 offset:10240
    ds_read_b64_tr_b16 v[122:123], v60 offset:11264
    buffer_load_dwordx4 v[208:211], v4, s[36:39], s82 offen offset:2048 sc1
    s_waitcnt lgkmcnt(10)
    v_mfma_f32_32x32x16_bf16 v[80:95], v[152:155], v[100:103], v[80:95]
    ds_read_b64_tr_b16 v[124:125], v61 offset:10240
    ds_read_b64_tr_b16 v[126:127], v61 offset:11264
    s_waitcnt vmcnt(13) lgkmcnt(10)
    v_mfma_f32_32x32x16_bf16 v[64:79], v[156:159], v[104:107], v[64:79]
    ds_read_b64_tr_b16 v[96:97], v60 offset:16384
    ds_read_b64_tr_b16 v[98:99], v60 offset:17408
    buffer_load_dwordx4 v[212:215], v4, s[36:39], s82 offen offset:3072 sc1
    s_waitcnt lgkmcnt(10)
    v_mfma_f32_32x32x16_bf16 v[80:95], v[156:159], v[108:111], v[80:95]
    ds_read_b64_tr_b16 v[100:101], v61 offset:16384
    ds_read_b64_tr_b16 v[102:103], v61 offset:17408
    s_waitcnt vmcnt(13) lgkmcnt(10)
    v_mfma_f32_32x32x16_bf16 v[64:79], v[160:163], v[112:115], v[64:79]
    ds_read_b64_tr_b16 v[104:105], v60 offset:18432
    ds_read_b64_tr_b16 v[106:107], v60 offset:19456
    s_add_u32 s82, s72, 40960
    buffer_load_dwordx4 v[216:219], v4, s[36:39], s82 offen offset:0 sc1
    s_waitcnt lgkmcnt(10)
    v_mfma_f32_32x32x16_bf16 v[80:95], v[160:163], v[116:119], v[80:95]
    ds_read_b64_tr_b16 v[108:109], v61 offset:18432
    ds_read_b64_tr_b16 v[110:111], v61 offset:19456
    s_waitcnt vmcnt(13) lgkmcnt(10)
    v_mfma_f32_32x32x16_bf16 v[64:79], v[164:167], v[120:123], v[64:79]
    ds_read_b64_tr_b16 v[112:113], v60 offset:24576
    ds_read_b64_tr_b16 v[114:115], v60 offset:25600
    buffer_load_dwordx4 v[220:223], v4, s[36:39], s82 offen offset:1024 sc1
    s_waitcnt lgkmcnt(10)
    v_mfma_f32_32x32x16_bf16 v[80:95], v[164:167], v[124:127], v[80:95]
    ds_read_b64_tr_b16 v[116:117], v61 offset:24576
    ds_read_b64_tr_b16 v[118:119], v61 offset:25600
    s_waitcnt vmcnt(13) lgkmcnt(10)
    v_mfma_f32_32x32x16_bf16 v[64:79], v[168:171], v[96:99], v[64:79]
    ds_read_b64_tr_b16 v[120:121], v60 offset:26624
    ds_read_b64_tr_b16 v[122:123], v60 offset:27648
    buffer_load_dwordx4 v[224:227], v4, s[36:39], s82 offen offset:2048 sc1
    s_waitcnt lgkmcnt(10)
    v_mfma_f32_32x32x16_bf16 v[80:95], v[168:171], v[100:103], v[80:95]
    ds_read_b64_tr_b16 v[124:125], v61 offset:26624
    ds_read_b64_tr_b16 v[126:127], v61 offset:27648
    s_waitcnt vmcnt(13) lgkmcnt(10)
    v_mfma_f32_32x32x16_bf16 v[64:79], v[172:175], v[104:107], v[64:79]
    ds_read_b64_tr_b16 v[96:97], v60 offset:32768
    ds_read_b64_tr_b16 v[98:99], v60 offset:33792
    buffer_load_dwordx4 v[228:231], v4, s[36:39], s82 offen offset:3072 sc1
    s_waitcnt lgkmcnt(10)
    v_mfma_f32_32x32x16_bf16 v[80:95], v[172:175], v[108:111], v[80:95]
    ds_read_b64_tr_b16 v[100:101], v61 offset:32768
    ds_read_b64_tr_b16 v[102:103], v61 offset:33792
    s_waitcnt vmcnt(13) lgkmcnt(10)
    v_mfma_f32_32x32x16_bf16 v[64:79], v[176:179], v[112:115], v[64:79]
    ds_read_b64_tr_b16 v[104:105], v60 offset:34816
    ds_read_b64_tr_b16 v[106:107], v60 offset:35840
    s_add_u32 s82, s72, 45056
    buffer_load_dwordx4 v[128:131], v4, s[36:39], s82 offen offset:0 sc1
    s_waitcnt lgkmcnt(10)
    v_mfma_f32_32x32x16_bf16 v[80:95], v[176:179], v[116:119], v[80:95]
    ds_read_b64_tr_b16 v[108:109], v61 offset:34816
    ds_read_b64_tr_b16 v[110:111], v61 offset:35840
    s_waitcnt vmcnt(13) lgkmcnt(10)
    v_mfma_f32_32x32x16_bf16 v[64:79], v[180:183], v[120:123], v[64:79]
    ds_read_b64_tr_b16 v[112:113], v60 offset:40960
    ds_read_b64_tr_b16 v[114:115], v60 offset:41984
    buffer_load_dwordx4 v[132:135], v4, s[36:39], s82 offen offset:1024 sc1
    s_waitcnt lgkmcnt(10)
    v_mfma_f32_32x32x16_bf16 v[80:95], v[180:183], v[124:127], v[80:95]
    ds_read_b64_tr_b16 v[116:117], v61 offset:40960
    ds_read_b64_tr_b16 v[118:119], v61 offset:41984
    s_waitcnt vmcnt(13) lgkmcnt(10)
    v_mfma_f32_32x32x16_bf16 v[64:79], v[184:187], v[96:99], v[64:79]
    ds_read_b64_tr_b16 v[120:121], v60 offset:43008
    ds_read_b64_tr_b16 v[122:123], v60 offset:44032
    buffer_load_dwordx4 v[136:139], v4, s[36:39], s82 offen offset:2048 sc1
    s_waitcnt lgkmcnt(10)
    v_mfma_f32_32x32x16_bf16 v[80:95], v[184:187], v[100:103], v[80:95]
    ds_read_b64_tr_b16 v[124:125], v61 offset:43008
    ds_read_b64_tr_b16 v[126:127], v61 offset:44032
    s_waitcnt vmcnt(13) lgkmcnt(10)
    v_mfma_f32_32x32x16_bf16 v[64:79], v[188:191], v[104:107], v[64:79]
    buffer_load_dwordx4 v[140:143], v4, s[36:39], s82 offen offset:3072 sc1
    s_waitcnt lgkmcnt(8)
    v_mfma_f32_32x32x16_bf16 v[80:95], v[188:191], v[108:111], v[80:95]
    s_waitcnt vmcnt(13) lgkmcnt(6)
    v_mfma_f32_32x32x16_bf16 v[64:79], v[192:195], v[112:115], v[64:79]
    s_waitcnt lgkmcnt(4)
    v_mfma_f32_32x32x16_bf16 v[80:95], v[192:195], v[116:119], v[80:95]
    s_waitcnt vmcnt(12) lgkmcnt(2)
    v_mfma_f32_32x32x16_bf16 v[64:79], v[196:199], v[120:123], v[64:79]
    s_waitcnt lgkmcnt(0)
    v_mfma_f32_32x32x16_bf16 v[80:95], v[196:199], v[124:127], v[80:95]
    s_barrier
    s_waitcnt vmcnt(11)
    v_mfma_f32_32x32x16_bf16 v[64:79], v[200:203], a[0:3], v[64:79]
    v_mfma_f32_32x32x16_bf16 v[80:95], v[200:203], a[4:7], v[80:95]
    s_waitcnt vmcnt(10)
    v_mfma_f32_32x32x16_bf16 v[64:79], v[204:207], a[8:11], v[64:79]
    v_mfma_f32_32x32x16_bf16 v[80:95], v[204:207], a[12:15], v[80:95]
    s_waitcnt vmcnt(9)
    v_mfma_f32_32x32x16_bf16 v[64:79], v[208:211], a[16:19], v[64:79]
    v_mfma_f32_32x32x16_bf16 v[80:95], v[208:211], a[20:23], v[80:95]
    s_waitcnt vmcnt(8)
    v_mfma_f32_32x32x16_bf16 v[64:79], v[212:215], a[24:27], v[64:79]
    v_mfma_f32_32x32x16_bf16 v[80:95], v[212:215], a[28:31], v[80:95]
    s_waitcnt vmcnt(7)
    v_mfma_f32_32x32x16_bf16 v[64:79], v[216:219], a[32:35], v[64:79]
    v_mfma_f32_32x32x16_bf16 v[80:95], v[216:219], a[36:39], v[80:95]
    s_waitcnt vmcnt(6)
    v_mfma_f32_32x32x16_bf16 v[64:79], v[220:223], a[40:43], v[64:79]
    v_mfma_f32_32x32x16_bf16 v[80:95], v[220:223], a[44:47], v[80:95]
    s_waitcnt vmcnt(5)
    v_mfma_f32_32x32x16_bf16 v[64:79], v[224:227], a[48:51], v[64:79]
    v_mfma_f32_32x32x16_bf16 v[80:95], v[224:227], a[52:55], v[80:95]
    s_waitcnt vmcnt(4)
    v_mfma_f32_32x32x16_bf16 v[64:79], v[228:231], a[56:59], v[64:79]
    v_mfma_f32_32x32x16_bf16 v[80:95], v[228:231], a[60:63], v[80:95]
    s_waitcnt vmcnt(3)
    v_mfma_f32_32x32x16_bf16 v[64:79], v[128:131], a[64:67], v[64:79]
    v_mfma_f32_32x32x16_bf16 v[80:95], v[128:131], a[68:71], v[80:95]
    s_waitcnt vmcnt(2)
    v_mfma_f32_32x32x16_bf16 v[64:79], v[132:135], a[72:75], v[64:79]
    v_mfma_f32_32x32x16_bf16 v[80:95], v[132:135], a[76:79], v[80:95]
    s_waitcnt vmcnt(1)
    v_mfma_f32_32x32x16_bf16 v[80:95], v[136:139], a[84:87], v[80:95]
    s_waitcnt vmcnt(0)
    v_mfma_f32_32x32x16_bf16 v[80:95], v[140:143], a[92:95], v[80:95]
    v_mfma_f32_32x32x16_bf16 v[64:79], v[136:139], a[80:83], v[64:79]
    v_mfma_f32_32x32x16_bf16 v[64:79], v[140:143], a[88:91], v[64:79]
    s_nop 9
    ds_write_b128 v22, v[80:83] offset:0
    ds_write_b128 v22, v[84:87] offset:1024
    ds_write_b128 v22, v[88:91] offset:2048
    ds_write_b128 v22, v[92:95] offset:3072
    s_waitcnt lgkmcnt(0)
    s_barrier
    ds_read_b128 v[96:99], v23 offset:0
    ds_read_b128 v[100:103], v23 offset:1024
    ds_read_b128 v[104:107], v23 offset:2048
    ds_read_b128 v[108:111], v23 offset:3072
    s_waitcnt lgkmcnt(3)
    v_pk_add_f32 v[64:65], v[64:65], v[96:97]
    v_pk_add_f32 v[66:67], v[66:67], v[98:99]
    s_waitcnt lgkmcnt(2)
    v_pk_add_f32 v[68:69], v[68:69], v[100:101]
    v_pk_add_f32 v[70:71], v[70:71], v[102:103]
    v_cvt_pk_bf16_f32 v80, v64, v65
    v_cvt_pk_bf16_f32 v81, v66, v67
    v_cvt_pk_bf16_f32 v82, v68, v69
    v_cvt_pk_bf16_f32 v83, v70, v71
    buffer_store_dwordx4 v[80:83], v24, s[32:35], s60 offen offset:0
    s_waitcnt lgkmcnt(1)
    v_pk_add_f32 v[72:73], v[72:73], v[104:105]
    v_pk_add_f32 v[74:75], v[74:75], v[106:107]
    s_waitcnt lgkmcnt(0)
    v_pk_add_f32 v[76:77], v[76:77], v[108:109]
    v_pk_add_f32 v[78:79], v[78:79], v[110:111]
    v_cvt_pk_bf16_f32 v84, v72, v73
    v_cvt_pk_bf16_f32 v85, v74, v75
    v_cvt_pk_bf16_f32 v86, v76, v77
    v_cvt_pk_bf16_f32 v87, v78, v79
    buffer_store_dwordx4 v[84:87], v24, s[32:35], s60 offen offset:32
    s_or_b32 s60, s2, s41
    s_cmp_lg_u32 s60, 0
    s_cbranch_scc1 ep_47
    v_mov_b32 v22, 0
    s_mov_b64 exec, 1
    buffer_store_dword v26, v22, s[36:39], 0 offen sc1
    s_mov_b32 s60, 2031616
    buffer_store_dword v26, v22, s[36:39], s60 offen sc1
    s_mov_b64 exec, -1
ep_47:
    s_endpgm
L_end:
.section .rodata,"a"
.p2align 6
.amdhsa_kernel interleave_layers__sliding_local_dilated__mixer_token_mlp__prompt_kernel
  .amdhsa_next_free_vgpr 512
  .amdhsa_next_free_sgpr 102
  .amdhsa_accum_offset 256
  .amdhsa_group_segment_fixed_size 0
  .amdhsa_kernarg_size 88
  .amdhsa_user_sgpr_count 2
  .amdhsa_user_sgpr_kernarg_segment_ptr 1
  .amdhsa_system_sgpr_workgroup_id_x 1
.end_amdhsa_kernel
```
